```python
import torch

def _softmax(x, axis=-1):
    return torch.softmax(x, dim=axis)
def _gelu(x):
    return torch.nn.functional.gelu(x, approximate="tanh")
def _silu(x):
    return torch.nn.functional.silu(x)
def _sigmoid(x):
    return torch.sigmoid(x)
def _layernorm(x, axis=-1, eps=1e-5):
    m = x.mean(dim=axis, keepdim=True)
    v = x.var(dim=axis, keepdim=True, unbiased=False)
    return (x - m) / torch.sqrt(v + eps)
def _scatter_add(tgt, idx, src, axis=0):
    return tgt.clone().index_add_(axis, idx, src)
def _segment_sum(src, seg, n):
    out = torch.zeros((n,) + src.shape[1:], dtype=src.dtype)
    return out.index_add_(0, seg, src)
def _pad(x, pw):
    flat = tuple(v for pair in reversed(pw) for v in pair)
    return torch.nn.functional.pad(x, flat)

kernel_name = 'recurrent_scan__linear_kernel_hedgehog__glu_gated_swiglu__prompt'

def setup_inputs():

    _w = (lambda a: (lambda t: t.to(torch.bfloat16) if t.is_floating_point() else t)(torch.as_tensor(a)))
    def _A_setup():
        B, S, D, H = 1, 2048, 512, 32
        Dh = D // H
        return {
            "x": _w((lambda *s: torch.randn(*s, dtype=torch.bfloat16) * 0.05)(B, S, D)),
            "wqkv": _w((lambda *s: torch.randn(*s, dtype=torch.bfloat16) * 0.8)(D, 3 * D)),
            "w_phi": _w((lambda *s: torch.randn(*s, dtype=torch.bfloat16) * 0.8)(H, Dh, Dh) * (Dh ** -0.5)),
            "wo": _w((lambda *s: torch.randn(*s, dtype=torch.bfloat16) * 0.8)(D, D)),
        }
    _A_in = _A_setup()

    def _B_setup():
        B, S, D, F = 1, 2048, 512, 1376
        return {
            "x": _w((lambda *s: torch.randn(*s, dtype=torch.bfloat16) * 0.05)(B, S, D)),
            "w1": _w((lambda *s: torch.randn(*s, dtype=torch.bfloat16) * 0.2)(D, F) * (2.0 / D) ** 0.5),
            "w3": _w((lambda *s: torch.randn(*s, dtype=torch.bfloat16) * 0.2)(D, F) * (2.0 / D) ** 0.5),
            "w2": _w((lambda *s: torch.randn(*s, dtype=torch.bfloat16) * 0.2)(F, D) * (2.0 / F) ** 0.5),
        }
    _B_in = _B_setup()

    return {
        "A_x": _A_in["x"],
        "A_wqkv": _A_in["wqkv"],
        "A_w_phi": _A_in["w_phi"],
        "A_wo": _A_in["wo"],
        "B_x": _B_in["x"],
        "B_w1": _B_in["w1"],
        "B_w3": _B_in["w3"],
        "B_w2": _B_in["w2"],
    }

def reference(A_x, A_wqkv, A_w_phi, A_wo, B_x, B_w1, B_w3, B_w2):
    def _A_ref(x, wqkv, w_phi, wo):
        B, S, D = x.shape
        H = 32; Dh = D // H
        qkv = (lambda x, *d: x.permute(*d))((x @ wqkv).reshape(B, S, 3, H, Dh), 2, 0, 3, 1, 4)
        q, k, v = qkv[0], qkv[1], qkv[2]
        pq = torch.einsum("bhsd,hdf->bhsf", q, w_phi)
        pk = torch.einsum("bhsd,hdf->bhsf", k, w_phi)
        phi_q = torch.concatenate([_softmax(pq, axis=-1), _softmax(-pq, axis=-1)], axis=-1)
        phi_k = torch.concatenate([_softmax(pk, axis=-1), _softmax(-pk, axis=-1)], axis=-1)
        kv = torch.einsum("bhsf,bhsd->bhfd", phi_k, v)
        z  = torch.einsum("bhsf->bhf", phi_k)
        num = torch.einsum("bhqf,bhfd->bhqd", phi_q, kv)
        den = torch.einsum("bhqf,bhf->bhq", phi_q, z)[..., None] + 1e-6
        o = num / den
        return (lambda x, *d: x.permute(*d))(o, 0, 2, 1, 3).reshape(B, S, D) @ wo

    def _B_ref(x, w1, w3, w2):
        gate = torch.einsum("bsd,df->bsf", x, w1)
        up = torch.einsum("bsd,df->bsf", x, w3)
        h = _silu(gate) * up
        out = torch.einsum("bsf,fd->bsd", h, w2)
        return out

    x = A_x
    xn = _layernorm(x, axis=-1)
    s = _A_ref(xn, A_wqkv, A_w_phi, A_wo)
    g = _silu(_B_ref(xn, B_w1, B_w3, B_w2))
    return x + s * g
```

```asm
; @launch kernel=k0_kernel grid=(256,1,1) block=(1024,1,1) lds=16384
; @launch kernel=k1_kernel grid=(256,1,1) block=(512,1,1) lds=163840
; @launch kernel=k2_kernel grid=(256,1,1) block=(512,1,1) lds=139264
.amdgcn_target "amdgcn-amd-amdhsa--gfx950"
.text
.globl k0_kernel
.p2align 8
.type k0_kernel,@function
k0_kernel:
    s_cmp_ge_u32 s2, 128
    s_cbranch_scc1 K0_pref
    s_load_dwordx2 s[4:5], s[0:1], 0
    s_load_dwordx2 s[6:7], s[0:1], 80
    v_lshrrev_b32 v1, 6, v0
    v_and_b32 v2, 63, v0
    v_mov_b32 v28, v1
    s_lshl_b32 s3, s2, 4
    v_add_u32 v1, s3, v1
    v_lshlrev_b32 v3, 10, v1
    v_lshl_add_u32 v3, v2, 4, v3
    s_lshl_b32 s3, s2, 10
    v_add_u32 v20, s3, v0
    v_lshlrev_b32 v20, 4, v20
    v_mov_b32 v24, 0
    v_mov_b32 v25, 0
    v_mov_b32 v26, 0
    v_mov_b32 v27, 0
    s_waitcnt lgkmcnt(0)
    s_mov_b32 s8, s4
    s_mov_b32 s9, s5
    s_mov_b32 s10, 0x200000
    s_mov_b32 s11, 0x00020000
    s_mov_b32 s12, s6
    s_mov_b32 s13, s7
    s_mov_b32 s14, 0x200000
    s_mov_b32 s15, 0x00020000
    s_add_u32 s16, s6, 0xc00000
    s_addc_u32 s17, s7, 0
    s_mov_b32 s18, 0x11000
    s_mov_b32 s19, 0x00020000
    buffer_load_dwordx4 v[4:7], v3, s[8:11], 0 offen
    buffer_store_dwordx4 v[24:27], v20, s[16:19], 0 offen
    s_waitcnt vmcnt(1)
    v_lshlrev_b32 v8, 16, v4
    v_and_b32 v9, 0xffff0000, v4
    v_lshlrev_b32 v10, 16, v5
    v_and_b32 v11, 0xffff0000, v5
    v_lshlrev_b32 v12, 16, v6
    v_and_b32 v13, 0xffff0000, v6
    v_lshlrev_b32 v14, 16, v7
    v_and_b32 v15, 0xffff0000, v7
    v_add_f32 v16, v8, v9
    v_add_f32 v16, v16, v10
    v_add_f32 v16, v16, v11
    v_add_f32 v16, v16, v12
    v_add_f32 v16, v16, v13
    v_add_f32 v16, v16, v14
    v_add_f32 v16, v16, v15
    s_nop 1
    v_add_f32_dpp v16, v16, v16 row_ror:8 row_mask:0xf bank_mask:0xf
    s_nop 1
    v_add_f32_dpp v16, v16, v16 row_ror:4 row_mask:0xf bank_mask:0xf
    s_nop 1
    v_add_f32_dpp v16, v16, v16 row_ror:2 row_mask:0xf bank_mask:0xf
    s_nop 1
    v_add_f32_dpp v16, v16, v16 row_ror:1 row_mask:0xf bank_mask:0xf
    v_mov_b32 v17, v16
    s_nop 1
    v_permlane16_swap_b32 v16, v17
    v_add_f32 v16, v16, v17
    v_mov_b32 v17, v16
    s_nop 1
    v_permlane32_swap_b32 v16, v17
    v_add_f32 v16, v16, v17
    v_mul_f32 v16, 0x3b000000, v16
    v_sub_f32 v18, v8, v16
    v_mul_f32 v17, v18, v18
    v_sub_f32 v18, v9, v16
    v_fmac_f32 v17, v18, v18
    v_sub_f32 v18, v10, v16
    v_fmac_f32 v17, v18, v18
    v_sub_f32 v18, v11, v16
    v_fmac_f32 v17, v18, v18
    v_sub_f32 v18, v12, v16
    v_fmac_f32 v17, v18, v18
    v_sub_f32 v18, v13, v16
    v_fmac_f32 v17, v18, v18
    v_sub_f32 v18, v14, v16
    v_fmac_f32 v17, v18, v18
    v_sub_f32 v18, v15, v16
    v_fmac_f32 v17, v18, v18
    s_nop 1
    v_add_f32_dpp v17, v17, v17 row_ror:8 row_mask:0xf bank_mask:0xf
    s_nop 1
    v_add_f32_dpp v17, v17, v17 row_ror:4 row_mask:0xf bank_mask:0xf
    s_nop 1
    v_add_f32_dpp v17, v17, v17 row_ror:2 row_mask:0xf bank_mask:0xf
    s_nop 1
    v_add_f32_dpp v17, v17, v17 row_ror:1 row_mask:0xf bank_mask:0xf
    v_mov_b32 v18, v17
    s_nop 1
    v_permlane16_swap_b32 v17, v18
    v_add_f32 v17, v17, v18
    v_mov_b32 v18, v17
    s_nop 1
    v_permlane32_swap_b32 v17, v18
    v_add_f32 v17, v17, v18
    v_mul_f32 v17, 0x3b000000, v17
    v_cvt_pk_bf16_f32 v16, v16, v17
    v_and_b32 v17, 0xffff0000, v16
    v_lshlrev_b32 v16, 16, v16
    v_add_f32 v17, 0x3727c5ac, v17
    v_cvt_pk_bf16_f32 v17, v17, v17
    v_lshlrev_b32 v17, 16, v17
    v_sqrt_f32 v17, v17
    s_nop 0
    v_cvt_pk_bf16_f32 v17, v17, v17
    v_lshlrev_b32 v17, 16, v17
    v_rcp_f32 v17, v17
    v_sub_f32 v8, v8, v16
    v_sub_f32 v9, v9, v16
    v_sub_f32 v10, v10, v16
    v_sub_f32 v11, v11, v16
    v_sub_f32 v12, v12, v16
    v_sub_f32 v13, v13, v16
    v_sub_f32 v14, v14, v16
    v_sub_f32 v15, v15, v16
    v_cvt_pk_bf16_f32 v4, v8, v9
    v_cvt_pk_bf16_f32 v5, v10, v11
    v_cvt_pk_bf16_f32 v6, v12, v13
    v_cvt_pk_bf16_f32 v7, v14, v15
    v_lshlrev_b32 v8, 16, v4
    v_and_b32 v9, 0xffff0000, v4
    v_lshlrev_b32 v10, 16, v5
    v_and_b32 v11, 0xffff0000, v5
    v_lshlrev_b32 v12, 16, v6
    v_and_b32 v13, 0xffff0000, v6
    v_lshlrev_b32 v14, 16, v7
    v_and_b32 v15, 0xffff0000, v7
    v_mul_f32 v8, v8, v17
    v_mul_f32 v9, v9, v17
    v_mul_f32 v10, v10, v17
    v_mul_f32 v11, v11, v17
    v_mul_f32 v12, v12, v17
    v_mul_f32 v13, v13, v17
    v_mul_f32 v14, v14, v17
    v_mul_f32 v15, v15, v17
    v_cvt_pk_bf16_f32 v4, v8, v9
    v_cvt_pk_bf16_f32 v5, v10, v11
    v_cvt_pk_bf16_f32 v6, v12, v13
    v_cvt_pk_bf16_f32 v7, v14, v15
    v_lshrrev_b32 v8, 2, v2
    v_and_b32 v9, 3, v2
    v_lshlrev_b32 v8, 10, v8
    v_lshl_add_u32 v8, v9, 8, v8
    v_lshl_add_u32 v8, v28, 4, v8
    ds_write_b128 v8, v[4:7]
    v_lshlrev_b32 v9, 4, v0
    s_lshl_b32 s3, s2, 14
    s_waitcnt lgkmcnt(0)
    s_barrier
    ds_read_b128 v[4:7], v9
    s_waitcnt lgkmcnt(0)
    buffer_store_dwordx4 v[4:7], v9, s[12:15], s3 offen
    s_branch K0_done
K0_pref:
    s_cmp_ge_u32 s2, 256
    s_cbranch_scc1 K0_done
    s_load_dwordx2 s[4:5], s[0:1], 8
    s_load_dwordx2 s[6:7], s[0:1], 24
    s_load_dwordx4 s[8:11], s[0:1], 40
    s_load_dwordx2 s[12:13], s[0:1], 56
    s_sub_u32 s3, s2, 128
    s_lshl_b32 s3, s3, 10
    v_add_u32 v1, s3, v0
    v_lshlrev_b32 v1, 4, v1
    s_waitcnt lgkmcnt(0)
    s_mov_b32 s16, s4
    s_mov_b32 s17, s5
    s_mov_b32 s18, 0x180000
    s_mov_b32 s19, 0x00020000
    s_mov_b32 s20, s6
    s_mov_b32 s21, s7
    s_mov_b32 s22, 0x80000
    s_mov_b32 s23, 0x00020000
    s_mov_b32 s24, s8
    s_mov_b32 s25, s9
    s_mov_b32 s26, 0x158000
    s_mov_b32 s27, 0x00020000
    s_mov_b32 s28, s10
    s_mov_b32 s29, s11
    s_mov_b32 s30, 0x158000
    s_mov_b32 s31, 0x00020000
    s_mov_b32 s32, s12
    s_mov_b32 s33, s13
    s_mov_b32 s34, 0x158000
    s_mov_b32 s35, 0x00020000
    buffer_load_dwordx4 v[4:7], v1, s[16:19], 0 offen
    buffer_load_dwordx4 v[8:11], v1, s[24:27], 0 offen
    buffer_load_dwordx4 v[12:15], v1, s[28:31], 0 offen
    buffer_load_dwordx4 v[16:19], v1, s[32:35], 0 offen
    buffer_load_dwordx4 v[20:23], v1, s[20:23], 0 offen
K0_done:
    s_endpgm
.text
.globl k1_kernel
.p2align 8
.type k1_kernel,@function
k1_kernel:
    s_cmp_ge_u32 s2, 256
    s_cbranch_scc1 K1_done
    s_load_dwordx4 s[4:7], s[0:1], 8
    s_load_dwordx4 s[8:11], s[0:1], 40
    s_load_dwordx2 s[12:13], s[0:1], 80
    v_lshrrev_b32 v12, 6, v0
    v_and_b32 v1, 63, v0
    v_readfirstlane_b32 s16, v12
    v_and_b32 v2, 15, v1
    v_lshrrev_b32 v3, 4, v1
    v_mov_b32 v244, 0
    s_and_b32 s14, s2, 7
    s_lshl_b32 s14, s14, 2
    s_lshr_b32 s15, s2, 3
    s_and_b32 s3, s15, 3
    s_add_u32 s14, s14, s3
    s_lshr_b32 s15, s15, 2
    s_lshl_b32 s3, s15, 8
    s_lshl_b32 s46, s16, 5
    s_add_u32 s46, s46, s3
    s_lshl_b32 s3, s46, 10
    v_lshlrev_b32 v4, 4, v1
    v_add_u32 v4, s3, v4
    v_add_u32 v5, 0x4000, v4
    s_lshr_b32 s47, s16, 2
    s_and_b32 s48, s16, 3
    s_waitcnt lgkmcnt(0)
    s_mov_b32 s28, s12
    s_mov_b32 s29, s13
    s_mov_b32 s30, 0x200000
    s_mov_b32 s31, 0x00020000
    s_add_u32 s36, s12, 0xc00000
    s_addc_u32 s37, s13, 0
    s_mov_b32 s38, 0x11000
    s_mov_b32 s39, 0x00020000
    s_mov_b32 s40, s6
    s_mov_b32 s41, s7
    s_mov_b32 s42, 0x4000
    s_mov_b32 s43, 0x00020000
    s_cmp_lt_u32 s14, 12
    s_cbranch_scc0 K1_gu_setup
    s_movk_i32 s17, 3072
    s_cmp_lt_u32 s14, 4
    s_cbranch_scc0 K1_kv_off
    s_lshl_b32 s3, s14, 8
    s_lshl_b32 s49, s47, 7
    s_add_u32 s3, s3, s49
    s_lshl_b32 s50, s14, 3
    s_branch K1_qkv_srd
K1_kv_off:
    s_sub_u32 s3, s14, 4
    s_lshl_b32 s50, s3, 2
    s_lshl_b32 s3, s3, 7
    s_add_u32 s3, s3, 1024
    s_lshl_b32 s49, s47, 10
    s_add_u32 s3, s3, s49
K1_qkv_srd:
    s_add_u32 s24, s4, s3
    s_addc_u32 s25, s5, 0
    s_sub_u32 s26, 0x180000, s3
    s_mov_b32 s27, 0x00020000
    s_lshl_b32 s3, s50, 9
    v_lshlrev_b32 v13, 4, v1
    v_add_u32 v244, s3, v13
    s_branch K1_w4_setup
K1_gu_setup:
    s_movk_i32 s17, 2752
    s_sub_u32 s3, s14, 12
    s_mul_i32 s49, s3, 5
    s_lshl_b32 s50, s3, 2
    s_add_u32 s50, s50, 6
    s_cmp_lt_u32 s3, 6
    s_cselect_b32 s50, s49, s50
    s_lshl_b32 s3, s50, 5
    s_cmp_eq_u32 s47, 0
    s_cselect_b32 s24, s8, s10
    s_cselect_b32 s25, s9, s11
    s_add_u32 s24, s24, s3
    s_addc_u32 s25, s25, 0
    s_sub_u32 s26, 0x158000, s3
    s_mov_b32 s27, 0x00020000
    s_cmp_lt_u32 s14, 18
    s_cbranch_scc1 K1_w5_setup
K1_w4_setup:
    s_lshl_b32 s18, s17, 5
    v_lshrrev_b32 v13, 3, v1
    s_lshl_b32 s3, s48, 3
    v_add_u32 v13, s3, v13
    v_and_b32 v14, 7, v1
    v_and_b32 v15, 0x13, v13
    v_and_b32 v6, 8, v13
    v_lshrrev_b32 v6, 1, v6
    v_or_b32 v15, v15, v6
    v_and_b32 v6, 4, v13
    v_lshlrev_b32 v6, 1, v6
    v_or_b32 v15, v15, v6
    v_bfe_u32 v13, v13, 1, 2
    v_lshrrev_b32 v6, 1, v14
    v_xor_b32 v6, v6, v13
    v_and_b32 v14, 1, v14
    v_lshl_or_b32 v6, v6, 1, v14
    v_lshlrev_b32 v6, 4, v6
    v_mad_u32_u24 v6, v15, s17, v6
    s_lshl_b32 s20, s47, 12
    s_lshl_b32 s3, s48, 10
    s_add_u32 s20, s20, s3
    v_lshrrev_b32 v13, 2, v2
    v_and_b32 v14, 1, v3
    v_lshrrev_b32 v15, 1, v3
    v_lshlrev_b32 v15, 4, v15
    v_lshl_add_u32 v15, v14, 2, v15
    v_add_u32 v15, v15, v13
    v_lshrrev_b32 v13, 1, v13
    v_lshl_add_u32 v13, v14, 1, v13
    v_and_b32 v14, 3, v1
    v_lshlrev_b32 v14, 3, v14
    v_lshl_add_u32 v14, v15, 7, v14
    v_xor_b32 v15, 0, v13
    v_lshl_add_u32 v8, v15, 5, v14
    v_xor_b32 v15, 1, v13
    v_lshl_add_u32 v9, v15, 5, v14
    v_xor_b32 v15, 2, v13
    v_lshl_add_u32 v10, v15, 5, v14
    v_xor_b32 v15, 3, v13
    v_lshl_add_u32 v11, v15, 5, v14
    s_cmp_lt_u32 s14, 4
    s_cbranch_scc1 K1_A_go
    s_cmp_lt_u32 s14, 12
    s_cbranch_scc0 K1_A_go
    s_and_b32 s54, s14, 3
    s_lshl_b32 s54, s54, 1
    s_add_u32 s54, s54, s15
    s_lshl_b32 s54, s54, 1
    s_and_b32 s54, s54, 0
    s_mul_i32 s19, s54, s18
    s_lshl_b32 s3, s16, 10
    s_add_u32 m0, s3, 131072
    s_nop 0
    buffer_load_dwordx4 v244, s[40:43], s3 offen lds
    s_add_u32 m0, s20, 0
    s_nop 0
    buffer_load_dwordx4 v6, s[24:27], s19 offen lds
    s_lshl_b32 s52, s54, 10
    s_add_u32 s54, s54, 1
    s_and_b32 s54, s54, 15
    s_mul_i32 s19, s54, s18
    buffer_load_dwordx4 v[16:19], v4, s[28:31], s52 offen
    buffer_load_dwordx4 v[20:23], v5, s[28:31], s52 offen
    s_add_u32 m0, s20, 8192
    s_nop 0
    buffer_load_dwordx4 v6, s[24:27], s19 offen lds
    s_lshl_b32 s52, s54, 10
    s_add_u32 s54, s54, 1
    s_and_b32 s54, s54, 15
    s_mul_i32 s19, s54, s18
    buffer_load_dwordx4 v[24:27], v4, s[28:31], s52 offen
    buffer_load_dwordx4 v[28:31], v5, s[28:31], s52 offen
    s_add_u32 m0, s20, 16384
    s_nop 0
    buffer_load_dwordx4 v6, s[24:27], s19 offen lds
    s_lshl_b32 s52, s54, 10
    s_add_u32 s54, s54, 1
    s_and_b32 s54, s54, 15
    s_mul_i32 s19, s54, s18
    buffer_load_dwordx4 v[32:35], v4, s[28:31], s52 offen
    buffer_load_dwordx4 v[36:39], v5, s[28:31], s52 offen
    s_add_u32 m0, s20, 24576
    s_nop 0
    buffer_load_dwordx4 v6, s[24:27], s19 offen lds
    s_lshl_b32 s52, s54, 10
    s_add_u32 s54, s54, 1
    s_and_b32 s54, s54, 15
    s_mul_i32 s19, s54, s18
    buffer_load_dwordx4 v[40:43], v4, s[28:31], s52 offen
    buffer_load_dwordx4 v[44:47], v5, s[28:31], s52 offen
    v_add_u32 v240, 0x10000, v8
    v_add_u32 v241, 0x10000, v9
    v_add_u32 v242, 0x10000, v10
    v_add_u32 v243, 0x10000, v11
    v_mov_b32 v144, 0
    v_mov_b32 v145, 0
    v_mov_b32 v146, 0
    v_mov_b32 v147, 0
    v_mov_b32 v148, 0
    v_mov_b32 v149, 0
    v_mov_b32 v150, 0
    v_mov_b32 v151, 0
    v_mov_b32 v152, 0
    v_mov_b32 v153, 0
    v_mov_b32 v154, 0
    v_mov_b32 v155, 0
    v_mov_b32 v156, 0
    v_mov_b32 v157, 0
    v_mov_b32 v158, 0
    v_mov_b32 v159, 0
    v_mov_b32 v160, 0
    v_mov_b32 v161, 0
    v_mov_b32 v162, 0
    v_mov_b32 v163, 0
    v_mov_b32 v164, 0
    v_mov_b32 v165, 0
    v_mov_b32 v166, 0
    v_mov_b32 v167, 0
    v_mov_b32 v168, 0
    v_mov_b32 v169, 0
    v_mov_b32 v170, 0
    v_mov_b32 v171, 0
    v_mov_b32 v172, 0
    v_mov_b32 v173, 0
    v_mov_b32 v174, 0
    v_mov_b32 v175, 0
    v_mov_b32 v176, 0
    v_mov_b32 v177, 0
    v_mov_b32 v178, 0
    v_mov_b32 v179, 0
    v_mov_b32 v180, 0
    v_mov_b32 v181, 0
    v_mov_b32 v182, 0
    v_mov_b32 v183, 0
    v_mov_b32 v184, 0
    v_mov_b32 v185, 0
    v_mov_b32 v186, 0
    v_mov_b32 v187, 0
    v_mov_b32 v188, 0
    v_mov_b32 v189, 0
    v_mov_b32 v190, 0
    v_mov_b32 v191, 0
    v_mov_b32 v192, 0
    v_mov_b32 v193, 0
    v_mov_b32 v194, 0
    v_mov_b32 v195, 0
    v_mov_b32 v196, 0
    v_mov_b32 v197, 0
    v_mov_b32 v198, 0
    v_mov_b32 v199, 0
    v_mov_b32 v200, 0
    v_mov_b32 v201, 0
    v_mov_b32 v202, 0
    v_mov_b32 v203, 0
    v_mov_b32 v204, 0
    v_mov_b32 v205, 0
    v_mov_b32 v206, 0
    v_mov_b32 v207, 0
    s_waitcnt vmcnt(11)
    s_barrier
    ds_read_b64_tr_b16 v[224:225], v8 offset:0
    ds_read_b64_tr_b16 v[226:227], v8 offset:1024
    ds_read_b64_tr_b16 v[228:229], v9 offset:0
    ds_read_b64_tr_b16 v[230:231], v9 offset:1024
    s_waitcnt vmcnt(5)
    s_barrier
    ds_read_b64_tr_b16 v[232:233], v10 offset:0
    ds_read_b64_tr_b16 v[234:235], v10 offset:1024
    s_waitcnt lgkmcnt(4)
    v_mfma_f32_16x16x32_bf16 v[144:147], v[224:227], v[16:19], v[144:147]
    v_mfma_f32_16x16x32_bf16 v[148:151], v[224:227], v[20:23], v[148:151]
    s_add_u32 m0, s20, 32768
    s_nop 0
    buffer_load_dwordx4 v6, s[24:27], s19 offen lds
    s_lshl_b32 s52, s54, 10
    s_add_u32 s54, s54, 1
    s_and_b32 s54, s54, 15
    s_mul_i32 s19, s54, s18
    ds_read_b64_tr_b16 v[236:237], v11 offset:0
    ds_read_b64_tr_b16 v[238:239], v11 offset:1024
    s_waitcnt lgkmcnt(4)
    v_mfma_f32_16x16x32_bf16 v[152:155], v[228:231], v[16:19], v[152:155]
    v_mfma_f32_16x16x32_bf16 v[156:159], v[228:231], v[20:23], v[156:159]
    ds_read_b64_tr_b16 v[224:225], v8 offset:4096
    ds_read_b64_tr_b16 v[226:227], v8 offset:5120
    s_waitcnt lgkmcnt(4)
    v_mfma_f32_16x16x32_bf16 v[160:163], v[232:235], v[16:19], v[160:163]
    v_mfma_f32_16x16x32_bf16 v[164:167], v[232:235], v[20:23], v[164:167]
    buffer_load_dwordx4 v[48:51], v4, s[28:31], s52 offen
    ds_read_b64_tr_b16 v[228:229], v9 offset:4096
    ds_read_b64_tr_b16 v[230:231], v9 offset:5120
    s_waitcnt lgkmcnt(4)
    v_mfma_f32_16x16x32_bf16 v[168:171], v[236:239], v[16:19], v[168:171]
    v_mfma_f32_16x16x32_bf16 v[172:175], v[236:239], v[20:23], v[172:175]
    ds_read_b64_tr_b16 v[232:233], v10 offset:4096
    ds_read_b64_tr_b16 v[234:235], v10 offset:5120
    s_waitcnt lgkmcnt(4)
    v_mfma_f32_16x16x32_bf16 v[176:179], v[16:19], v[224:227], v[176:179]
    v_mfma_f32_16x16x32_bf16 v[180:183], v[20:23], v[224:227], v[180:183]
    buffer_load_dwordx4 v[52:55], v5, s[28:31], s52 offen
    ds_read_b64_tr_b16 v[236:237], v11 offset:4096
    ds_read_b64_tr_b16 v[238:239], v11 offset:5120
    s_waitcnt lgkmcnt(4)
    v_mfma_f32_16x16x32_bf16 v[184:187], v[16:19], v[228:231], v[184:187]
    v_mfma_f32_16x16x32_bf16 v[188:191], v[20:23], v[228:231], v[188:191]
    ds_read_b64_tr_b16 v[224:225], v8 offset:8192
    ds_read_b64_tr_b16 v[226:227], v8 offset:9216
    s_waitcnt lgkmcnt(4)
    v_mfma_f32_16x16x32_bf16 v[192:195], v[16:19], v[232:235], v[192:195]
    v_mfma_f32_16x16x32_bf16 v[196:199], v[20:23], v[232:235], v[196:199]
    ds_read_b64_tr_b16 v[228:229], v9 offset:8192
    ds_read_b64_tr_b16 v[230:231], v9 offset:9216
    s_waitcnt lgkmcnt(4)
    v_mfma_f32_16x16x32_bf16 v[200:203], v[16:19], v[236:239], v[200:203]
    v_mfma_f32_16x16x32_bf16 v[204:207], v[20:23], v[236:239], v[204:207]
    s_waitcnt vmcnt(9)
    ds_read_b64_tr_b16 v[232:233], v10 offset:8192
    ds_read_b64_tr_b16 v[234:235], v10 offset:9216
    s_waitcnt lgkmcnt(4)
    v_mfma_f32_16x16x32_bf16 v[144:147], v[224:227], v[24:27], v[144:147]
    v_mfma_f32_16x16x32_bf16 v[148:151], v[224:227], v[28:31], v[148:151]
    s_add_u32 m0, s20, 40960
    s_nop 0
    buffer_load_dwordx4 v6, s[24:27], s19 offen lds
    s_lshl_b32 s52, s54, 10
    s_add_u32 s54, s54, 1
    s_and_b32 s54, s54, 15
    s_mul_i32 s19, s54, s18
    ds_read_b64_tr_b16 v[236:237], v11 offset:8192
    ds_read_b64_tr_b16 v[238:239], v11 offset:9216
    s_waitcnt lgkmcnt(4)
    v_mfma_f32_16x16x32_bf16 v[152:155], v[228:231], v[24:27], v[152:155]
    v_mfma_f32_16x16x32_bf16 v[156:159], v[228:231], v[28:31], v[156:159]
    ds_read_b64_tr_b16 v[224:225], v8 offset:12288
    ds_read_b64_tr_b16 v[226:227], v8 offset:13312
    s_waitcnt lgkmcnt(4)
    v_mfma_f32_16x16x32_bf16 v[160:163], v[232:235], v[24:27], v[160:163]
    v_mfma_f32_16x16x32_bf16 v[164:167], v[232:235], v[28:31], v[164:167]
    buffer_load_dwordx4 v[56:59], v4, s[28:31], s52 offen
    ds_read_b64_tr_b16 v[228:229], v9 offset:12288
    ds_read_b64_tr_b16 v[230:231], v9 offset:13312
    s_waitcnt lgkmcnt(4)
    v_mfma_f32_16x16x32_bf16 v[168:171], v[236:239], v[24:27], v[168:171]
    v_mfma_f32_16x16x32_bf16 v[172:175], v[236:239], v[28:31], v[172:175]
    ds_read_b64_tr_b16 v[232:233], v10 offset:12288
    ds_read_b64_tr_b16 v[234:235], v10 offset:13312
    s_waitcnt lgkmcnt(4)
    v_mfma_f32_16x16x32_bf16 v[176:179], v[24:27], v[224:227], v[176:179]
    v_mfma_f32_16x16x32_bf16 v[180:183], v[28:31], v[224:227], v[180:183]
    buffer_load_dwordx4 v[60:63], v5, s[28:31], s52 offen
    ds_read_b64_tr_b16 v[236:237], v11 offset:12288
    ds_read_b64_tr_b16 v[238:239], v11 offset:13312
    s_waitcnt lgkmcnt(4)
    v_mfma_f32_16x16x32_bf16 v[184:187], v[24:27], v[228:231], v[184:187]
    v_mfma_f32_16x16x32_bf16 v[188:191], v[28:31], v[228:231], v[188:191]
    ds_read_b64_tr_b16 v[224:225], v8 offset:16384
    ds_read_b64_tr_b16 v[226:227], v8 offset:17408
    s_waitcnt lgkmcnt(4)
    v_mfma_f32_16x16x32_bf16 v[192:195], v[24:27], v[232:235], v[192:195]
    v_mfma_f32_16x16x32_bf16 v[196:199], v[28:31], v[232:235], v[196:199]
    ds_read_b64_tr_b16 v[228:229], v9 offset:16384
    ds_read_b64_tr_b16 v[230:231], v9 offset:17408
    s_waitcnt lgkmcnt(4)
    v_mfma_f32_16x16x32_bf16 v[200:203], v[24:27], v[236:239], v[200:203]
    v_mfma_f32_16x16x32_bf16 v[204:207], v[28:31], v[236:239], v[204:207]
    s_waitcnt vmcnt(5)
    s_barrier
    ds_read_b64_tr_b16 v[232:233], v10 offset:16384
    ds_read_b64_tr_b16 v[234:235], v10 offset:17408
    s_waitcnt lgkmcnt(4)
    v_mfma_f32_16x16x32_bf16 v[144:147], v[224:227], v[32:35], v[144:147]
    v_mfma_f32_16x16x32_bf16 v[148:151], v[224:227], v[36:39], v[148:151]
    s_add_u32 m0, s20, 49152
    s_nop 0
    buffer_load_dwordx4 v6, s[24:27], s19 offen lds
    s_lshl_b32 s52, s54, 10
    s_add_u32 s54, s54, 1
    s_and_b32 s54, s54, 15
    s_mul_i32 s19, s54, s18
    ds_read_b64_tr_b16 v[236:237], v11 offset:16384
    ds_read_b64_tr_b16 v[238:239], v11 offset:17408
    s_waitcnt lgkmcnt(4)
    v_mfma_f32_16x16x32_bf16 v[152:155], v[228:231], v[32:35], v[152:155]
    v_mfma_f32_16x16x32_bf16 v[156:159], v[228:231], v[36:39], v[156:159]
    ds_read_b64_tr_b16 v[224:225], v8 offset:20480
    ds_read_b64_tr_b16 v[226:227], v8 offset:21504
    s_waitcnt lgkmcnt(4)
    v_mfma_f32_16x16x32_bf16 v[160:163], v[232:235], v[32:35], v[160:163]
    v_mfma_f32_16x16x32_bf16 v[164:167], v[232:235], v[36:39], v[164:167]
    buffer_load_dwordx4 v[64:67], v4, s[28:31], s52 offen
    ds_read_b64_tr_b16 v[228:229], v9 offset:20480
    ds_read_b64_tr_b16 v[230:231], v9 offset:21504
    s_waitcnt lgkmcnt(4)
    v_mfma_f32_16x16x32_bf16 v[168:171], v[236:239], v[32:35], v[168:171]
    v_mfma_f32_16x16x32_bf16 v[172:175], v[236:239], v[36:39], v[172:175]
    ds_read_b64_tr_b16 v[232:233], v10 offset:20480
    ds_read_b64_tr_b16 v[234:235], v10 offset:21504
    s_waitcnt lgkmcnt(4)
    v_mfma_f32_16x16x32_bf16 v[176:179], v[32:35], v[224:227], v[176:179]
    v_mfma_f32_16x16x32_bf16 v[180:183], v[36:39], v[224:227], v[180:183]
    buffer_load_dwordx4 v[68:71], v5, s[28:31], s52 offen
    ds_read_b64_tr_b16 v[236:237], v11 offset:20480
    ds_read_b64_tr_b16 v[238:239], v11 offset:21504
    s_waitcnt lgkmcnt(4)
    v_mfma_f32_16x16x32_bf16 v[184:187], v[32:35], v[228:231], v[184:187]
    v_mfma_f32_16x16x32_bf16 v[188:191], v[36:39], v[228:231], v[188:191]
    ds_read_b64_tr_b16 v[224:225], v8 offset:24576
    ds_read_b64_tr_b16 v[226:227], v8 offset:25600
    s_waitcnt lgkmcnt(4)
    v_mfma_f32_16x16x32_bf16 v[192:195], v[32:35], v[232:235], v[192:195]
    v_mfma_f32_16x16x32_bf16 v[196:199], v[36:39], v[232:235], v[196:199]
    ds_read_b64_tr_b16 v[228:229], v9 offset:24576
    ds_read_b64_tr_b16 v[230:231], v9 offset:25600
    s_waitcnt lgkmcnt(4)
    v_mfma_f32_16x16x32_bf16 v[200:203], v[32:35], v[236:239], v[200:203]
    v_mfma_f32_16x16x32_bf16 v[204:207], v[36:39], v[236:239], v[204:207]
    s_waitcnt vmcnt(9)
    ds_read_b64_tr_b16 v[232:233], v10 offset:24576
    ds_read_b64_tr_b16 v[234:235], v10 offset:25600
    s_waitcnt lgkmcnt(4)
    v_mfma_f32_16x16x32_bf16 v[144:147], v[224:227], v[40:43], v[144:147]
    v_mfma_f32_16x16x32_bf16 v[148:151], v[224:227], v[44:47], v[148:151]
    s_add_u32 m0, s20, 57344
    s_nop 0
    buffer_load_dwordx4 v6, s[24:27], s19 offen lds
    s_lshl_b32 s52, s54, 10
    s_add_u32 s54, s54, 1
    s_and_b32 s54, s54, 15
    s_mul_i32 s19, s54, s18
    ds_read_b64_tr_b16 v[236:237], v11 offset:24576
    ds_read_b64_tr_b16 v[238:239], v11 offset:25600
    s_waitcnt lgkmcnt(4)
    v_mfma_f32_16x16x32_bf16 v[152:155], v[228:231], v[40:43], v[152:155]
    v_mfma_f32_16x16x32_bf16 v[156:159], v[228:231], v[44:47], v[156:159]
    ds_read_b64_tr_b16 v[224:225], v8 offset:28672
    ds_read_b64_tr_b16 v[226:227], v8 offset:29696
    s_waitcnt lgkmcnt(4)
    v_mfma_f32_16x16x32_bf16 v[160:163], v[232:235], v[40:43], v[160:163]
    v_mfma_f32_16x16x32_bf16 v[164:167], v[232:235], v[44:47], v[164:167]
    buffer_load_dwordx4 v[72:75], v4, s[28:31], s52 offen
    ds_read_b64_tr_b16 v[228:229], v9 offset:28672
    ds_read_b64_tr_b16 v[230:231], v9 offset:29696
    s_waitcnt lgkmcnt(4)
    v_mfma_f32_16x16x32_bf16 v[168:171], v[236:239], v[40:43], v[168:171]
    v_mfma_f32_16x16x32_bf16 v[172:175], v[236:239], v[44:47], v[172:175]
    ds_read_b64_tr_b16 v[232:233], v10 offset:28672
    ds_read_b64_tr_b16 v[234:235], v10 offset:29696
    s_waitcnt lgkmcnt(4)
    v_mfma_f32_16x16x32_bf16 v[176:179], v[40:43], v[224:227], v[176:179]
    v_mfma_f32_16x16x32_bf16 v[180:183], v[44:47], v[224:227], v[180:183]
    buffer_load_dwordx4 v[76:79], v5, s[28:31], s52 offen
    ds_read_b64_tr_b16 v[236:237], v11 offset:28672
    ds_read_b64_tr_b16 v[238:239], v11 offset:29696
    s_waitcnt lgkmcnt(4)
    v_mfma_f32_16x16x32_bf16 v[184:187], v[40:43], v[228:231], v[184:187]
    v_mfma_f32_16x16x32_bf16 v[188:191], v[44:47], v[228:231], v[188:191]
    ds_read_b64_tr_b16 v[224:225], v8 offset:32768
    ds_read_b64_tr_b16 v[226:227], v8 offset:33792
    s_waitcnt lgkmcnt(4)
    v_mfma_f32_16x16x32_bf16 v[192:195], v[40:43], v[232:235], v[192:195]
    v_mfma_f32_16x16x32_bf16 v[196:199], v[44:47], v[232:235], v[196:199]
    ds_read_b64_tr_b16 v[228:229], v9 offset:32768
    ds_read_b64_tr_b16 v[230:231], v9 offset:33792
    s_waitcnt lgkmcnt(4)
    v_mfma_f32_16x16x32_bf16 v[200:203], v[40:43], v[236:239], v[200:203]
    v_mfma_f32_16x16x32_bf16 v[204:207], v[44:47], v[236:239], v[204:207]
    s_waitcnt vmcnt(5)
    s_barrier
    ds_read_b64_tr_b16 v[232:233], v10 offset:32768
    ds_read_b64_tr_b16 v[234:235], v10 offset:33792
    s_waitcnt lgkmcnt(4)
    v_mfma_f32_16x16x32_bf16 v[144:147], v[224:227], v[48:51], v[144:147]
    v_mfma_f32_16x16x32_bf16 v[148:151], v[224:227], v[52:55], v[148:151]
    s_add_u32 m0, s20, 65536
    s_nop 0
    buffer_load_dwordx4 v6, s[24:27], s19 offen lds
    s_lshl_b32 s52, s54, 10
    s_add_u32 s54, s54, 1
    s_and_b32 s54, s54, 15
    s_mul_i32 s19, s54, s18
    ds_read_b64_tr_b16 v[236:237], v11 offset:32768
    ds_read_b64_tr_b16 v[238:239], v11 offset:33792
    s_waitcnt lgkmcnt(4)
    v_mfma_f32_16x16x32_bf16 v[152:155], v[228:231], v[48:51], v[152:155]
    v_mfma_f32_16x16x32_bf16 v[156:159], v[228:231], v[52:55], v[156:159]
    ds_read_b64_tr_b16 v[224:225], v8 offset:36864
    ds_read_b64_tr_b16 v[226:227], v8 offset:37888
    s_waitcnt lgkmcnt(4)
    v_mfma_f32_16x16x32_bf16 v[160:163], v[232:235], v[48:51], v[160:163]
    v_mfma_f32_16x16x32_bf16 v[164:167], v[232:235], v[52:55], v[164:167]
    buffer_load_dwordx4 v[80:83], v4, s[28:31], s52 offen
    ds_read_b64_tr_b16 v[228:229], v9 offset:36864
    ds_read_b64_tr_b16 v[230:231], v9 offset:37888
    s_waitcnt lgkmcnt(4)
    v_mfma_f32_16x16x32_bf16 v[168:171], v[236:239], v[48:51], v[168:171]
    v_mfma_f32_16x16x32_bf16 v[172:175], v[236:239], v[52:55], v[172:175]
    ds_read_b64_tr_b16 v[232:233], v10 offset:36864
    ds_read_b64_tr_b16 v[234:235], v10 offset:37888
    s_waitcnt lgkmcnt(4)
    v_mfma_f32_16x16x32_bf16 v[176:179], v[48:51], v[224:227], v[176:179]
    v_mfma_f32_16x16x32_bf16 v[180:183], v[52:55], v[224:227], v[180:183]
    buffer_load_dwordx4 v[84:87], v5, s[28:31], s52 offen
    ds_read_b64_tr_b16 v[236:237], v11 offset:36864
    ds_read_b64_tr_b16 v[238:239], v11 offset:37888
    s_waitcnt lgkmcnt(4)
    v_mfma_f32_16x16x32_bf16 v[184:187], v[48:51], v[228:231], v[184:187]
    v_mfma_f32_16x16x32_bf16 v[188:191], v[52:55], v[228:231], v[188:191]
    ds_read_b64_tr_b16 v[224:225], v8 offset:40960
    ds_read_b64_tr_b16 v[226:227], v8 offset:41984
    s_waitcnt lgkmcnt(4)
    v_mfma_f32_16x16x32_bf16 v[192:195], v[48:51], v[232:235], v[192:195]
    v_mfma_f32_16x16x32_bf16 v[196:199], v[52:55], v[232:235], v[196:199]
    ds_read_b64_tr_b16 v[228:229], v9 offset:40960
    ds_read_b64_tr_b16 v[230:231], v9 offset:41984
    s_waitcnt lgkmcnt(4)
    v_mfma_f32_16x16x32_bf16 v[200:203], v[48:51], v[236:239], v[200:203]
    v_mfma_f32_16x16x32_bf16 v[204:207], v[52:55], v[236:239], v[204:207]
    s_waitcnt vmcnt(9)
    ds_read_b64_tr_b16 v[232:233], v10 offset:40960
    ds_read_b64_tr_b16 v[234:235], v10 offset:41984
    s_waitcnt lgkmcnt(4)
    v_mfma_f32_16x16x32_bf16 v[144:147], v[224:227], v[56:59], v[144:147]
    v_mfma_f32_16x16x32_bf16 v[148:151], v[224:227], v[60:63], v[148:151]
    s_add_u32 m0, s20, 73728
    s_nop 0
    buffer_load_dwordx4 v6, s[24:27], s19 offen lds
    s_lshl_b32 s52, s54, 10
    s_add_u32 s54, s54, 1
    s_and_b32 s54, s54, 15
    s_mul_i32 s19, s54, s18
    ds_read_b64_tr_b16 v[236:237], v11 offset:40960
    ds_read_b64_tr_b16 v[238:239], v11 offset:41984
    s_waitcnt lgkmcnt(4)
    v_mfma_f32_16x16x32_bf16 v[152:155], v[228:231], v[56:59], v[152:155]
    v_mfma_f32_16x16x32_bf16 v[156:159], v[228:231], v[60:63], v[156:159]
    ds_read_b64_tr_b16 v[224:225], v8 offset:45056
    ds_read_b64_tr_b16 v[226:227], v8 offset:46080
    s_waitcnt lgkmcnt(4)
    v_mfma_f32_16x16x32_bf16 v[160:163], v[232:235], v[56:59], v[160:163]
    v_mfma_f32_16x16x32_bf16 v[164:167], v[232:235], v[60:63], v[164:167]
    buffer_load_dwordx4 v[88:91], v4, s[28:31], s52 offen
    ds_read_b64_tr_b16 v[228:229], v9 offset:45056
    ds_read_b64_tr_b16 v[230:231], v9 offset:46080
    s_waitcnt lgkmcnt(4)
    v_mfma_f32_16x16x32_bf16 v[168:171], v[236:239], v[56:59], v[168:171]
    v_mfma_f32_16x16x32_bf16 v[172:175], v[236:239], v[60:63], v[172:175]
    ds_read_b64_tr_b16 v[232:233], v10 offset:45056
    ds_read_b64_tr_b16 v[234:235], v10 offset:46080
    s_waitcnt lgkmcnt(4)
    v_mfma_f32_16x16x32_bf16 v[176:179], v[56:59], v[224:227], v[176:179]
    v_mfma_f32_16x16x32_bf16 v[180:183], v[60:63], v[224:227], v[180:183]
    buffer_load_dwordx4 v[92:95], v5, s[28:31], s52 offen
    ds_read_b64_tr_b16 v[236:237], v11 offset:45056
    ds_read_b64_tr_b16 v[238:239], v11 offset:46080
    s_waitcnt lgkmcnt(4)
    v_mfma_f32_16x16x32_bf16 v[184:187], v[56:59], v[228:231], v[184:187]
    v_mfma_f32_16x16x32_bf16 v[188:191], v[60:63], v[228:231], v[188:191]
    ds_read_b64_tr_b16 v[224:225], v8 offset:49152
    ds_read_b64_tr_b16 v[226:227], v8 offset:50176
    s_waitcnt lgkmcnt(4)
    v_mfma_f32_16x16x32_bf16 v[192:195], v[56:59], v[232:235], v[192:195]
    v_mfma_f32_16x16x32_bf16 v[196:199], v[60:63], v[232:235], v[196:199]
    ds_read_b64_tr_b16 v[228:229], v9 offset:49152
    ds_read_b64_tr_b16 v[230:231], v9 offset:50176
    s_waitcnt lgkmcnt(4)
    v_mfma_f32_16x16x32_bf16 v[200:203], v[56:59], v[236:239], v[200:203]
    v_mfma_f32_16x16x32_bf16 v[204:207], v[60:63], v[236:239], v[204:207]
    s_waitcnt vmcnt(5)
    s_barrier
    ds_read_b64_tr_b16 v[232:233], v10 offset:49152
    ds_read_b64_tr_b16 v[234:235], v10 offset:50176
    s_waitcnt lgkmcnt(4)
    v_mfma_f32_16x16x32_bf16 v[144:147], v[224:227], v[64:67], v[144:147]
    v_mfma_f32_16x16x32_bf16 v[148:151], v[224:227], v[68:71], v[148:151]
    s_add_u32 m0, s20, 81920
    s_nop 0
    buffer_load_dwordx4 v6, s[24:27], s19 offen lds
    s_lshl_b32 s52, s54, 10
    s_add_u32 s54, s54, 1
    s_and_b32 s54, s54, 15
    s_mul_i32 s19, s54, s18
    ds_read_b64_tr_b16 v[236:237], v11 offset:49152
    ds_read_b64_tr_b16 v[238:239], v11 offset:50176
    s_waitcnt lgkmcnt(4)
    v_mfma_f32_16x16x32_bf16 v[152:155], v[228:231], v[64:67], v[152:155]
    v_mfma_f32_16x16x32_bf16 v[156:159], v[228:231], v[68:71], v[156:159]
    ds_read_b64_tr_b16 v[224:225], v8 offset:53248
    ds_read_b64_tr_b16 v[226:227], v8 offset:54272
    s_waitcnt lgkmcnt(4)
    v_mfma_f32_16x16x32_bf16 v[160:163], v[232:235], v[64:67], v[160:163]
    v_mfma_f32_16x16x32_bf16 v[164:167], v[232:235], v[68:71], v[164:167]
    buffer_load_dwordx4 v[96:99], v4, s[28:31], s52 offen
    ds_read_b64_tr_b16 v[228:229], v9 offset:53248
    ds_read_b64_tr_b16 v[230:231], v9 offset:54272
    s_waitcnt lgkmcnt(4)
    v_mfma_f32_16x16x32_bf16 v[168:171], v[236:239], v[64:67], v[168:171]
    v_mfma_f32_16x16x32_bf16 v[172:175], v[236:239], v[68:71], v[172:175]
    ds_read_b64_tr_b16 v[232:233], v10 offset:53248
    ds_read_b64_tr_b16 v[234:235], v10 offset:54272
    s_waitcnt lgkmcnt(4)
    v_mfma_f32_16x16x32_bf16 v[176:179], v[64:67], v[224:227], v[176:179]
    v_mfma_f32_16x16x32_bf16 v[180:183], v[68:71], v[224:227], v[180:183]
    buffer_load_dwordx4 v[100:103], v5, s[28:31], s52 offen
    ds_read_b64_tr_b16 v[236:237], v11 offset:53248
    ds_read_b64_tr_b16 v[238:239], v11 offset:54272
    s_waitcnt lgkmcnt(4)
    v_mfma_f32_16x16x32_bf16 v[184:187], v[64:67], v[228:231], v[184:187]
    v_mfma_f32_16x16x32_bf16 v[188:191], v[68:71], v[228:231], v[188:191]
    ds_read_b64_tr_b16 v[224:225], v8 offset:57344
    ds_read_b64_tr_b16 v[226:227], v8 offset:58368
    s_waitcnt lgkmcnt(4)
    v_mfma_f32_16x16x32_bf16 v[192:195], v[64:67], v[232:235], v[192:195]
    v_mfma_f32_16x16x32_bf16 v[196:199], v[68:71], v[232:235], v[196:199]
    ds_read_b64_tr_b16 v[228:229], v9 offset:57344
    ds_read_b64_tr_b16 v[230:231], v9 offset:58368
    s_waitcnt lgkmcnt(4)
    v_mfma_f32_16x16x32_bf16 v[200:203], v[64:67], v[236:239], v[200:203]
    v_mfma_f32_16x16x32_bf16 v[204:207], v[68:71], v[236:239], v[204:207]
    s_waitcnt vmcnt(9)
    ds_read_b64_tr_b16 v[232:233], v10 offset:57344
    ds_read_b64_tr_b16 v[234:235], v10 offset:58368
    s_waitcnt lgkmcnt(4)
    v_mfma_f32_16x16x32_bf16 v[144:147], v[224:227], v[72:75], v[144:147]
    v_mfma_f32_16x16x32_bf16 v[148:151], v[224:227], v[76:79], v[148:151]
    s_add_u32 m0, s20, 90112
    s_nop 0
    buffer_load_dwordx4 v6, s[24:27], s19 offen lds
    s_lshl_b32 s52, s54, 10
    s_add_u32 s54, s54, 1
    s_and_b32 s54, s54, 15
    s_mul_i32 s19, s54, s18
    ds_read_b64_tr_b16 v[236:237], v11 offset:57344
    ds_read_b64_tr_b16 v[238:239], v11 offset:58368
    s_waitcnt lgkmcnt(4)
    v_mfma_f32_16x16x32_bf16 v[152:155], v[228:231], v[72:75], v[152:155]
    v_mfma_f32_16x16x32_bf16 v[156:159], v[228:231], v[76:79], v[156:159]
    ds_read_b64_tr_b16 v[224:225], v8 offset:61440
    ds_read_b64_tr_b16 v[226:227], v8 offset:62464
    s_waitcnt lgkmcnt(4)
    v_mfma_f32_16x16x32_bf16 v[160:163], v[232:235], v[72:75], v[160:163]
    v_mfma_f32_16x16x32_bf16 v[164:167], v[232:235], v[76:79], v[164:167]
    buffer_load_dwordx4 v[104:107], v4, s[28:31], s52 offen
    ds_read_b64_tr_b16 v[228:229], v9 offset:61440
    ds_read_b64_tr_b16 v[230:231], v9 offset:62464
    s_waitcnt lgkmcnt(4)
    v_mfma_f32_16x16x32_bf16 v[168:171], v[236:239], v[72:75], v[168:171]
    v_mfma_f32_16x16x32_bf16 v[172:175], v[236:239], v[76:79], v[172:175]
    ds_read_b64_tr_b16 v[232:233], v10 offset:61440
    ds_read_b64_tr_b16 v[234:235], v10 offset:62464
    s_waitcnt lgkmcnt(4)
    v_mfma_f32_16x16x32_bf16 v[176:179], v[72:75], v[224:227], v[176:179]
    v_mfma_f32_16x16x32_bf16 v[180:183], v[76:79], v[224:227], v[180:183]
    buffer_load_dwordx4 v[108:111], v5, s[28:31], s52 offen
    ds_read_b64_tr_b16 v[236:237], v11 offset:61440
    ds_read_b64_tr_b16 v[238:239], v11 offset:62464
    s_waitcnt lgkmcnt(4)
    v_mfma_f32_16x16x32_bf16 v[184:187], v[72:75], v[228:231], v[184:187]
    v_mfma_f32_16x16x32_bf16 v[188:191], v[76:79], v[228:231], v[188:191]
    ds_read_b64_tr_b16 v[224:225], v240 offset:0
    ds_read_b64_tr_b16 v[226:227], v240 offset:1024
    s_waitcnt lgkmcnt(4)
    v_mfma_f32_16x16x32_bf16 v[192:195], v[72:75], v[232:235], v[192:195]
    v_mfma_f32_16x16x32_bf16 v[196:199], v[76:79], v[232:235], v[196:199]
    ds_read_b64_tr_b16 v[228:229], v241 offset:0
    ds_read_b64_tr_b16 v[230:231], v241 offset:1024
    s_waitcnt lgkmcnt(4)
    v_mfma_f32_16x16x32_bf16 v[200:203], v[72:75], v[236:239], v[200:203]
    v_mfma_f32_16x16x32_bf16 v[204:207], v[76:79], v[236:239], v[204:207]
    s_waitcnt vmcnt(5)
    s_barrier
    ds_read_b64_tr_b16 v[232:233], v242 offset:0
    ds_read_b64_tr_b16 v[234:235], v242 offset:1024
    s_waitcnt lgkmcnt(4)
    v_mfma_f32_16x16x32_bf16 v[144:147], v[224:227], v[80:83], v[144:147]
    v_mfma_f32_16x16x32_bf16 v[148:151], v[224:227], v[84:87], v[148:151]
    s_add_u32 m0, s20, 98304
    s_nop 0
    buffer_load_dwordx4 v6, s[24:27], s19 offen lds
    s_lshl_b32 s52, s54, 10
    s_add_u32 s54, s54, 1
    s_and_b32 s54, s54, 15
    s_mul_i32 s19, s54, s18
    ds_read_b64_tr_b16 v[236:237], v243 offset:0
    ds_read_b64_tr_b16 v[238:239], v243 offset:1024
    s_waitcnt lgkmcnt(4)
    v_mfma_f32_16x16x32_bf16 v[152:155], v[228:231], v[80:83], v[152:155]
    v_mfma_f32_16x16x32_bf16 v[156:159], v[228:231], v[84:87], v[156:159]
    ds_read_b64_tr_b16 v[224:225], v240 offset:4096
    ds_read_b64_tr_b16 v[226:227], v240 offset:5120
    s_waitcnt lgkmcnt(4)
    v_mfma_f32_16x16x32_bf16 v[160:163], v[232:235], v[80:83], v[160:163]
    v_mfma_f32_16x16x32_bf16 v[164:167], v[232:235], v[84:87], v[164:167]
    buffer_load_dwordx4 v[112:115], v4, s[28:31], s52 offen
    ds_read_b64_tr_b16 v[228:229], v241 offset:4096
    ds_read_b64_tr_b16 v[230:231], v241 offset:5120
    s_waitcnt lgkmcnt(4)
    v_mfma_f32_16x16x32_bf16 v[168:171], v[236:239], v[80:83], v[168:171]
    v_mfma_f32_16x16x32_bf16 v[172:175], v[236:239], v[84:87], v[172:175]
    ds_read_b64_tr_b16 v[232:233], v242 offset:4096
    ds_read_b64_tr_b16 v[234:235], v242 offset:5120
    s_waitcnt lgkmcnt(4)
    v_mfma_f32_16x16x32_bf16 v[176:179], v[80:83], v[224:227], v[176:179]
    v_mfma_f32_16x16x32_bf16 v[180:183], v[84:87], v[224:227], v[180:183]
    buffer_load_dwordx4 v[116:119], v5, s[28:31], s52 offen
    ds_read_b64_tr_b16 v[236:237], v243 offset:4096
    ds_read_b64_tr_b16 v[238:239], v243 offset:5120
    s_waitcnt lgkmcnt(4)
    v_mfma_f32_16x16x32_bf16 v[184:187], v[80:83], v[228:231], v[184:187]
    v_mfma_f32_16x16x32_bf16 v[188:191], v[84:87], v[228:231], v[188:191]
    ds_read_b64_tr_b16 v[224:225], v240 offset:8192
    ds_read_b64_tr_b16 v[226:227], v240 offset:9216
    s_waitcnt lgkmcnt(4)
    v_mfma_f32_16x16x32_bf16 v[192:195], v[80:83], v[232:235], v[192:195]
    v_mfma_f32_16x16x32_bf16 v[196:199], v[84:87], v[232:235], v[196:199]
    ds_read_b64_tr_b16 v[228:229], v241 offset:8192
    ds_read_b64_tr_b16 v[230:231], v241 offset:9216
    s_waitcnt lgkmcnt(4)
    v_mfma_f32_16x16x32_bf16 v[200:203], v[80:83], v[236:239], v[200:203]
    v_mfma_f32_16x16x32_bf16 v[204:207], v[84:87], v[236:239], v[204:207]
    s_waitcnt vmcnt(9)
    ds_read_b64_tr_b16 v[232:233], v242 offset:8192
    ds_read_b64_tr_b16 v[234:235], v242 offset:9216
    s_waitcnt lgkmcnt(4)
    v_mfma_f32_16x16x32_bf16 v[144:147], v[224:227], v[88:91], v[144:147]
    v_mfma_f32_16x16x32_bf16 v[148:151], v[224:227], v[92:95], v[148:151]
    s_add_u32 m0, s20, 106496
    s_nop 0
    buffer_load_dwordx4 v6, s[24:27], s19 offen lds
    s_lshl_b32 s52, s54, 10
    s_add_u32 s54, s54, 1
    s_and_b32 s54, s54, 15
    s_mul_i32 s19, s54, s18
    ds_read_b64_tr_b16 v[236:237], v243 offset:8192
    ds_read_b64_tr_b16 v[238:239], v243 offset:9216
    s_waitcnt lgkmcnt(4)
    v_mfma_f32_16x16x32_bf16 v[152:155], v[228:231], v[88:91], v[152:155]
    v_mfma_f32_16x16x32_bf16 v[156:159], v[228:231], v[92:95], v[156:159]
    ds_read_b64_tr_b16 v[224:225], v240 offset:12288
    ds_read_b64_tr_b16 v[226:227], v240 offset:13312
    s_waitcnt lgkmcnt(4)
    v_mfma_f32_16x16x32_bf16 v[160:163], v[232:235], v[88:91], v[160:163]
    v_mfma_f32_16x16x32_bf16 v[164:167], v[232:235], v[92:95], v[164:167]
    buffer_load_dwordx4 v[120:123], v4, s[28:31], s52 offen
    ds_read_b64_tr_b16 v[228:229], v241 offset:12288
    ds_read_b64_tr_b16 v[230:231], v241 offset:13312
    s_waitcnt lgkmcnt(4)
    v_mfma_f32_16x16x32_bf16 v[168:171], v[236:239], v[88:91], v[168:171]
    v_mfma_f32_16x16x32_bf16 v[172:175], v[236:239], v[92:95], v[172:175]
    ds_read_b64_tr_b16 v[232:233], v242 offset:12288
    ds_read_b64_tr_b16 v[234:235], v242 offset:13312
    s_waitcnt lgkmcnt(4)
    v_mfma_f32_16x16x32_bf16 v[176:179], v[88:91], v[224:227], v[176:179]
    v_mfma_f32_16x16x32_bf16 v[180:183], v[92:95], v[224:227], v[180:183]
    buffer_load_dwordx4 v[124:127], v5, s[28:31], s52 offen
    ds_read_b64_tr_b16 v[236:237], v243 offset:12288
    ds_read_b64_tr_b16 v[238:239], v243 offset:13312
    s_waitcnt lgkmcnt(4)
    v_mfma_f32_16x16x32_bf16 v[184:187], v[88:91], v[228:231], v[184:187]
    v_mfma_f32_16x16x32_bf16 v[188:191], v[92:95], v[228:231], v[188:191]
    ds_read_b64_tr_b16 v[224:225], v240 offset:16384
    ds_read_b64_tr_b16 v[226:227], v240 offset:17408
    s_waitcnt lgkmcnt(4)
    v_mfma_f32_16x16x32_bf16 v[192:195], v[88:91], v[232:235], v[192:195]
    v_mfma_f32_16x16x32_bf16 v[196:199], v[92:95], v[232:235], v[196:199]
    ds_read_b64_tr_b16 v[228:229], v241 offset:16384
    ds_read_b64_tr_b16 v[230:231], v241 offset:17408
    s_waitcnt lgkmcnt(4)
    v_mfma_f32_16x16x32_bf16 v[200:203], v[88:91], v[236:239], v[200:203]
    v_mfma_f32_16x16x32_bf16 v[204:207], v[92:95], v[236:239], v[204:207]
    s_waitcnt vmcnt(5)
    s_barrier
    ds_read_b64_tr_b16 v[232:233], v242 offset:16384
    ds_read_b64_tr_b16 v[234:235], v242 offset:17408
    s_waitcnt lgkmcnt(4)
    v_mfma_f32_16x16x32_bf16 v[144:147], v[224:227], v[96:99], v[144:147]
    v_mfma_f32_16x16x32_bf16 v[148:151], v[224:227], v[100:103], v[148:151]
    s_add_u32 m0, s20, 114688
    s_nop 0
    buffer_load_dwordx4 v6, s[24:27], s19 offen lds
    s_lshl_b32 s52, s54, 10
    s_add_u32 s54, s54, 1
    s_and_b32 s54, s54, 15
    s_mul_i32 s19, s54, s18
    ds_read_b64_tr_b16 v[236:237], v243 offset:16384
    ds_read_b64_tr_b16 v[238:239], v243 offset:17408
    s_waitcnt lgkmcnt(4)
    v_mfma_f32_16x16x32_bf16 v[152:155], v[228:231], v[96:99], v[152:155]
    v_mfma_f32_16x16x32_bf16 v[156:159], v[228:231], v[100:103], v[156:159]
    ds_read_b64_tr_b16 v[224:225], v240 offset:20480
    ds_read_b64_tr_b16 v[226:227], v240 offset:21504
    s_waitcnt lgkmcnt(4)
    v_mfma_f32_16x16x32_bf16 v[160:163], v[232:235], v[96:99], v[160:163]
    v_mfma_f32_16x16x32_bf16 v[164:167], v[232:235], v[100:103], v[164:167]
    buffer_load_dwordx4 v[128:131], v4, s[28:31], s52 offen
    ds_read_b64_tr_b16 v[228:229], v241 offset:20480
    ds_read_b64_tr_b16 v[230:231], v241 offset:21504
    s_waitcnt lgkmcnt(4)
    v_mfma_f32_16x16x32_bf16 v[168:171], v[236:239], v[96:99], v[168:171]
    v_mfma_f32_16x16x32_bf16 v[172:175], v[236:239], v[100:103], v[172:175]
    ds_read_b64_tr_b16 v[232:233], v242 offset:20480
    ds_read_b64_tr_b16 v[234:235], v242 offset:21504
    s_waitcnt lgkmcnt(4)
    v_mfma_f32_16x16x32_bf16 v[176:179], v[96:99], v[224:227], v[176:179]
    v_mfma_f32_16x16x32_bf16 v[180:183], v[100:103], v[224:227], v[180:183]
    buffer_load_dwordx4 v[132:135], v5, s[28:31], s52 offen
    ds_read_b64_tr_b16 v[236:237], v243 offset:20480
    ds_read_b64_tr_b16 v[238:239], v243 offset:21504
    s_waitcnt lgkmcnt(4)
    v_mfma_f32_16x16x32_bf16 v[184:187], v[96:99], v[228:231], v[184:187]
    v_mfma_f32_16x16x32_bf16 v[188:191], v[100:103], v[228:231], v[188:191]
    ds_read_b64_tr_b16 v[224:225], v240 offset:24576
    ds_read_b64_tr_b16 v[226:227], v240 offset:25600
    s_waitcnt lgkmcnt(4)
    v_mfma_f32_16x16x32_bf16 v[192:195], v[96:99], v[232:235], v[192:195]
    v_mfma_f32_16x16x32_bf16 v[196:199], v[100:103], v[232:235], v[196:199]
    ds_read_b64_tr_b16 v[228:229], v241 offset:24576
    ds_read_b64_tr_b16 v[230:231], v241 offset:25600
    s_waitcnt lgkmcnt(4)
    v_mfma_f32_16x16x32_bf16 v[200:203], v[96:99], v[236:239], v[200:203]
    v_mfma_f32_16x16x32_bf16 v[204:207], v[100:103], v[236:239], v[204:207]
    s_waitcnt vmcnt(9)
    ds_read_b64_tr_b16 v[232:233], v242 offset:24576
    ds_read_b64_tr_b16 v[234:235], v242 offset:25600
    s_waitcnt lgkmcnt(4)
    v_mfma_f32_16x16x32_bf16 v[144:147], v[224:227], v[104:107], v[144:147]
    v_mfma_f32_16x16x32_bf16 v[148:151], v[224:227], v[108:111], v[148:151]
    s_add_u32 m0, s20, 122880
    s_nop 0
    buffer_load_dwordx4 v6, s[24:27], s19 offen lds
    s_lshl_b32 s52, s54, 10
    s_add_u32 s54, s54, 1
    s_and_b32 s54, s54, 15
    s_mul_i32 s19, s54, s18
    ds_read_b64_tr_b16 v[236:237], v243 offset:24576
    ds_read_b64_tr_b16 v[238:239], v243 offset:25600
    s_waitcnt lgkmcnt(4)
    v_mfma_f32_16x16x32_bf16 v[152:155], v[228:231], v[104:107], v[152:155]
    v_mfma_f32_16x16x32_bf16 v[156:159], v[228:231], v[108:111], v[156:159]
    ds_read_b64_tr_b16 v[224:225], v240 offset:28672
    ds_read_b64_tr_b16 v[226:227], v240 offset:29696
    s_waitcnt lgkmcnt(4)
    v_mfma_f32_16x16x32_bf16 v[160:163], v[232:235], v[104:107], v[160:163]
    v_mfma_f32_16x16x32_bf16 v[164:167], v[232:235], v[108:111], v[164:167]
    buffer_load_dwordx4 v[136:139], v4, s[28:31], s52 offen
    ds_read_b64_tr_b16 v[228:229], v241 offset:28672
    ds_read_b64_tr_b16 v[230:231], v241 offset:29696
    s_waitcnt lgkmcnt(4)
    v_mfma_f32_16x16x32_bf16 v[168:171], v[236:239], v[104:107], v[168:171]
    v_mfma_f32_16x16x32_bf16 v[172:175], v[236:239], v[108:111], v[172:175]
    ds_read_b64_tr_b16 v[232:233], v242 offset:28672
    ds_read_b64_tr_b16 v[234:235], v242 offset:29696
    s_waitcnt lgkmcnt(4)
    v_mfma_f32_16x16x32_bf16 v[176:179], v[104:107], v[224:227], v[176:179]
    v_mfma_f32_16x16x32_bf16 v[180:183], v[108:111], v[224:227], v[180:183]
    buffer_load_dwordx4 v[140:143], v5, s[28:31], s52 offen
    ds_read_b64_tr_b16 v[236:237], v243 offset:28672
    ds_read_b64_tr_b16 v[238:239], v243 offset:29696
    s_waitcnt lgkmcnt(4)
    v_mfma_f32_16x16x32_bf16 v[184:187], v[104:107], v[228:231], v[184:187]
    v_mfma_f32_16x16x32_bf16 v[188:191], v[108:111], v[228:231], v[188:191]
    ds_read_b64_tr_b16 v[224:225], v240 offset:32768
    ds_read_b64_tr_b16 v[226:227], v240 offset:33792
    s_waitcnt lgkmcnt(4)
    v_mfma_f32_16x16x32_bf16 v[192:195], v[104:107], v[232:235], v[192:195]
    v_mfma_f32_16x16x32_bf16 v[196:199], v[108:111], v[232:235], v[196:199]
    ds_read_b64_tr_b16 v[228:229], v241 offset:32768
    ds_read_b64_tr_b16 v[230:231], v241 offset:33792
    s_waitcnt lgkmcnt(4)
    v_mfma_f32_16x16x32_bf16 v[200:203], v[104:107], v[236:239], v[200:203]
    v_mfma_f32_16x16x32_bf16 v[204:207], v[108:111], v[236:239], v[204:207]
    s_waitcnt vmcnt(5)
    s_barrier
    ds_read_b64_tr_b16 v[232:233], v242 offset:32768
    ds_read_b64_tr_b16 v[234:235], v242 offset:33792
    s_waitcnt lgkmcnt(4)
    v_mfma_f32_16x16x32_bf16 v[144:147], v[224:227], v[112:115], v[144:147]
    v_mfma_f32_16x16x32_bf16 v[148:151], v[224:227], v[116:119], v[148:151]
    ds_read_b64_tr_b16 v[236:237], v243 offset:32768
    ds_read_b64_tr_b16 v[238:239], v243 offset:33792
    s_waitcnt lgkmcnt(4)
    v_mfma_f32_16x16x32_bf16 v[152:155], v[228:231], v[112:115], v[152:155]
    v_mfma_f32_16x16x32_bf16 v[156:159], v[228:231], v[116:119], v[156:159]
    ds_read_b64_tr_b16 v[224:225], v240 offset:36864
    ds_read_b64_tr_b16 v[226:227], v240 offset:37888
    s_waitcnt lgkmcnt(4)
    v_mfma_f32_16x16x32_bf16 v[160:163], v[232:235], v[112:115], v[160:163]
    v_mfma_f32_16x16x32_bf16 v[164:167], v[232:235], v[116:119], v[164:167]
    ds_read_b64_tr_b16 v[228:229], v241 offset:36864
    ds_read_b64_tr_b16 v[230:231], v241 offset:37888
    s_waitcnt lgkmcnt(4)
    v_mfma_f32_16x16x32_bf16 v[168:171], v[236:239], v[112:115], v[168:171]
    v_mfma_f32_16x16x32_bf16 v[172:175], v[236:239], v[116:119], v[172:175]
    ds_read_b64_tr_b16 v[232:233], v242 offset:36864
    ds_read_b64_tr_b16 v[234:235], v242 offset:37888
    s_waitcnt lgkmcnt(4)
    v_mfma_f32_16x16x32_bf16 v[176:179], v[112:115], v[224:227], v[176:179]
    v_mfma_f32_16x16x32_bf16 v[180:183], v[116:119], v[224:227], v[180:183]
    ds_read_b64_tr_b16 v[236:237], v243 offset:36864
    ds_read_b64_tr_b16 v[238:239], v243 offset:37888
    s_waitcnt lgkmcnt(4)
    v_mfma_f32_16x16x32_bf16 v[184:187], v[112:115], v[228:231], v[184:187]
    v_mfma_f32_16x16x32_bf16 v[188:191], v[116:119], v[228:231], v[188:191]
    ds_read_b64_tr_b16 v[224:225], v240 offset:40960
    ds_read_b64_tr_b16 v[226:227], v240 offset:41984
    s_waitcnt lgkmcnt(4)
    v_mfma_f32_16x16x32_bf16 v[192:195], v[112:115], v[232:235], v[192:195]
    v_mfma_f32_16x16x32_bf16 v[196:199], v[116:119], v[232:235], v[196:199]
    ds_read_b64_tr_b16 v[228:229], v241 offset:40960
    ds_read_b64_tr_b16 v[230:231], v241 offset:41984
    s_waitcnt lgkmcnt(4)
    v_mfma_f32_16x16x32_bf16 v[200:203], v[112:115], v[236:239], v[200:203]
    v_mfma_f32_16x16x32_bf16 v[204:207], v[116:119], v[236:239], v[204:207]
    s_waitcnt vmcnt(6)
    ds_read_b64_tr_b16 v[232:233], v242 offset:40960
    ds_read_b64_tr_b16 v[234:235], v242 offset:41984
    s_waitcnt lgkmcnt(4)
    v_mfma_f32_16x16x32_bf16 v[144:147], v[224:227], v[120:123], v[144:147]
    v_mfma_f32_16x16x32_bf16 v[148:151], v[224:227], v[124:127], v[148:151]
    ds_read_b64_tr_b16 v[236:237], v243 offset:40960
    ds_read_b64_tr_b16 v[238:239], v243 offset:41984
    s_waitcnt lgkmcnt(4)
    v_mfma_f32_16x16x32_bf16 v[152:155], v[228:231], v[120:123], v[152:155]
    v_mfma_f32_16x16x32_bf16 v[156:159], v[228:231], v[124:127], v[156:159]
    ds_read_b64_tr_b16 v[224:225], v240 offset:45056
    ds_read_b64_tr_b16 v[226:227], v240 offset:46080
    s_waitcnt lgkmcnt(4)
    v_mfma_f32_16x16x32_bf16 v[160:163], v[232:235], v[120:123], v[160:163]
    v_mfma_f32_16x16x32_bf16 v[164:167], v[232:235], v[124:127], v[164:167]
    ds_read_b64_tr_b16 v[228:229], v241 offset:45056
    ds_read_b64_tr_b16 v[230:231], v241 offset:46080
    s_waitcnt lgkmcnt(4)
    v_mfma_f32_16x16x32_bf16 v[168:171], v[236:239], v[120:123], v[168:171]
    v_mfma_f32_16x16x32_bf16 v[172:175], v[236:239], v[124:127], v[172:175]
    ds_read_b64_tr_b16 v[232:233], v242 offset:45056
    ds_read_b64_tr_b16 v[234:235], v242 offset:46080
    s_waitcnt lgkmcnt(4)
    v_mfma_f32_16x16x32_bf16 v[176:179], v[120:123], v[224:227], v[176:179]
    v_mfma_f32_16x16x32_bf16 v[180:183], v[124:127], v[224:227], v[180:183]
    ds_read_b64_tr_b16 v[236:237], v243 offset:45056
    ds_read_b64_tr_b16 v[238:239], v243 offset:46080
    s_waitcnt lgkmcnt(4)
    v_mfma_f32_16x16x32_bf16 v[184:187], v[120:123], v[228:231], v[184:187]
    v_mfma_f32_16x16x32_bf16 v[188:191], v[124:127], v[228:231], v[188:191]
    ds_read_b64_tr_b16 v[224:225], v240 offset:49152
    ds_read_b64_tr_b16 v[226:227], v240 offset:50176
    s_waitcnt lgkmcnt(4)
    v_mfma_f32_16x16x32_bf16 v[192:195], v[120:123], v[232:235], v[192:195]
    v_mfma_f32_16x16x32_bf16 v[196:199], v[124:127], v[232:235], v[196:199]
    ds_read_b64_tr_b16 v[228:229], v241 offset:49152
    ds_read_b64_tr_b16 v[230:231], v241 offset:50176
    s_waitcnt lgkmcnt(4)
    v_mfma_f32_16x16x32_bf16 v[200:203], v[120:123], v[236:239], v[200:203]
    v_mfma_f32_16x16x32_bf16 v[204:207], v[124:127], v[236:239], v[204:207]
    s_waitcnt vmcnt(2)
    s_barrier
    ds_read_b64_tr_b16 v[232:233], v242 offset:49152
    ds_read_b64_tr_b16 v[234:235], v242 offset:50176
    s_waitcnt lgkmcnt(4)
    v_mfma_f32_16x16x32_bf16 v[144:147], v[224:227], v[128:131], v[144:147]
    v_mfma_f32_16x16x32_bf16 v[148:151], v[224:227], v[132:135], v[148:151]
    ds_read_b64_tr_b16 v[236:237], v243 offset:49152
    ds_read_b64_tr_b16 v[238:239], v243 offset:50176
    s_waitcnt lgkmcnt(4)
    v_mfma_f32_16x16x32_bf16 v[152:155], v[228:231], v[128:131], v[152:155]
    v_mfma_f32_16x16x32_bf16 v[156:159], v[228:231], v[132:135], v[156:159]
    ds_read_b64_tr_b16 v[224:225], v240 offset:53248
    ds_read_b64_tr_b16 v[226:227], v240 offset:54272
    s_waitcnt lgkmcnt(4)
    v_mfma_f32_16x16x32_bf16 v[160:163], v[232:235], v[128:131], v[160:163]
    v_mfma_f32_16x16x32_bf16 v[164:167], v[232:235], v[132:135], v[164:167]
    ds_read_b64_tr_b16 v[228:229], v241 offset:53248
    ds_read_b64_tr_b16 v[230:231], v241 offset:54272
    s_waitcnt lgkmcnt(4)
    v_mfma_f32_16x16x32_bf16 v[168:171], v[236:239], v[128:131], v[168:171]
    v_mfma_f32_16x16x32_bf16 v[172:175], v[236:239], v[132:135], v[172:175]
    ds_read_b64_tr_b16 v[232:233], v242 offset:53248
    ds_read_b64_tr_b16 v[234:235], v242 offset:54272
    s_waitcnt lgkmcnt(4)
    v_mfma_f32_16x16x32_bf16 v[176:179], v[128:131], v[224:227], v[176:179]
    v_mfma_f32_16x16x32_bf16 v[180:183], v[132:135], v[224:227], v[180:183]
    ds_read_b64_tr_b16 v[236:237], v243 offset:53248
    ds_read_b64_tr_b16 v[238:239], v243 offset:54272
    s_waitcnt lgkmcnt(4)
    v_mfma_f32_16x16x32_bf16 v[184:187], v[128:131], v[228:231], v[184:187]
    v_mfma_f32_16x16x32_bf16 v[188:191], v[132:135], v[228:231], v[188:191]
    ds_read_b64_tr_b16 v[224:225], v240 offset:57344
    ds_read_b64_tr_b16 v[226:227], v240 offset:58368
    s_waitcnt lgkmcnt(4)
    v_mfma_f32_16x16x32_bf16 v[192:195], v[128:131], v[232:235], v[192:195]
    v_mfma_f32_16x16x32_bf16 v[196:199], v[132:135], v[232:235], v[196:199]
    ds_read_b64_tr_b16 v[228:229], v241 offset:57344
    ds_read_b64_tr_b16 v[230:231], v241 offset:58368
    s_waitcnt lgkmcnt(4)
    v_mfma_f32_16x16x32_bf16 v[200:203], v[128:131], v[236:239], v[200:203]
    v_mfma_f32_16x16x32_bf16 v[204:207], v[132:135], v[236:239], v[204:207]
    s_waitcnt vmcnt(0)
    ds_read_b64_tr_b16 v[232:233], v242 offset:57344
    ds_read_b64_tr_b16 v[234:235], v242 offset:58368
    s_waitcnt lgkmcnt(4)
    v_mfma_f32_16x16x32_bf16 v[144:147], v[224:227], v[136:139], v[144:147]
    v_mfma_f32_16x16x32_bf16 v[148:151], v[224:227], v[140:143], v[148:151]
    ds_read_b64_tr_b16 v[236:237], v243 offset:57344
    ds_read_b64_tr_b16 v[238:239], v243 offset:58368
    s_waitcnt lgkmcnt(4)
    v_mfma_f32_16x16x32_bf16 v[152:155], v[228:231], v[136:139], v[152:155]
    v_mfma_f32_16x16x32_bf16 v[156:159], v[228:231], v[140:143], v[156:159]
    ds_read_b64_tr_b16 v[224:225], v240 offset:61440
    ds_read_b64_tr_b16 v[226:227], v240 offset:62464
    s_waitcnt lgkmcnt(4)
    v_mfma_f32_16x16x32_bf16 v[160:163], v[232:235], v[136:139], v[160:163]
    v_mfma_f32_16x16x32_bf16 v[164:167], v[232:235], v[140:143], v[164:167]
    ds_read_b64_tr_b16 v[228:229], v241 offset:61440
    ds_read_b64_tr_b16 v[230:231], v241 offset:62464
    s_waitcnt lgkmcnt(4)
    v_mfma_f32_16x16x32_bf16 v[168:171], v[236:239], v[136:139], v[168:171]
    v_mfma_f32_16x16x32_bf16 v[172:175], v[236:239], v[140:143], v[172:175]
    ds_read_b64_tr_b16 v[232:233], v242 offset:61440
    ds_read_b64_tr_b16 v[234:235], v242 offset:62464
    s_waitcnt lgkmcnt(4)
    v_mfma_f32_16x16x32_bf16 v[176:179], v[136:139], v[224:227], v[176:179]
    v_mfma_f32_16x16x32_bf16 v[180:183], v[140:143], v[224:227], v[180:183]
    ds_read_b64_tr_b16 v[236:237], v243 offset:61440
    ds_read_b64_tr_b16 v[238:239], v243 offset:62464
    s_waitcnt lgkmcnt(4)
    v_mfma_f32_16x16x32_bf16 v[184:187], v[136:139], v[228:231], v[184:187]
    v_mfma_f32_16x16x32_bf16 v[188:191], v[140:143], v[228:231], v[188:191]
    s_waitcnt lgkmcnt(2)
    v_mfma_f32_16x16x32_bf16 v[192:195], v[136:139], v[232:235], v[192:195]
    v_mfma_f32_16x16x32_bf16 v[196:199], v[140:143], v[232:235], v[196:199]
    s_waitcnt lgkmcnt(0)
    v_mfma_f32_16x16x32_bf16 v[200:203], v[136:139], v[236:239], v[200:203]
    v_mfma_f32_16x16x32_bf16 v[204:207], v[140:143], v[236:239], v[204:207]
    s_waitcnt vmcnt(0)
    s_lshl_b32 s3, s16, 14
    v_lshlrev_b32 v12, 4, v1
    v_add_u32 v12, s3, v12
    s_barrier
    v_lshrrev_b32 v16, 2, v2
    v_lshl_add_u32 v16, v3, 2, v16
    v_lshlrev_b32 v16, 5, v16
    v_and_b32 v17, 3, v1
    v_lshl_add_u32 v16, v17, 3, v16
    v_add_u32 v16, 131072, v16
    ds_read_b64_tr_b16 v[240:241], v16 offset:0
    ds_read_b64_tr_b16 v[242:243], v16 offset:512
    ds_read_b64_tr_b16 v[244:245], v16 offset:1024
    ds_read_b64_tr_b16 v[246:247], v16 offset:1536
    s_waitcnt lgkmcnt(0)
    s_mov_b32 s53, 0x3fb8aa3b
    v_mov_b32 v108, 0x3f803f80
    v_mov_b32 v109, 0x3f803f80
    v_mov_b32 v110, 0x3f803f80
    v_mov_b32 v111, 0x3f803f80
    v_lshlrev_b32 v114, 2, v3
    v_sub_u32 v114, v2, v114
    v_mov_b32 v112, 0
    v_mov_b32 v115, 0x3f80
    v_cmp_eq_u32 vcc, 0, v114
    s_nop 1
    v_cndmask_b32 v112, v112, v115, vcc
    v_mov_b32 v115, 0x3f800000
    v_cmp_eq_u32 vcc, 1, v114
    s_nop 1
    v_cndmask_b32 v112, v112, v115, vcc
    v_mov_b32 v113, 0
    v_mov_b32 v115, 0x3f80
    v_cmp_eq_u32 vcc, 2, v114
    s_nop 1
    v_cndmask_b32 v113, v113, v115, vcc
    v_mov_b32 v115, 0x3f800000
    v_cmp_eq_u32 vcc, 3, v114
    s_nop 1
    v_cndmask_b32 v113, v113, v115, vcc
    v_cvt_pk_bf16_f32 v48, v144, v145
    v_cvt_pk_bf16_f32 v49, v146, v147
    v_cvt_pk_bf16_f32 v50, v148, v149
    v_cvt_pk_bf16_f32 v51, v150, v151
    v_mfma_f32_16x16x16_bf16 v[52:55], v[240:241], v[48:49], 0
    s_nop 0
    v_mfma_f32_16x16x16_bf16 v[68:71], v[240:241], v[50:51], 0
    s_nop 5
    v_cvt_pk_bf16_f32 v48, v52, v53
    v_cvt_pk_bf16_f32 v49, v54, v55
    v_cvt_pk_bf16_f32 v50, v68, v69
    v_cvt_pk_bf16_f32 v51, v70, v71
    v_lshlrev_b32 v52, 16, v48
    v_and_b32 v53, 0xffff0000, v48
    v_lshlrev_b32 v54, 16, v49
    v_and_b32 v55, 0xffff0000, v49
    v_lshlrev_b32 v68, 16, v50
    v_and_b32 v69, 0xffff0000, v50
    v_lshlrev_b32 v70, 16, v51
    v_and_b32 v71, 0xffff0000, v51
    v_max3_f32 v56, v52, v53, v54
    v_min3_f32 v57, v52, v53, v54
    v_max3_f32 v72, v68, v69, v70
    v_min3_f32 v73, v68, v69, v70
    v_max_f32 v56, v56, v55
    v_max_f32 v57, -v57, -v55
    v_max_f32 v72, v72, v71
    v_max_f32 v73, -v73, -v71
    v_permlane32_swap_b32 v56, v57
    s_nop 0
    v_permlane32_swap_b32 v72, v73
    v_max_f32 v56, v56, v57
    v_max_f32 v72, v72, v73
    v_mov_b32 v58, v56
    v_mov_b32 v74, v72
    s_nop 0
    v_permlane16_swap_b32 v56, v58
    v_permlane16_swap_b32 v72, v74
    v_max_f32 v56, v56, v58
    v_max_f32 v72, v72, v74
    v_mov_b32 v57, v56
    v_mov_b32 v73, v72
    s_nop 0
    v_permlane32_swap_b32 v56, v57
    v_permlane32_swap_b32 v72, v73
    v_mul_f32 v56, s53, v56
    v_mul_f32 v57, s53, v57
    v_mul_f32 v72, s53, v72
    v_mul_f32 v73, s53, v73
    v_fma_f32 v60, v52, s53, -v56
    v_fma_f32 v64, -v52, s53, -v57
    v_fma_f32 v61, v53, s53, -v56
    v_fma_f32 v65, -v53, s53, -v57
    v_fma_f32 v62, v54, s53, -v56
    v_fma_f32 v66, -v54, s53, -v57
    v_fma_f32 v63, v55, s53, -v56
    v_fma_f32 v67, -v55, s53, -v57
    v_fma_f32 v76, v68, s53, -v72
    v_fma_f32 v80, -v68, s53, -v73
    v_fma_f32 v77, v69, s53, -v72
    v_fma_f32 v81, -v69, s53, -v73
    v_fma_f32 v78, v70, s53, -v72
    v_fma_f32 v82, -v70, s53, -v73
    v_fma_f32 v79, v71, s53, -v72
    v_fma_f32 v83, -v71, s53, -v73
    v_exp_f32 v60, v60
    v_exp_f32 v61, v61
    v_exp_f32 v62, v62
    v_exp_f32 v63, v63
    v_exp_f32 v64, v64
    v_exp_f32 v65, v65
    v_exp_f32 v66, v66
    v_exp_f32 v67, v67
    v_exp_f32 v76, v76
    v_exp_f32 v77, v77
    v_exp_f32 v78, v78
    v_exp_f32 v79, v79
    v_exp_f32 v80, v80
    v_exp_f32 v81, v81
    v_exp_f32 v82, v82
    v_exp_f32 v83, v83
    v_add_f32 v56, v60, v61
    v_add_f32 v57, v64, v65
    v_add_f32 v58, v62, v63
    v_add_f32 v59, v66, v67
    v_add_f32 v72, v76, v77
    v_add_f32 v73, v80, v81
    v_add_f32 v74, v78, v79
    v_add_f32 v75, v82, v83
    v_add_f32 v56, v56, v58
    v_add_f32 v57, v57, v59
    v_add_f32 v72, v72, v74
    v_add_f32 v73, v73, v75
    v_permlane32_swap_b32 v56, v57
    s_nop 0
    v_permlane32_swap_b32 v72, v73
    v_add_f32 v56, v56, v57
    v_add_f32 v72, v72, v73
    v_mov_b32 v58, v56
    v_mov_b32 v74, v72
    s_nop 0
    v_permlane16_swap_b32 v56, v58
    v_permlane16_swap_b32 v72, v74
    v_add_f32 v56, v56, v58
    v_add_f32 v72, v72, v74
    v_mov_b32 v57, v56
    v_mov_b32 v73, v72
    s_nop 0
    v_permlane32_swap_b32 v56, v57
    v_permlane32_swap_b32 v72, v73
    v_rcp_f32 v56, v56
    v_rcp_f32 v57, v57
    v_rcp_f32 v72, v72
    v_rcp_f32 v73, v73
    v_mul_f32 v60, v60, v56
    v_mul_f32 v64, v64, v57
    v_mul_f32 v61, v61, v56
    v_mul_f32 v65, v65, v57
    v_mul_f32 v62, v62, v56
    v_mul_f32 v66, v66, v57
    v_mul_f32 v63, v63, v56
    v_mul_f32 v67, v67, v57
    v_mul_f32 v76, v76, v72
    v_mul_f32 v80, v80, v73
    v_mul_f32 v77, v77, v72
    v_mul_f32 v81, v81, v73
    v_mul_f32 v78, v78, v72
    v_mul_f32 v82, v82, v73
    v_mul_f32 v79, v79, v72
    v_mul_f32 v83, v83, v73
    v_cvt_pk_bf16_f32 v88, v60, v61
    v_cvt_pk_bf16_f32 v89, v62, v63
    v_cvt_pk_bf16_f32 v92, v64, v65
    v_cvt_pk_bf16_f32 v93, v66, v67
    v_cvt_pk_bf16_f32 v90, v76, v77
    v_cvt_pk_bf16_f32 v91, v78, v79
    v_cvt_pk_bf16_f32 v94, v80, v81
    v_cvt_pk_bf16_f32 v95, v82, v83
    v_mfma_f32_16x16x16_bf16 v[52:55], v[88:89], v[112:113], 0
    v_mfma_f32_16x16x16_bf16 v[56:59], v[92:93], v[112:113], 0
    v_mfma_f32_16x16x16_bf16 v[60:63], v[90:91], v[112:113], 0
    v_mfma_f32_16x16x16_bf16 v[64:67], v[94:95], v[112:113], 0
    v_cvt_pk_bf16_f32 v104, v176, v177
    v_cvt_pk_bf16_f32 v105, v178, v179
    v_cvt_pk_bf16_f32 v106, v180, v181
    v_cvt_pk_bf16_f32 v107, v182, v183
    s_nop 0
    v_cvt_pk_bf16_f32 v96, v52, v53
    v_cvt_pk_bf16_f32 v97, v54, v55
    v_cvt_pk_bf16_f32 v100, v56, v57
    v_cvt_pk_bf16_f32 v101, v58, v59
    v_cvt_pk_bf16_f32 v98, v60, v61
    v_cvt_pk_bf16_f32 v99, v62, v63
    v_cvt_pk_bf16_f32 v102, v64, v65
    v_cvt_pk_bf16_f32 v103, v66, v67
    v_mfma_f32_16x16x32_bf16 v[48:51], v[96:99], v[104:107], 0
    s_nop 0
    v_mfma_f32_16x16x32_bf16 v[52:55], v[100:103], v[104:107], 0
    v_mfma_f32_16x16x32_bf16 v[56:59], v[96:99], v[108:111], 0
    v_mfma_f32_16x16x32_bf16 v[60:63], v[100:103], v[108:111], 0
    s_nop 3
    ds_write_b128 v12, v[48:51] offset:0
    s_nop 0
    ds_write_b128 v12, v[52:55] offset:1024
    ds_write_b128 v12, v[56:59] offset:2048
    ds_write_b128 v12, v[60:63] offset:3072
    v_cvt_pk_bf16_f32 v48, v152, v153
    v_cvt_pk_bf16_f32 v49, v154, v155
    v_cvt_pk_bf16_f32 v50, v156, v157
    v_cvt_pk_bf16_f32 v51, v158, v159
    v_mfma_f32_16x16x16_bf16 v[52:55], v[242:243], v[48:49], 0
    s_nop 0
    v_mfma_f32_16x16x16_bf16 v[68:71], v[242:243], v[50:51], 0
    s_nop 5
    v_cvt_pk_bf16_f32 v48, v52, v53
    v_cvt_pk_bf16_f32 v49, v54, v55
    v_cvt_pk_bf16_f32 v50, v68, v69
    v_cvt_pk_bf16_f32 v51, v70, v71
    v_lshlrev_b32 v52, 16, v48
    v_and_b32 v53, 0xffff0000, v48
    v_lshlrev_b32 v54, 16, v49
    v_and_b32 v55, 0xffff0000, v49
    v_lshlrev_b32 v68, 16, v50
    v_and_b32 v69, 0xffff0000, v50
    v_lshlrev_b32 v70, 16, v51
    v_and_b32 v71, 0xffff0000, v51
    v_max3_f32 v56, v52, v53, v54
    v_min3_f32 v57, v52, v53, v54
    v_max3_f32 v72, v68, v69, v70
    v_min3_f32 v73, v68, v69, v70
    v_max_f32 v56, v56, v55
    v_max_f32 v57, -v57, -v55
    v_max_f32 v72, v72, v71
    v_max_f32 v73, -v73, -v71
    v_permlane32_swap_b32 v56, v57
    s_nop 0
    v_permlane32_swap_b32 v72, v73
    v_max_f32 v56, v56, v57
    v_max_f32 v72, v72, v73
    v_mov_b32 v58, v56
    v_mov_b32 v74, v72
    s_nop 0
    v_permlane16_swap_b32 v56, v58
    v_permlane16_swap_b32 v72, v74
    v_max_f32 v56, v56, v58
    v_max_f32 v72, v72, v74
    v_mov_b32 v57, v56
    v_mov_b32 v73, v72
    s_nop 0
    v_permlane32_swap_b32 v56, v57
    v_permlane32_swap_b32 v72, v73
    v_mul_f32 v56, s53, v56
    v_mul_f32 v57, s53, v57
    v_mul_f32 v72, s53, v72
    v_mul_f32 v73, s53, v73
    v_fma_f32 v60, v52, s53, -v56
    v_fma_f32 v64, -v52, s53, -v57
    v_fma_f32 v61, v53, s53, -v56
    v_fma_f32 v65, -v53, s53, -v57
    v_fma_f32 v62, v54, s53, -v56
    v_fma_f32 v66, -v54, s53, -v57
    v_fma_f32 v63, v55, s53, -v56
    v_fma_f32 v67, -v55, s53, -v57
    v_fma_f32 v76, v68, s53, -v72
    v_fma_f32 v80, -v68, s53, -v73
    v_fma_f32 v77, v69, s53, -v72
    v_fma_f32 v81, -v69, s53, -v73
    v_fma_f32 v78, v70, s53, -v72
    v_fma_f32 v82, -v70, s53, -v73
    v_fma_f32 v79, v71, s53, -v72
    v_fma_f32 v83, -v71, s53, -v73
    v_exp_f32 v60, v60
    v_exp_f32 v61, v61
    v_exp_f32 v62, v62
    v_exp_f32 v63, v63
    v_exp_f32 v64, v64
    v_exp_f32 v65, v65
    v_exp_f32 v66, v66
    v_exp_f32 v67, v67
    v_exp_f32 v76, v76
    v_exp_f32 v77, v77
    v_exp_f32 v78, v78
    v_exp_f32 v79, v79
    v_exp_f32 v80, v80
    v_exp_f32 v81, v81
    v_exp_f32 v82, v82
    v_exp_f32 v83, v83
    v_add_f32 v56, v60, v61
    v_add_f32 v57, v64, v65
    v_add_f32 v58, v62, v63
    v_add_f32 v59, v66, v67
    v_add_f32 v72, v76, v77
    v_add_f32 v73, v80, v81
    v_add_f32 v74, v78, v79
    v_add_f32 v75, v82, v83
    v_add_f32 v56, v56, v58
    v_add_f32 v57, v57, v59
    v_add_f32 v72, v72, v74
    v_add_f32 v73, v73, v75
    v_permlane32_swap_b32 v56, v57
    s_nop 0
    v_permlane32_swap_b32 v72, v73
    v_add_f32 v56, v56, v57
    v_add_f32 v72, v72, v73
    v_mov_b32 v58, v56
    v_mov_b32 v74, v72
    s_nop 0
    v_permlane16_swap_b32 v56, v58
    v_permlane16_swap_b32 v72, v74
    v_add_f32 v56, v56, v58
    v_add_f32 v72, v72, v74
    v_mov_b32 v57, v56
    v_mov_b32 v73, v72
    s_nop 0
    v_permlane32_swap_b32 v56, v57
    v_permlane32_swap_b32 v72, v73
    v_rcp_f32 v56, v56
    v_rcp_f32 v57, v57
    v_rcp_f32 v72, v72
    v_rcp_f32 v73, v73
    v_mul_f32 v60, v60, v56
    v_mul_f32 v64, v64, v57
    v_mul_f32 v61, v61, v56
    v_mul_f32 v65, v65, v57
    v_mul_f32 v62, v62, v56
    v_mul_f32 v66, v66, v57
    v_mul_f32 v63, v63, v56
    v_mul_f32 v67, v67, v57
    v_mul_f32 v76, v76, v72
    v_mul_f32 v80, v80, v73
    v_mul_f32 v77, v77, v72
    v_mul_f32 v81, v81, v73
    v_mul_f32 v78, v78, v72
    v_mul_f32 v82, v82, v73
    v_mul_f32 v79, v79, v72
    v_mul_f32 v83, v83, v73
    v_cvt_pk_bf16_f32 v88, v60, v61
    v_cvt_pk_bf16_f32 v89, v62, v63
    v_cvt_pk_bf16_f32 v92, v64, v65
    v_cvt_pk_bf16_f32 v93, v66, v67
    v_cvt_pk_bf16_f32 v90, v76, v77
    v_cvt_pk_bf16_f32 v91, v78, v79
    v_cvt_pk_bf16_f32 v94, v80, v81
    v_cvt_pk_bf16_f32 v95, v82, v83
    v_mfma_f32_16x16x16_bf16 v[52:55], v[88:89], v[112:113], 0
    v_mfma_f32_16x16x16_bf16 v[56:59], v[92:93], v[112:113], 0
    v_mfma_f32_16x16x16_bf16 v[60:63], v[90:91], v[112:113], 0
    v_mfma_f32_16x16x16_bf16 v[64:67], v[94:95], v[112:113], 0
    v_cvt_pk_bf16_f32 v104, v184, v185
    v_cvt_pk_bf16_f32 v105, v186, v187
    v_cvt_pk_bf16_f32 v106, v188, v189
    v_cvt_pk_bf16_f32 v107, v190, v191
    s_nop 0
    v_cvt_pk_bf16_f32 v96, v52, v53
    v_cvt_pk_bf16_f32 v97, v54, v55
    v_cvt_pk_bf16_f32 v100, v56, v57
    v_cvt_pk_bf16_f32 v101, v58, v59
    v_cvt_pk_bf16_f32 v98, v60, v61
    v_cvt_pk_bf16_f32 v99, v62, v63
    v_cvt_pk_bf16_f32 v102, v64, v65
    v_cvt_pk_bf16_f32 v103, v66, v67
    v_mfma_f32_16x16x32_bf16 v[48:51], v[96:99], v[104:107], 0
    s_nop 0
    v_mfma_f32_16x16x32_bf16 v[52:55], v[100:103], v[104:107], 0
    v_mfma_f32_16x16x32_bf16 v[56:59], v[96:99], v[108:111], 0
    v_mfma_f32_16x16x32_bf16 v[60:63], v[100:103], v[108:111], 0
    s_nop 3
    ds_write_b128 v12, v[48:51] offset:4096
    s_nop 0
    ds_write_b128 v12, v[52:55] offset:5120
    ds_write_b128 v12, v[56:59] offset:6144
    ds_write_b128 v12, v[60:63] offset:7168
    v_cvt_pk_bf16_f32 v48, v160, v161
    v_cvt_pk_bf16_f32 v49, v162, v163
    v_cvt_pk_bf16_f32 v50, v164, v165
    v_cvt_pk_bf16_f32 v51, v166, v167
    v_mfma_f32_16x16x16_bf16 v[52:55], v[244:245], v[48:49], 0
    s_nop 0
    v_mfma_f32_16x16x16_bf16 v[68:71], v[244:245], v[50:51], 0
    s_nop 5
    v_cvt_pk_bf16_f32 v48, v52, v53
    v_cvt_pk_bf16_f32 v49, v54, v55
    v_cvt_pk_bf16_f32 v50, v68, v69
    v_cvt_pk_bf16_f32 v51, v70, v71
    v_lshlrev_b32 v52, 16, v48
    v_and_b32 v53, 0xffff0000, v48
    v_lshlrev_b32 v54, 16, v49
    v_and_b32 v55, 0xffff0000, v49
    v_lshlrev_b32 v68, 16, v50
    v_and_b32 v69, 0xffff0000, v50
    v_lshlrev_b32 v70, 16, v51
    v_and_b32 v71, 0xffff0000, v51
    v_max3_f32 v56, v52, v53, v54
    v_min3_f32 v57, v52, v53, v54
    v_max3_f32 v72, v68, v69, v70
    v_min3_f32 v73, v68, v69, v70
    v_max_f32 v56, v56, v55
    v_max_f32 v57, -v57, -v55
    v_max_f32 v72, v72, v71
    v_max_f32 v73, -v73, -v71
    v_permlane32_swap_b32 v56, v57
    s_nop 0
    v_permlane32_swap_b32 v72, v73
    v_max_f32 v56, v56, v57
    v_max_f32 v72, v72, v73
    v_mov_b32 v58, v56
    v_mov_b32 v74, v72
    s_nop 0
    v_permlane16_swap_b32 v56, v58
    v_permlane16_swap_b32 v72, v74
    v_max_f32 v56, v56, v58
    v_max_f32 v72, v72, v74
    v_mov_b32 v57, v56
    v_mov_b32 v73, v72
    s_nop 0
    v_permlane32_swap_b32 v56, v57
    v_permlane32_swap_b32 v72, v73
    v_mul_f32 v56, s53, v56
    v_mul_f32 v57, s53, v57
    v_mul_f32 v72, s53, v72
    v_mul_f32 v73, s53, v73
    v_fma_f32 v60, v52, s53, -v56
    v_fma_f32 v64, -v52, s53, -v57
    v_fma_f32 v61, v53, s53, -v56
    v_fma_f32 v65, -v53, s53, -v57
    v_fma_f32 v62, v54, s53, -v56
    v_fma_f32 v66, -v54, s53, -v57
    v_fma_f32 v63, v55, s53, -v56
    v_fma_f32 v67, -v55, s53, -v57
    v_fma_f32 v76, v68, s53, -v72
    v_fma_f32 v80, -v68, s53, -v73
    v_fma_f32 v77, v69, s53, -v72
    v_fma_f32 v81, -v69, s53, -v73
    v_fma_f32 v78, v70, s53, -v72
    v_fma_f32 v82, -v70, s53, -v73
    v_fma_f32 v79, v71, s53, -v72
    v_fma_f32 v83, -v71, s53, -v73
    v_exp_f32 v60, v60
    v_exp_f32 v61, v61
    v_exp_f32 v62, v62
    v_exp_f32 v63, v63
    v_exp_f32 v64, v64
    v_exp_f32 v65, v65
    v_exp_f32 v66, v66
    v_exp_f32 v67, v67
    v_exp_f32 v76, v76
    v_exp_f32 v77, v77
    v_exp_f32 v78, v78
    v_exp_f32 v79, v79
    v_exp_f32 v80, v80
    v_exp_f32 v81, v81
    v_exp_f32 v82, v82
    v_exp_f32 v83, v83
    v_add_f32 v56, v60, v61
    v_add_f32 v57, v64, v65
    v_add_f32 v58, v62, v63
    v_add_f32 v59, v66, v67
    v_add_f32 v72, v76, v77
    v_add_f32 v73, v80, v81
    v_add_f32 v74, v78, v79
    v_add_f32 v75, v82, v83
    v_add_f32 v56, v56, v58
    v_add_f32 v57, v57, v59
    v_add_f32 v72, v72, v74
    v_add_f32 v73, v73, v75
    v_permlane32_swap_b32 v56, v57
    s_nop 0
    v_permlane32_swap_b32 v72, v73
    v_add_f32 v56, v56, v57
    v_add_f32 v72, v72, v73
    v_mov_b32 v58, v56
    v_mov_b32 v74, v72
    s_nop 0
    v_permlane16_swap_b32 v56, v58
    v_permlane16_swap_b32 v72, v74
    v_add_f32 v56, v56, v58
    v_add_f32 v72, v72, v74
    v_mov_b32 v57, v56
    v_mov_b32 v73, v72
    s_nop 0
    v_permlane32_swap_b32 v56, v57
    v_permlane32_swap_b32 v72, v73
    v_rcp_f32 v56, v56
    v_rcp_f32 v57, v57
    v_rcp_f32 v72, v72
    v_rcp_f32 v73, v73
    v_mul_f32 v60, v60, v56
    v_mul_f32 v64, v64, v57
    v_mul_f32 v61, v61, v56
    v_mul_f32 v65, v65, v57
    v_mul_f32 v62, v62, v56
    v_mul_f32 v66, v66, v57
    v_mul_f32 v63, v63, v56
    v_mul_f32 v67, v67, v57
    v_mul_f32 v76, v76, v72
    v_mul_f32 v80, v80, v73
    v_mul_f32 v77, v77, v72
    v_mul_f32 v81, v81, v73
    v_mul_f32 v78, v78, v72
    v_mul_f32 v82, v82, v73
    v_mul_f32 v79, v79, v72
    v_mul_f32 v83, v83, v73
    v_cvt_pk_bf16_f32 v88, v60, v61
    v_cvt_pk_bf16_f32 v89, v62, v63
    v_cvt_pk_bf16_f32 v92, v64, v65
    v_cvt_pk_bf16_f32 v93, v66, v67
    v_cvt_pk_bf16_f32 v90, v76, v77
    v_cvt_pk_bf16_f32 v91, v78, v79
    v_cvt_pk_bf16_f32 v94, v80, v81
    v_cvt_pk_bf16_f32 v95, v82, v83
    v_mfma_f32_16x16x16_bf16 v[52:55], v[88:89], v[112:113], 0
    v_mfma_f32_16x16x16_bf16 v[56:59], v[92:93], v[112:113], 0
    v_mfma_f32_16x16x16_bf16 v[60:63], v[90:91], v[112:113], 0
    v_mfma_f32_16x16x16_bf16 v[64:67], v[94:95], v[112:113], 0
    v_cvt_pk_bf16_f32 v104, v192, v193
    v_cvt_pk_bf16_f32 v105, v194, v195
    v_cvt_pk_bf16_f32 v106, v196, v197
    v_cvt_pk_bf16_f32 v107, v198, v199
    s_nop 0
    v_cvt_pk_bf16_f32 v96, v52, v53
    v_cvt_pk_bf16_f32 v97, v54, v55
    v_cvt_pk_bf16_f32 v100, v56, v57
    v_cvt_pk_bf16_f32 v101, v58, v59
    v_cvt_pk_bf16_f32 v98, v60, v61
    v_cvt_pk_bf16_f32 v99, v62, v63
    v_cvt_pk_bf16_f32 v102, v64, v65
    v_cvt_pk_bf16_f32 v103, v66, v67
    v_mfma_f32_16x16x32_bf16 v[48:51], v[96:99], v[104:107], 0
    s_nop 0
    v_mfma_f32_16x16x32_bf16 v[52:55], v[100:103], v[104:107], 0
    v_mfma_f32_16x16x32_bf16 v[56:59], v[96:99], v[108:111], 0
    v_mfma_f32_16x16x32_bf16 v[60:63], v[100:103], v[108:111], 0
    s_nop 3
    ds_write_b128 v12, v[48:51] offset:8192
    s_nop 0
    ds_write_b128 v12, v[52:55] offset:9216
    ds_write_b128 v12, v[56:59] offset:10240
    ds_write_b128 v12, v[60:63] offset:11264
    v_cvt_pk_bf16_f32 v48, v168, v169
    v_cvt_pk_bf16_f32 v49, v170, v171
    v_cvt_pk_bf16_f32 v50, v172, v173
    v_cvt_pk_bf16_f32 v51, v174, v175
    v_mfma_f32_16x16x16_bf16 v[52:55], v[246:247], v[48:49], 0
    s_nop 0
    v_mfma_f32_16x16x16_bf16 v[68:71], v[246:247], v[50:51], 0
    s_nop 5
    v_cvt_pk_bf16_f32 v48, v52, v53
    v_cvt_pk_bf16_f32 v49, v54, v55
    v_cvt_pk_bf16_f32 v50, v68, v69
    v_cvt_pk_bf16_f32 v51, v70, v71
    v_lshlrev_b32 v52, 16, v48
    v_and_b32 v53, 0xffff0000, v48
    v_lshlrev_b32 v54, 16, v49
    v_and_b32 v55, 0xffff0000, v49
    v_lshlrev_b32 v68, 16, v50
    v_and_b32 v69, 0xffff0000, v50
    v_lshlrev_b32 v70, 16, v51
    v_and_b32 v71, 0xffff0000, v51
    v_max3_f32 v56, v52, v53, v54
    v_min3_f32 v57, v52, v53, v54
    v_max3_f32 v72, v68, v69, v70
    v_min3_f32 v73, v68, v69, v70
    v_max_f32 v56, v56, v55
    v_max_f32 v57, -v57, -v55
    v_max_f32 v72, v72, v71
    v_max_f32 v73, -v73, -v71
    v_permlane32_swap_b32 v56, v57
    s_nop 0
    v_permlane32_swap_b32 v72, v73
    v_max_f32 v56, v56, v57
    v_max_f32 v72, v72, v73
    v_mov_b32 v58, v56
    v_mov_b32 v74, v72
    s_nop 0
    v_permlane16_swap_b32 v56, v58
    v_permlane16_swap_b32 v72, v74
    v_max_f32 v56, v56, v58
    v_max_f32 v72, v72, v74
    v_mov_b32 v57, v56
    v_mov_b32 v73, v72
    s_nop 0
    v_permlane32_swap_b32 v56, v57
    v_permlane32_swap_b32 v72, v73
    v_mul_f32 v56, s53, v56
    v_mul_f32 v57, s53, v57
    v_mul_f32 v72, s53, v72
    v_mul_f32 v73, s53, v73
    v_fma_f32 v60, v52, s53, -v56
    v_fma_f32 v64, -v52, s53, -v57
    v_fma_f32 v61, v53, s53, -v56
    v_fma_f32 v65, -v53, s53, -v57
    v_fma_f32 v62, v54, s53, -v56
    v_fma_f32 v66, -v54, s53, -v57
    v_fma_f32 v63, v55, s53, -v56
    v_fma_f32 v67, -v55, s53, -v57
    v_fma_f32 v76, v68, s53, -v72
    v_fma_f32 v80, -v68, s53, -v73
    v_fma_f32 v77, v69, s53, -v72
    v_fma_f32 v81, -v69, s53, -v73
    v_fma_f32 v78, v70, s53, -v72
    v_fma_f32 v82, -v70, s53, -v73
    v_fma_f32 v79, v71, s53, -v72
    v_fma_f32 v83, -v71, s53, -v73
    v_exp_f32 v60, v60
    v_exp_f32 v61, v61
    v_exp_f32 v62, v62
    v_exp_f32 v63, v63
    v_exp_f32 v64, v64
    v_exp_f32 v65, v65
    v_exp_f32 v66, v66
    v_exp_f32 v67, v67
    v_exp_f32 v76, v76
    v_exp_f32 v77, v77
    v_exp_f32 v78, v78
    v_exp_f32 v79, v79
    v_exp_f32 v80, v80
    v_exp_f32 v81, v81
    v_exp_f32 v82, v82
    v_exp_f32 v83, v83
    v_add_f32 v56, v60, v61
    v_add_f32 v57, v64, v65
    v_add_f32 v58, v62, v63
    v_add_f32 v59, v66, v67
    v_add_f32 v72, v76, v77
    v_add_f32 v73, v80, v81
    v_add_f32 v74, v78, v79
    v_add_f32 v75, v82, v83
    v_add_f32 v56, v56, v58
    v_add_f32 v57, v57, v59
    v_add_f32 v72, v72, v74
    v_add_f32 v73, v73, v75
    v_permlane32_swap_b32 v56, v57
    s_nop 0
    v_permlane32_swap_b32 v72, v73
    v_add_f32 v56, v56, v57
    v_add_f32 v72, v72, v73
    v_mov_b32 v58, v56
    v_mov_b32 v74, v72
    s_nop 0
    v_permlane16_swap_b32 v56, v58
    v_permlane16_swap_b32 v72, v74
    v_add_f32 v56, v56, v58
    v_add_f32 v72, v72, v74
    v_mov_b32 v57, v56
    v_mov_b32 v73, v72
    s_nop 0
    v_permlane32_swap_b32 v56, v57
    v_permlane32_swap_b32 v72, v73
    v_rcp_f32 v56, v56
    v_rcp_f32 v57, v57
    v_rcp_f32 v72, v72
    v_rcp_f32 v73, v73
    v_mul_f32 v60, v60, v56
    v_mul_f32 v64, v64, v57
    v_mul_f32 v61, v61, v56
    v_mul_f32 v65, v65, v57
    v_mul_f32 v62, v62, v56
    v_mul_f32 v66, v66, v57
    v_mul_f32 v63, v63, v56
    v_mul_f32 v67, v67, v57
    v_mul_f32 v76, v76, v72
    v_mul_f32 v80, v80, v73
    v_mul_f32 v77, v77, v72
    v_mul_f32 v81, v81, v73
    v_mul_f32 v78, v78, v72
    v_mul_f32 v82, v82, v73
    v_mul_f32 v79, v79, v72
    v_mul_f32 v83, v83, v73
    v_cvt_pk_bf16_f32 v88, v60, v61
    v_cvt_pk_bf16_f32 v89, v62, v63
    v_cvt_pk_bf16_f32 v92, v64, v65
    v_cvt_pk_bf16_f32 v93, v66, v67
    v_cvt_pk_bf16_f32 v90, v76, v77
    v_cvt_pk_bf16_f32 v91, v78, v79
    v_cvt_pk_bf16_f32 v94, v80, v81
    v_cvt_pk_bf16_f32 v95, v82, v83
    v_mfma_f32_16x16x16_bf16 v[52:55], v[88:89], v[112:113], 0
    v_mfma_f32_16x16x16_bf16 v[56:59], v[92:93], v[112:113], 0
    v_mfma_f32_16x16x16_bf16 v[60:63], v[90:91], v[112:113], 0
    v_mfma_f32_16x16x16_bf16 v[64:67], v[94:95], v[112:113], 0
    v_cvt_pk_bf16_f32 v104, v200, v201
    v_cvt_pk_bf16_f32 v105, v202, v203
    v_cvt_pk_bf16_f32 v106, v204, v205
    v_cvt_pk_bf16_f32 v107, v206, v207
    s_nop 0
    v_cvt_pk_bf16_f32 v96, v52, v53
    v_cvt_pk_bf16_f32 v97, v54, v55
    v_cvt_pk_bf16_f32 v100, v56, v57
    v_cvt_pk_bf16_f32 v101, v58, v59
    v_cvt_pk_bf16_f32 v98, v60, v61
    v_cvt_pk_bf16_f32 v99, v62, v63
    v_cvt_pk_bf16_f32 v102, v64, v65
    v_cvt_pk_bf16_f32 v103, v66, v67
    v_mfma_f32_16x16x32_bf16 v[48:51], v[96:99], v[104:107], 0
    s_nop 0
    v_mfma_f32_16x16x32_bf16 v[52:55], v[100:103], v[104:107], 0
    v_mfma_f32_16x16x32_bf16 v[56:59], v[96:99], v[108:111], 0
    v_mfma_f32_16x16x32_bf16 v[60:63], v[100:103], v[108:111], 0
    s_nop 3
    ds_write_b128 v12, v[48:51] offset:12288
    s_nop 0
    ds_write_b128 v12, v[52:55] offset:13312
    ds_write_b128 v12, v[56:59] offset:14336
    ds_write_b128 v12, v[60:63] offset:15360
    s_waitcnt lgkmcnt(0)
    s_barrier
    v_lshrrev_b32 v48, 7, v0
    v_lshlrev_b32 v48, 12, v48
    v_and_b32 v49, 0x7f, v0
    v_lshl_add_u32 v48, v49, 4, v48
    v_add_u32 v49, 0x10000, v48
    ds_read_b128 v[52:55], v48 offset:0
    ds_read_b128 v[56:59], v48 offset:2048
    ds_read_b128 v[60:63], v48 offset:16384
    ds_read_b128 v[64:67], v48 offset:18432
    ds_read_b128 v[68:71], v48 offset:32768
    ds_read_b128 v[72:75], v48 offset:34816
    ds_read_b128 v[76:79], v48 offset:49152
    ds_read_b128 v[80:83], v48 offset:51200
    ds_read_b128 v[84:87], v49 offset:0
    ds_read_b128 v[88:91], v49 offset:2048
    ds_read_b128 v[92:95], v49 offset:16384
    ds_read_b128 v[96:99], v49 offset:18432
    ds_read_b128 v[100:103], v49 offset:32768
    ds_read_b128 v[104:107], v49 offset:34816
    ds_read_b128 v[108:111], v49 offset:49152
    ds_read_b128 v[112:115], v49 offset:51200
    v_lshlrev_b32 v50, 4, v0
    v_lshrrev_b32 v51, 6, v0
    v_lshlrev_b32 v51, 6, v51
    v_lshl_add_u32 v51, v3, 4, v51
    s_lshl_b32 s23, s14, 13
    s_sub_u32 s23, s23, 4*8192
    s_lshr_b32 s51, s23, 4
    s_add_u32 s51, s51, 65536
    s_waitcnt lgkmcnt(0)
    v_add_f32 v52, v52, v60
    v_add_f32 v53, v53, v61
    v_add_f32 v54, v54, v62
    v_add_f32 v55, v55, v63
    v_add_f32 v56, v56, v64
    v_add_f32 v57, v57, v65
    v_add_f32 v58, v58, v66
    v_add_f32 v59, v59, v67
    v_add_f32 v52, v52, v68
    v_add_f32 v53, v53, v69
    v_add_f32 v54, v54, v70
    v_add_f32 v55, v55, v71
    v_add_f32 v56, v56, v72
    v_add_f32 v57, v57, v73
    v_add_f32 v58, v58, v74
    v_add_f32 v59, v59, v75
    v_add_f32 v52, v52, v76
    v_add_f32 v53, v53, v77
    v_add_f32 v54, v54, v78
    v_add_f32 v55, v55, v79
    v_add_f32 v56, v56, v80
    v_add_f32 v57, v57, v81
    v_add_f32 v58, v58, v82
    v_add_f32 v59, v59, v83
    v_add_f32 v52, v52, v84
    v_add_f32 v53, v53, v85
    v_add_f32 v54, v54, v86
    v_add_f32 v55, v55, v87
    v_add_f32 v56, v56, v88
    v_add_f32 v57, v57, v89
    v_add_f32 v58, v58, v90
    v_add_f32 v59, v59, v91
    v_add_f32 v52, v52, v92
    v_add_f32 v53, v53, v93
    v_add_f32 v54, v54, v94
    v_add_f32 v55, v55, v95
    v_add_f32 v56, v56, v96
    v_add_f32 v57, v57, v97
    v_add_f32 v58, v58, v98
    v_add_f32 v59, v59, v99
    v_add_f32 v52, v52, v100
    v_add_f32 v53, v53, v101
    v_add_f32 v54, v54, v102
    v_add_f32 v55, v55, v103
    v_add_f32 v56, v56, v104
    v_add_f32 v57, v57, v105
    v_add_f32 v58, v58, v106
    v_add_f32 v59, v59, v107
    v_add_f32 v52, v52, v108
    v_add_f32 v53, v53, v109
    v_add_f32 v54, v54, v110
    v_add_f32 v55, v55, v111
    v_add_f32 v56, v56, v112
    v_add_f32 v57, v57, v113
    v_add_f32 v58, v58, v114
    v_add_f32 v59, v59, v115
    s_barrier
    ds_write_b128 v50, v[52:55]
    s_mov_b32 exec_lo, 0x00010001
    s_mov_b32 exec_hi, 0x00010001
    ds_write_b128 v51, v[56:59] offset:8192
    s_mov_b64 exec, -1
    v_lshlrev_b32 v48, 2, v0
    s_add_u32 s55, s23, 4096
    s_waitcnt lgkmcnt(0)
    s_barrier
    ds_read_b32 v52, v48 offset:0
    ds_read_b32 v53, v48 offset:2048
    ds_read_b32 v54, v48 offset:4096
    ds_read_b32 v55, v48 offset:6144
    ds_read_b32 v56, v48 offset:8192
    s_waitcnt lgkmcnt(0)
    buffer_atomic_add_f32 v52, v48, s[36:39], s23 offen offset:0
    buffer_atomic_add_f32 v53, v48, s[36:39], s23 offen offset:2048
    buffer_atomic_add_f32 v54, v48, s[36:39], s55 offen offset:0
    buffer_atomic_add_f32 v55, v48, s[36:39], s55 offen offset:2048
    s_cmp_lt_u32 s16, 2
    s_cbranch_scc0 K1_kv_end
    buffer_atomic_add_f32 v56, v48, s[36:39], s51 offen
K1_kv_end:
    s_mov_b64 exec, -1
    s_branch K1_done
K1_A_go:
    s_and_b32 s54, s14, 3
    s_lshl_b32 s54, s54, 1
    s_add_u32 s54, s54, s15
    s_lshl_b32 s54, s54, 1
    s_and_b32 s54, s54, 0
    s_mul_i32 s19, s54, s18
    s_lshl_b32 s3, s16, 10
    s_add_u32 m0, s3, 131072
    s_nop 0
    buffer_load_dwordx4 v244, s[40:43], s3 offen lds
    s_add_u32 m0, s20, 0
    s_nop 0
    buffer_load_dwordx4 v6, s[24:27], s19 offen lds
    s_lshl_b32 s52, s54, 10
    s_add_u32 s54, s54, 1
    s_and_b32 s54, s54, 15
    s_mul_i32 s19, s54, s18
    buffer_load_dwordx4 v[16:19], v4, s[28:31], s52 offen
    buffer_load_dwordx4 v[20:23], v5, s[28:31], s52 offen
    s_add_u32 m0, s20, 8192
    s_nop 0
    buffer_load_dwordx4 v6, s[24:27], s19 offen lds
    s_lshl_b32 s52, s54, 10
    s_add_u32 s54, s54, 1
    s_and_b32 s54, s54, 15
    s_mul_i32 s19, s54, s18
    buffer_load_dwordx4 v[24:27], v4, s[28:31], s52 offen
    buffer_load_dwordx4 v[28:31], v5, s[28:31], s52 offen
    s_add_u32 m0, s20, 16384
    s_nop 0
    buffer_load_dwordx4 v6, s[24:27], s19 offen lds
    s_lshl_b32 s52, s54, 10
    s_add_u32 s54, s54, 1
    s_and_b32 s54, s54, 15
    s_mul_i32 s19, s54, s18
    buffer_load_dwordx4 v[32:35], v4, s[28:31], s52 offen
    buffer_load_dwordx4 v[36:39], v5, s[28:31], s52 offen
    s_add_u32 m0, s20, 24576
    s_nop 0
    buffer_load_dwordx4 v6, s[24:27], s19 offen lds
    s_lshl_b32 s52, s54, 10
    s_add_u32 s54, s54, 1
    s_and_b32 s54, s54, 15
    s_mul_i32 s19, s54, s18
    buffer_load_dwordx4 v[40:43], v4, s[28:31], s52 offen
    buffer_load_dwordx4 v[44:47], v5, s[28:31], s52 offen
    v_add_u32 v240, 0x10000, v8
    v_add_u32 v241, 0x10000, v9
    v_add_u32 v242, 0x10000, v10
    v_add_u32 v243, 0x10000, v11
    v_mov_b32 v144, 0
    v_mov_b32 v145, 0
    v_mov_b32 v146, 0
    v_mov_b32 v147, 0
    v_mov_b32 v148, 0
    v_mov_b32 v149, 0
    v_mov_b32 v150, 0
    v_mov_b32 v151, 0
    v_mov_b32 v152, 0
    v_mov_b32 v153, 0
    v_mov_b32 v154, 0
    v_mov_b32 v155, 0
    v_mov_b32 v156, 0
    v_mov_b32 v157, 0
    v_mov_b32 v158, 0
    v_mov_b32 v159, 0
    v_mov_b32 v160, 0
    v_mov_b32 v161, 0
    v_mov_b32 v162, 0
    v_mov_b32 v163, 0
    v_mov_b32 v164, 0
    v_mov_b32 v165, 0
    v_mov_b32 v166, 0
    v_mov_b32 v167, 0
    v_mov_b32 v168, 0
    v_mov_b32 v169, 0
    v_mov_b32 v170, 0
    v_mov_b32 v171, 0
    v_mov_b32 v172, 0
    v_mov_b32 v173, 0
    v_mov_b32 v174, 0
    v_mov_b32 v175, 0
    v_mov_b32 v176, 0
    v_mov_b32 v177, 0
    v_mov_b32 v178, 0
    v_mov_b32 v179, 0
    v_mov_b32 v180, 0
    v_mov_b32 v181, 0
    v_mov_b32 v182, 0
    v_mov_b32 v183, 0
    v_mov_b32 v184, 0
    v_mov_b32 v185, 0
    v_mov_b32 v186, 0
    v_mov_b32 v187, 0
    v_mov_b32 v188, 0
    v_mov_b32 v189, 0
    v_mov_b32 v190, 0
    v_mov_b32 v191, 0
    v_mov_b32 v192, 0
    v_mov_b32 v193, 0
    v_mov_b32 v194, 0
    v_mov_b32 v195, 0
    v_mov_b32 v196, 0
    v_mov_b32 v197, 0
    v_mov_b32 v198, 0
    v_mov_b32 v199, 0
    v_mov_b32 v200, 0
    v_mov_b32 v201, 0
    v_mov_b32 v202, 0
    v_mov_b32 v203, 0
    v_mov_b32 v204, 0
    v_mov_b32 v205, 0
    v_mov_b32 v206, 0
    v_mov_b32 v207, 0
    s_waitcnt vmcnt(11)
    s_barrier
    ds_read_b64_tr_b16 v[224:225], v8 offset:0
    ds_read_b64_tr_b16 v[226:227], v8 offset:1024
    ds_read_b64_tr_b16 v[228:229], v9 offset:0
    ds_read_b64_tr_b16 v[230:231], v9 offset:1024
    s_waitcnt vmcnt(5)
    s_barrier
    ds_read_b64_tr_b16 v[232:233], v10 offset:0
    ds_read_b64_tr_b16 v[234:235], v10 offset:1024
    s_waitcnt lgkmcnt(4)
    v_mfma_f32_16x16x32_bf16 v[144:147], v[224:227], v[16:19], v[144:147]
    v_mfma_f32_16x16x32_bf16 v[148:151], v[224:227], v[20:23], v[148:151]
    s_add_u32 m0, s20, 32768
    s_nop 0
    buffer_load_dwordx4 v6, s[24:27], s19 offen lds
    s_lshl_b32 s52, s54, 10
    s_add_u32 s54, s54, 1
    s_and_b32 s54, s54, 15
    s_mul_i32 s19, s54, s18
    ds_read_b64_tr_b16 v[236:237], v11 offset:0
    ds_read_b64_tr_b16 v[238:239], v11 offset:1024
    s_waitcnt lgkmcnt(4)
    v_mfma_f32_16x16x32_bf16 v[152:155], v[228:231], v[16:19], v[152:155]
    v_mfma_f32_16x16x32_bf16 v[156:159], v[228:231], v[20:23], v[156:159]
    ds_read_b64_tr_b16 v[224:225], v8 offset:4096
    ds_read_b64_tr_b16 v[226:227], v8 offset:5120
    s_waitcnt lgkmcnt(4)
    v_mfma_f32_16x16x32_bf16 v[160:163], v[232:235], v[16:19], v[160:163]
    v_mfma_f32_16x16x32_bf16 v[164:167], v[232:235], v[20:23], v[164:167]
    buffer_load_dwordx4 v[48:51], v4, s[28:31], s52 offen
    ds_read_b64_tr_b16 v[228:229], v9 offset:4096
    ds_read_b64_tr_b16 v[230:231], v9 offset:5120
    s_waitcnt lgkmcnt(4)
    v_mfma_f32_16x16x32_bf16 v[168:171], v[236:239], v[16:19], v[168:171]
    v_mfma_f32_16x16x32_bf16 v[172:175], v[236:239], v[20:23], v[172:175]
    ds_read_b64_tr_b16 v[232:233], v10 offset:4096
    ds_read_b64_tr_b16 v[234:235], v10 offset:5120
    s_waitcnt lgkmcnt(4)
    v_mfma_f32_16x16x32_bf16 v[176:179], v[224:227], v[16:19], v[176:179]
    v_mfma_f32_16x16x32_bf16 v[180:183], v[224:227], v[20:23], v[180:183]
    buffer_load_dwordx4 v[52:55], v5, s[28:31], s52 offen
    ds_read_b64_tr_b16 v[236:237], v11 offset:4096
    ds_read_b64_tr_b16 v[238:239], v11 offset:5120
    s_waitcnt lgkmcnt(4)
    v_mfma_f32_16x16x32_bf16 v[184:187], v[228:231], v[16:19], v[184:187]
    v_mfma_f32_16x16x32_bf16 v[188:191], v[228:231], v[20:23], v[188:191]
    ds_read_b64_tr_b16 v[224:225], v8 offset:8192
    ds_read_b64_tr_b16 v[226:227], v8 offset:9216
    s_waitcnt lgkmcnt(4)
    v_mfma_f32_16x16x32_bf16 v[192:195], v[232:235], v[16:19], v[192:195]
    v_mfma_f32_16x16x32_bf16 v[196:199], v[232:235], v[20:23], v[196:199]
    ds_read_b64_tr_b16 v[228:229], v9 offset:8192
    ds_read_b64_tr_b16 v[230:231], v9 offset:9216
    s_waitcnt lgkmcnt(4)
    v_mfma_f32_16x16x32_bf16 v[200:203], v[236:239], v[16:19], v[200:203]
    v_mfma_f32_16x16x32_bf16 v[204:207], v[236:239], v[20:23], v[204:207]
    s_waitcnt vmcnt(9)
    ds_read_b64_tr_b16 v[232:233], v10 offset:8192
    ds_read_b64_tr_b16 v[234:235], v10 offset:9216
    s_waitcnt lgkmcnt(4)
    v_mfma_f32_16x16x32_bf16 v[144:147], v[224:227], v[24:27], v[144:147]
    v_mfma_f32_16x16x32_bf16 v[148:151], v[224:227], v[28:31], v[148:151]
    s_add_u32 m0, s20, 40960
    s_nop 0
    buffer_load_dwordx4 v6, s[24:27], s19 offen lds
    s_lshl_b32 s52, s54, 10
    s_add_u32 s54, s54, 1
    s_and_b32 s54, s54, 15
    s_mul_i32 s19, s54, s18
    ds_read_b64_tr_b16 v[236:237], v11 offset:8192
    ds_read_b64_tr_b16 v[238:239], v11 offset:9216
    s_waitcnt lgkmcnt(4)
    v_mfma_f32_16x16x32_bf16 v[152:155], v[228:231], v[24:27], v[152:155]
    v_mfma_f32_16x16x32_bf16 v[156:159], v[228:231], v[28:31], v[156:159]
    ds_read_b64_tr_b16 v[224:225], v8 offset:12288
    ds_read_b64_tr_b16 v[226:227], v8 offset:13312
    s_waitcnt lgkmcnt(4)
    v_mfma_f32_16x16x32_bf16 v[160:163], v[232:235], v[24:27], v[160:163]
    v_mfma_f32_16x16x32_bf16 v[164:167], v[232:235], v[28:31], v[164:167]
    buffer_load_dwordx4 v[56:59], v4, s[28:31], s52 offen
    ds_read_b64_tr_b16 v[228:229], v9 offset:12288
    ds_read_b64_tr_b16 v[230:231], v9 offset:13312
    s_waitcnt lgkmcnt(4)
    v_mfma_f32_16x16x32_bf16 v[168:171], v[236:239], v[24:27], v[168:171]
    v_mfma_f32_16x16x32_bf16 v[172:175], v[236:239], v[28:31], v[172:175]
    ds_read_b64_tr_b16 v[232:233], v10 offset:12288
    ds_read_b64_tr_b16 v[234:235], v10 offset:13312
    s_waitcnt lgkmcnt(4)
    v_mfma_f32_16x16x32_bf16 v[176:179], v[224:227], v[24:27], v[176:179]
    v_mfma_f32_16x16x32_bf16 v[180:183], v[224:227], v[28:31], v[180:183]
    buffer_load_dwordx4 v[60:63], v5, s[28:31], s52 offen
    ds_read_b64_tr_b16 v[236:237], v11 offset:12288
    ds_read_b64_tr_b16 v[238:239], v11 offset:13312
    s_waitcnt lgkmcnt(4)
    v_mfma_f32_16x16x32_bf16 v[184:187], v[228:231], v[24:27], v[184:187]
    v_mfma_f32_16x16x32_bf16 v[188:191], v[228:231], v[28:31], v[188:191]
    ds_read_b64_tr_b16 v[224:225], v8 offset:16384
    ds_read_b64_tr_b16 v[226:227], v8 offset:17408
    s_waitcnt lgkmcnt(4)
    v_mfma_f32_16x16x32_bf16 v[192:195], v[232:235], v[24:27], v[192:195]
    v_mfma_f32_16x16x32_bf16 v[196:199], v[232:235], v[28:31], v[196:199]
    ds_read_b64_tr_b16 v[228:229], v9 offset:16384
    ds_read_b64_tr_b16 v[230:231], v9 offset:17408
    s_waitcnt lgkmcnt(4)
    v_mfma_f32_16x16x32_bf16 v[200:203], v[236:239], v[24:27], v[200:203]
    v_mfma_f32_16x16x32_bf16 v[204:207], v[236:239], v[28:31], v[204:207]
    s_waitcnt vmcnt(5)
    s_barrier
    ds_read_b64_tr_b16 v[232:233], v10 offset:16384
    ds_read_b64_tr_b16 v[234:235], v10 offset:17408
    s_waitcnt lgkmcnt(4)
    v_mfma_f32_16x16x32_bf16 v[144:147], v[224:227], v[32:35], v[144:147]
    v_mfma_f32_16x16x32_bf16 v[148:151], v[224:227], v[36:39], v[148:151]
    s_add_u32 m0, s20, 49152
    s_nop 0
    buffer_load_dwordx4 v6, s[24:27], s19 offen lds
    s_lshl_b32 s52, s54, 10
    s_add_u32 s54, s54, 1
    s_and_b32 s54, s54, 15
    s_mul_i32 s19, s54, s18
    ds_read_b64_tr_b16 v[236:237], v11 offset:16384
    ds_read_b64_tr_b16 v[238:239], v11 offset:17408
    s_waitcnt lgkmcnt(4)
    v_mfma_f32_16x16x32_bf16 v[152:155], v[228:231], v[32:35], v[152:155]
    v_mfma_f32_16x16x32_bf16 v[156:159], v[228:231], v[36:39], v[156:159]
    ds_read_b64_tr_b16 v[224:225], v8 offset:20480
    ds_read_b64_tr_b16 v[226:227], v8 offset:21504
    s_waitcnt lgkmcnt(4)
    v_mfma_f32_16x16x32_bf16 v[160:163], v[232:235], v[32:35], v[160:163]
    v_mfma_f32_16x16x32_bf16 v[164:167], v[232:235], v[36:39], v[164:167]
    buffer_load_dwordx4 v[64:67], v4, s[28:31], s52 offen
    ds_read_b64_tr_b16 v[228:229], v9 offset:20480
    ds_read_b64_tr_b16 v[230:231], v9 offset:21504
    s_waitcnt lgkmcnt(4)
    v_mfma_f32_16x16x32_bf16 v[168:171], v[236:239], v[32:35], v[168:171]
    v_mfma_f32_16x16x32_bf16 v[172:175], v[236:239], v[36:39], v[172:175]
    ds_read_b64_tr_b16 v[232:233], v10 offset:20480
    ds_read_b64_tr_b16 v[234:235], v10 offset:21504
    s_waitcnt lgkmcnt(4)
    v_mfma_f32_16x16x32_bf16 v[176:179], v[224:227], v[32:35], v[176:179]
    v_mfma_f32_16x16x32_bf16 v[180:183], v[224:227], v[36:39], v[180:183]
    buffer_load_dwordx4 v[68:71], v5, s[28:31], s52 offen
    ds_read_b64_tr_b16 v[236:237], v11 offset:20480
    ds_read_b64_tr_b16 v[238:239], v11 offset:21504
    s_waitcnt lgkmcnt(4)
    v_mfma_f32_16x16x32_bf16 v[184:187], v[228:231], v[32:35], v[184:187]
    v_mfma_f32_16x16x32_bf16 v[188:191], v[228:231], v[36:39], v[188:191]
    ds_read_b64_tr_b16 v[224:225], v8 offset:24576
    ds_read_b64_tr_b16 v[226:227], v8 offset:25600
    s_waitcnt lgkmcnt(4)
    v_mfma_f32_16x16x32_bf16 v[192:195], v[232:235], v[32:35], v[192:195]
    v_mfma_f32_16x16x32_bf16 v[196:199], v[232:235], v[36:39], v[196:199]
    ds_read_b64_tr_b16 v[228:229], v9 offset:24576
    ds_read_b64_tr_b16 v[230:231], v9 offset:25600
    s_waitcnt lgkmcnt(4)
    v_mfma_f32_16x16x32_bf16 v[200:203], v[236:239], v[32:35], v[200:203]
    v_mfma_f32_16x16x32_bf16 v[204:207], v[236:239], v[36:39], v[204:207]
    s_waitcnt vmcnt(9)
    ds_read_b64_tr_b16 v[232:233], v10 offset:24576
    ds_read_b64_tr_b16 v[234:235], v10 offset:25600
    s_waitcnt lgkmcnt(4)
    v_mfma_f32_16x16x32_bf16 v[144:147], v[224:227], v[40:43], v[144:147]
    v_mfma_f32_16x16x32_bf16 v[148:151], v[224:227], v[44:47], v[148:151]
    s_add_u32 m0, s20, 57344
    s_nop 0
    buffer_load_dwordx4 v6, s[24:27], s19 offen lds
    s_lshl_b32 s52, s54, 10
    s_add_u32 s54, s54, 1
    s_and_b32 s54, s54, 15
    s_mul_i32 s19, s54, s18
    ds_read_b64_tr_b16 v[236:237], v11 offset:24576
    ds_read_b64_tr_b16 v[238:239], v11 offset:25600
    s_waitcnt lgkmcnt(4)
    v_mfma_f32_16x16x32_bf16 v[152:155], v[228:231], v[40:43], v[152:155]
    v_mfma_f32_16x16x32_bf16 v[156:159], v[228:231], v[44:47], v[156:159]
    ds_read_b64_tr_b16 v[224:225], v8 offset:28672
    ds_read_b64_tr_b16 v[226:227], v8 offset:29696
    s_waitcnt lgkmcnt(4)
    v_mfma_f32_16x16x32_bf16 v[160:163], v[232:235], v[40:43], v[160:163]
    v_mfma_f32_16x16x32_bf16 v[164:167], v[232:235], v[44:47], v[164:167]
    buffer_load_dwordx4 v[72:75], v4, s[28:31], s52 offen
    ds_read_b64_tr_b16 v[228:229], v9 offset:28672
    ds_read_b64_tr_b16 v[230:231], v9 offset:29696
    s_waitcnt lgkmcnt(4)
    v_mfma_f32_16x16x32_bf16 v[168:171], v[236:239], v[40:43], v[168:171]
    v_mfma_f32_16x16x32_bf16 v[172:175], v[236:239], v[44:47], v[172:175]
    ds_read_b64_tr_b16 v[232:233], v10 offset:28672
    ds_read_b64_tr_b16 v[234:235], v10 offset:29696
    s_waitcnt lgkmcnt(4)
    v_mfma_f32_16x16x32_bf16 v[176:179], v[224:227], v[40:43], v[176:179]
    v_mfma_f32_16x16x32_bf16 v[180:183], v[224:227], v[44:47], v[180:183]
    buffer_load_dwordx4 v[76:79], v5, s[28:31], s52 offen
    ds_read_b64_tr_b16 v[236:237], v11 offset:28672
    ds_read_b64_tr_b16 v[238:239], v11 offset:29696
    s_waitcnt lgkmcnt(4)
    v_mfma_f32_16x16x32_bf16 v[184:187], v[228:231], v[40:43], v[184:187]
    v_mfma_f32_16x16x32_bf16 v[188:191], v[228:231], v[44:47], v[188:191]
    ds_read_b64_tr_b16 v[224:225], v8 offset:32768
    ds_read_b64_tr_b16 v[226:227], v8 offset:33792
    s_waitcnt lgkmcnt(4)
    v_mfma_f32_16x16x32_bf16 v[192:195], v[232:235], v[40:43], v[192:195]
    v_mfma_f32_16x16x32_bf16 v[196:199], v[232:235], v[44:47], v[196:199]
    ds_read_b64_tr_b16 v[228:229], v9 offset:32768
    ds_read_b64_tr_b16 v[230:231], v9 offset:33792
    s_waitcnt lgkmcnt(4)
    v_mfma_f32_16x16x32_bf16 v[200:203], v[236:239], v[40:43], v[200:203]
    v_mfma_f32_16x16x32_bf16 v[204:207], v[236:239], v[44:47], v[204:207]
    s_waitcnt vmcnt(5)
    s_barrier
    ds_read_b64_tr_b16 v[232:233], v10 offset:32768
    ds_read_b64_tr_b16 v[234:235], v10 offset:33792
    s_waitcnt lgkmcnt(4)
    v_mfma_f32_16x16x32_bf16 v[144:147], v[224:227], v[48:51], v[144:147]
    v_mfma_f32_16x16x32_bf16 v[148:151], v[224:227], v[52:55], v[148:151]
    s_add_u32 m0, s20, 65536
    s_nop 0
    buffer_load_dwordx4 v6, s[24:27], s19 offen lds
    s_lshl_b32 s52, s54, 10
    s_add_u32 s54, s54, 1
    s_and_b32 s54, s54, 15
    s_mul_i32 s19, s54, s18
    ds_read_b64_tr_b16 v[236:237], v11 offset:32768
    ds_read_b64_tr_b16 v[238:239], v11 offset:33792
    s_waitcnt lgkmcnt(4)
    v_mfma_f32_16x16x32_bf16 v[152:155], v[228:231], v[48:51], v[152:155]
    v_mfma_f32_16x16x32_bf16 v[156:159], v[228:231], v[52:55], v[156:159]
    ds_read_b64_tr_b16 v[224:225], v8 offset:36864
    ds_read_b64_tr_b16 v[226:227], v8 offset:37888
    s_waitcnt lgkmcnt(4)
    v_mfma_f32_16x16x32_bf16 v[160:163], v[232:235], v[48:51], v[160:163]
    v_mfma_f32_16x16x32_bf16 v[164:167], v[232:235], v[52:55], v[164:167]
    buffer_load_dwordx4 v[80:83], v4, s[28:31], s52 offen
    ds_read_b64_tr_b16 v[228:229], v9 offset:36864
    ds_read_b64_tr_b16 v[230:231], v9 offset:37888
    s_waitcnt lgkmcnt(4)
    v_mfma_f32_16x16x32_bf16 v[168:171], v[236:239], v[48:51], v[168:171]
    v_mfma_f32_16x16x32_bf16 v[172:175], v[236:239], v[52:55], v[172:175]
    ds_read_b64_tr_b16 v[232:233], v10 offset:36864
    ds_read_b64_tr_b16 v[234:235], v10 offset:37888
    s_waitcnt lgkmcnt(4)
    v_mfma_f32_16x16x32_bf16 v[176:179], v[224:227], v[48:51], v[176:179]
    v_mfma_f32_16x16x32_bf16 v[180:183], v[224:227], v[52:55], v[180:183]
    buffer_load_dwordx4 v[84:87], v5, s[28:31], s52 offen
    ds_read_b64_tr_b16 v[236:237], v11 offset:36864
    ds_read_b64_tr_b16 v[238:239], v11 offset:37888
    s_waitcnt lgkmcnt(4)
    v_mfma_f32_16x16x32_bf16 v[184:187], v[228:231], v[48:51], v[184:187]
    v_mfma_f32_16x16x32_bf16 v[188:191], v[228:231], v[52:55], v[188:191]
    ds_read_b64_tr_b16 v[224:225], v8 offset:40960
    ds_read_b64_tr_b16 v[226:227], v8 offset:41984
    s_waitcnt lgkmcnt(4)
    v_mfma_f32_16x16x32_bf16 v[192:195], v[232:235], v[48:51], v[192:195]
    v_mfma_f32_16x16x32_bf16 v[196:199], v[232:235], v[52:55], v[196:199]
    ds_read_b64_tr_b16 v[228:229], v9 offset:40960
    ds_read_b64_tr_b16 v[230:231], v9 offset:41984
    s_waitcnt lgkmcnt(4)
    v_mfma_f32_16x16x32_bf16 v[200:203], v[236:239], v[48:51], v[200:203]
    v_mfma_f32_16x16x32_bf16 v[204:207], v[236:239], v[52:55], v[204:207]
    s_waitcnt vmcnt(9)
    ds_read_b64_tr_b16 v[232:233], v10 offset:40960
    ds_read_b64_tr_b16 v[234:235], v10 offset:41984
    s_waitcnt lgkmcnt(4)
    v_mfma_f32_16x16x32_bf16 v[144:147], v[224:227], v[56:59], v[144:147]
    v_mfma_f32_16x16x32_bf16 v[148:151], v[224:227], v[60:63], v[148:151]
    s_add_u32 m0, s20, 73728
    s_nop 0
    buffer_load_dwordx4 v6, s[24:27], s19 offen lds
    s_lshl_b32 s52, s54, 10
    s_add_u32 s54, s54, 1
    s_and_b32 s54, s54, 15
    s_mul_i32 s19, s54, s18
    ds_read_b64_tr_b16 v[236:237], v11 offset:40960
    ds_read_b64_tr_b16 v[238:239], v11 offset:41984
    s_waitcnt lgkmcnt(4)
    v_mfma_f32_16x16x32_bf16 v[152:155], v[228:231], v[56:59], v[152:155]
    v_mfma_f32_16x16x32_bf16 v[156:159], v[228:231], v[60:63], v[156:159]
    ds_read_b64_tr_b16 v[224:225], v8 offset:45056
    ds_read_b64_tr_b16 v[226:227], v8 offset:46080
    s_waitcnt lgkmcnt(4)
    v_mfma_f32_16x16x32_bf16 v[160:163], v[232:235], v[56:59], v[160:163]
    v_mfma_f32_16x16x32_bf16 v[164:167], v[232:235], v[60:63], v[164:167]
    buffer_load_dwordx4 v[88:91], v4, s[28:31], s52 offen
    ds_read_b64_tr_b16 v[228:229], v9 offset:45056
    ds_read_b64_tr_b16 v[230:231], v9 offset:46080
    s_waitcnt lgkmcnt(4)
    v_mfma_f32_16x16x32_bf16 v[168:171], v[236:239], v[56:59], v[168:171]
    v_mfma_f32_16x16x32_bf16 v[172:175], v[236:239], v[60:63], v[172:175]
    ds_read_b64_tr_b16 v[232:233], v10 offset:45056
    ds_read_b64_tr_b16 v[234:235], v10 offset:46080
    s_waitcnt lgkmcnt(4)
    v_mfma_f32_16x16x32_bf16 v[176:179], v[224:227], v[56:59], v[176:179]
    v_mfma_f32_16x16x32_bf16 v[180:183], v[224:227], v[60:63], v[180:183]
    buffer_load_dwordx4 v[92:95], v5, s[28:31], s52 offen
    ds_read_b64_tr_b16 v[236:237], v11 offset:45056
    ds_read_b64_tr_b16 v[238:239], v11 offset:46080
    s_waitcnt lgkmcnt(4)
    v_mfma_f32_16x16x32_bf16 v[184:187], v[228:231], v[56:59], v[184:187]
    v_mfma_f32_16x16x32_bf16 v[188:191], v[228:231], v[60:63], v[188:191]
    ds_read_b64_tr_b16 v[224:225], v8 offset:49152
    ds_read_b64_tr_b16 v[226:227], v8 offset:50176
    s_waitcnt lgkmcnt(4)
    v_mfma_f32_16x16x32_bf16 v[192:195], v[232:235], v[56:59], v[192:195]
    v_mfma_f32_16x16x32_bf16 v[196:199], v[232:235], v[60:63], v[196:199]
    ds_read_b64_tr_b16 v[228:229], v9 offset:49152
    ds_read_b64_tr_b16 v[230:231], v9 offset:50176
    s_waitcnt lgkmcnt(4)
    v_mfma_f32_16x16x32_bf16 v[200:203], v[236:239], v[56:59], v[200:203]
    v_mfma_f32_16x16x32_bf16 v[204:207], v[236:239], v[60:63], v[204:207]
    s_waitcnt vmcnt(5)
    s_barrier
    ds_read_b64_tr_b16 v[232:233], v10 offset:49152
    ds_read_b64_tr_b16 v[234:235], v10 offset:50176
    s_waitcnt lgkmcnt(4)
    v_mfma_f32_16x16x32_bf16 v[144:147], v[224:227], v[64:67], v[144:147]
    v_mfma_f32_16x16x32_bf16 v[148:151], v[224:227], v[68:71], v[148:151]
    s_add_u32 m0, s20, 81920
    s_nop 0
    buffer_load_dwordx4 v6, s[24:27], s19 offen lds
    s_lshl_b32 s52, s54, 10
    s_add_u32 s54, s54, 1
    s_and_b32 s54, s54, 15
    s_mul_i32 s19, s54, s18
    ds_read_b64_tr_b16 v[236:237], v11 offset:49152
    ds_read_b64_tr_b16 v[238:239], v11 offset:50176
    s_waitcnt lgkmcnt(4)
    v_mfma_f32_16x16x32_bf16 v[152:155], v[228:231], v[64:67], v[152:155]
    v_mfma_f32_16x16x32_bf16 v[156:159], v[228:231], v[68:71], v[156:159]
    ds_read_b64_tr_b16 v[224:225], v8 offset:53248
    ds_read_b64_tr_b16 v[226:227], v8 offset:54272
    s_waitcnt lgkmcnt(4)
    v_mfma_f32_16x16x32_bf16 v[160:163], v[232:235], v[64:67], v[160:163]
    v_mfma_f32_16x16x32_bf16 v[164:167], v[232:235], v[68:71], v[164:167]
    buffer_load_dwordx4 v[96:99], v4, s[28:31], s52 offen
    ds_read_b64_tr_b16 v[228:229], v9 offset:53248
    ds_read_b64_tr_b16 v[230:231], v9 offset:54272
    s_waitcnt lgkmcnt(4)
    v_mfma_f32_16x16x32_bf16 v[168:171], v[236:239], v[64:67], v[168:171]
    v_mfma_f32_16x16x32_bf16 v[172:175], v[236:239], v[68:71], v[172:175]
    ds_read_b64_tr_b16 v[232:233], v10 offset:53248
    ds_read_b64_tr_b16 v[234:235], v10 offset:54272
    s_waitcnt lgkmcnt(4)
    v_mfma_f32_16x16x32_bf16 v[176:179], v[224:227], v[64:67], v[176:179]
    v_mfma_f32_16x16x32_bf16 v[180:183], v[224:227], v[68:71], v[180:183]
    buffer_load_dwordx4 v[100:103], v5, s[28:31], s52 offen
    ds_read_b64_tr_b16 v[236:237], v11 offset:53248
    ds_read_b64_tr_b16 v[238:239], v11 offset:54272
    s_waitcnt lgkmcnt(4)
    v_mfma_f32_16x16x32_bf16 v[184:187], v[228:231], v[64:67], v[184:187]
    v_mfma_f32_16x16x32_bf16 v[188:191], v[228:231], v[68:71], v[188:191]
    ds_read_b64_tr_b16 v[224:225], v8 offset:57344
    ds_read_b64_tr_b16 v[226:227], v8 offset:58368
    s_waitcnt lgkmcnt(4)
    v_mfma_f32_16x16x32_bf16 v[192:195], v[232:235], v[64:67], v[192:195]
    v_mfma_f32_16x16x32_bf16 v[196:199], v[232:235], v[68:71], v[196:199]
    ds_read_b64_tr_b16 v[228:229], v9 offset:57344
    ds_read_b64_tr_b16 v[230:231], v9 offset:58368
    s_waitcnt lgkmcnt(4)
    v_mfma_f32_16x16x32_bf16 v[200:203], v[236:239], v[64:67], v[200:203]
    v_mfma_f32_16x16x32_bf16 v[204:207], v[236:239], v[68:71], v[204:207]
    s_waitcnt vmcnt(9)
    ds_read_b64_tr_b16 v[232:233], v10 offset:57344
    ds_read_b64_tr_b16 v[234:235], v10 offset:58368
    s_waitcnt lgkmcnt(4)
    v_mfma_f32_16x16x32_bf16 v[144:147], v[224:227], v[72:75], v[144:147]
    v_mfma_f32_16x16x32_bf16 v[148:151], v[224:227], v[76:79], v[148:151]
    s_add_u32 m0, s20, 90112
    s_nop 0
    buffer_load_dwordx4 v6, s[24:27], s19 offen lds
    s_lshl_b32 s52, s54, 10
    s_add_u32 s54, s54, 1
    s_and_b32 s54, s54, 15
    s_mul_i32 s19, s54, s18
    ds_read_b64_tr_b16 v[236:237], v11 offset:57344
    ds_read_b64_tr_b16 v[238:239], v11 offset:58368
    s_waitcnt lgkmcnt(4)
    v_mfma_f32_16x16x32_bf16 v[152:155], v[228:231], v[72:75], v[152:155]
    v_mfma_f32_16x16x32_bf16 v[156:159], v[228:231], v[76:79], v[156:159]
    ds_read_b64_tr_b16 v[224:225], v8 offset:61440
    ds_read_b64_tr_b16 v[226:227], v8 offset:62464
    s_waitcnt lgkmcnt(4)
    v_mfma_f32_16x16x32_bf16 v[160:163], v[232:235], v[72:75], v[160:163]
    v_mfma_f32_16x16x32_bf16 v[164:167], v[232:235], v[76:79], v[164:167]
    buffer_load_dwordx4 v[104:107], v4, s[28:31], s52 offen
    ds_read_b64_tr_b16 v[228:229], v9 offset:61440
    ds_read_b64_tr_b16 v[230:231], v9 offset:62464
    s_waitcnt lgkmcnt(4)
    v_mfma_f32_16x16x32_bf16 v[168:171], v[236:239], v[72:75], v[168:171]
    v_mfma_f32_16x16x32_bf16 v[172:175], v[236:239], v[76:79], v[172:175]
    ds_read_b64_tr_b16 v[232:233], v10 offset:61440
    ds_read_b64_tr_b16 v[234:235], v10 offset:62464
    s_waitcnt lgkmcnt(4)
    v_mfma_f32_16x16x32_bf16 v[176:179], v[224:227], v[72:75], v[176:179]
    v_mfma_f32_16x16x32_bf16 v[180:183], v[224:227], v[76:79], v[180:183]
    buffer_load_dwordx4 v[108:111], v5, s[28:31], s52 offen
    ds_read_b64_tr_b16 v[236:237], v11 offset:61440
    ds_read_b64_tr_b16 v[238:239], v11 offset:62464
    s_waitcnt lgkmcnt(4)
    v_mfma_f32_16x16x32_bf16 v[184:187], v[228:231], v[72:75], v[184:187]
    v_mfma_f32_16x16x32_bf16 v[188:191], v[228:231], v[76:79], v[188:191]
    ds_read_b64_tr_b16 v[224:225], v240 offset:0
    ds_read_b64_tr_b16 v[226:227], v240 offset:1024
    s_waitcnt lgkmcnt(4)
    v_mfma_f32_16x16x32_bf16 v[192:195], v[232:235], v[72:75], v[192:195]
    v_mfma_f32_16x16x32_bf16 v[196:199], v[232:235], v[76:79], v[196:199]
    ds_read_b64_tr_b16 v[228:229], v241 offset:0
    ds_read_b64_tr_b16 v[230:231], v241 offset:1024
    s_waitcnt lgkmcnt(4)
    v_mfma_f32_16x16x32_bf16 v[200:203], v[236:239], v[72:75], v[200:203]
    v_mfma_f32_16x16x32_bf16 v[204:207], v[236:239], v[76:79], v[204:207]
    s_waitcnt vmcnt(5)
    s_barrier
    ds_read_b64_tr_b16 v[232:233], v242 offset:0
    ds_read_b64_tr_b16 v[234:235], v242 offset:1024
    s_waitcnt lgkmcnt(4)
    v_mfma_f32_16x16x32_bf16 v[144:147], v[224:227], v[80:83], v[144:147]
    v_mfma_f32_16x16x32_bf16 v[148:151], v[224:227], v[84:87], v[148:151]
    s_add_u32 m0, s20, 98304
    s_nop 0
    buffer_load_dwordx4 v6, s[24:27], s19 offen lds
    s_lshl_b32 s52, s54, 10
    s_add_u32 s54, s54, 1
    s_and_b32 s54, s54, 15
    s_mul_i32 s19, s54, s18
    ds_read_b64_tr_b16 v[236:237], v243 offset:0
    ds_read_b64_tr_b16 v[238:239], v243 offset:1024
    s_waitcnt lgkmcnt(4)
    v_mfma_f32_16x16x32_bf16 v[152:155], v[228:231], v[80:83], v[152:155]
    v_mfma_f32_16x16x32_bf16 v[156:159], v[228:231], v[84:87], v[156:159]
    ds_read_b64_tr_b16 v[224:225], v240 offset:4096
    ds_read_b64_tr_b16 v[226:227], v240 offset:5120
    s_waitcnt lgkmcnt(4)
    v_mfma_f32_16x16x32_bf16 v[160:163], v[232:235], v[80:83], v[160:163]
    v_mfma_f32_16x16x32_bf16 v[164:167], v[232:235], v[84:87], v[164:167]
    buffer_load_dwordx4 v[112:115], v4, s[28:31], s52 offen
    ds_read_b64_tr_b16 v[228:229], v241 offset:4096
    ds_read_b64_tr_b16 v[230:231], v241 offset:5120
    s_waitcnt lgkmcnt(4)
    v_mfma_f32_16x16x32_bf16 v[168:171], v[236:239], v[80:83], v[168:171]
    v_mfma_f32_16x16x32_bf16 v[172:175], v[236:239], v[84:87], v[172:175]
    ds_read_b64_tr_b16 v[232:233], v242 offset:4096
    ds_read_b64_tr_b16 v[234:235], v242 offset:5120
    s_waitcnt lgkmcnt(4)
    v_mfma_f32_16x16x32_bf16 v[176:179], v[224:227], v[80:83], v[176:179]
    v_mfma_f32_16x16x32_bf16 v[180:183], v[224:227], v[84:87], v[180:183]
    buffer_load_dwordx4 v[116:119], v5, s[28:31], s52 offen
    ds_read_b64_tr_b16 v[236:237], v243 offset:4096
    ds_read_b64_tr_b16 v[238:239], v243 offset:5120
    s_waitcnt lgkmcnt(4)
    v_mfma_f32_16x16x32_bf16 v[184:187], v[228:231], v[80:83], v[184:187]
    v_mfma_f32_16x16x32_bf16 v[188:191], v[228:231], v[84:87], v[188:191]
    ds_read_b64_tr_b16 v[224:225], v240 offset:8192
    ds_read_b64_tr_b16 v[226:227], v240 offset:9216
    s_waitcnt lgkmcnt(4)
    v_mfma_f32_16x16x32_bf16 v[192:195], v[232:235], v[80:83], v[192:195]
    v_mfma_f32_16x16x32_bf16 v[196:199], v[232:235], v[84:87], v[196:199]
    ds_read_b64_tr_b16 v[228:229], v241 offset:8192
    ds_read_b64_tr_b16 v[230:231], v241 offset:9216
    s_waitcnt lgkmcnt(4)
    v_mfma_f32_16x16x32_bf16 v[200:203], v[236:239], v[80:83], v[200:203]
    v_mfma_f32_16x16x32_bf16 v[204:207], v[236:239], v[84:87], v[204:207]
    s_waitcnt vmcnt(9)
    ds_read_b64_tr_b16 v[232:233], v242 offset:8192
    ds_read_b64_tr_b16 v[234:235], v242 offset:9216
    s_waitcnt lgkmcnt(4)
    v_mfma_f32_16x16x32_bf16 v[144:147], v[224:227], v[88:91], v[144:147]
    v_mfma_f32_16x16x32_bf16 v[148:151], v[224:227], v[92:95], v[148:151]
    s_add_u32 m0, s20, 106496
    s_nop 0
    buffer_load_dwordx4 v6, s[24:27], s19 offen lds
    s_lshl_b32 s52, s54, 10
    s_add_u32 s54, s54, 1
    s_and_b32 s54, s54, 15
    s_mul_i32 s19, s54, s18
    ds_read_b64_tr_b16 v[236:237], v243 offset:8192
    ds_read_b64_tr_b16 v[238:239], v243 offset:9216
    s_waitcnt lgkmcnt(4)
    v_mfma_f32_16x16x32_bf16 v[152:155], v[228:231], v[88:91], v[152:155]
    v_mfma_f32_16x16x32_bf16 v[156:159], v[228:231], v[92:95], v[156:159]
    ds_read_b64_tr_b16 v[224:225], v240 offset:12288
    ds_read_b64_tr_b16 v[226:227], v240 offset:13312
    s_waitcnt lgkmcnt(4)
    v_mfma_f32_16x16x32_bf16 v[160:163], v[232:235], v[88:91], v[160:163]
    v_mfma_f32_16x16x32_bf16 v[164:167], v[232:235], v[92:95], v[164:167]
    buffer_load_dwordx4 v[120:123], v4, s[28:31], s52 offen
    ds_read_b64_tr_b16 v[228:229], v241 offset:12288
    ds_read_b64_tr_b16 v[230:231], v241 offset:13312
    s_waitcnt lgkmcnt(4)
    v_mfma_f32_16x16x32_bf16 v[168:171], v[236:239], v[88:91], v[168:171]
    v_mfma_f32_16x16x32_bf16 v[172:175], v[236:239], v[92:95], v[172:175]
    ds_read_b64_tr_b16 v[232:233], v242 offset:12288
    ds_read_b64_tr_b16 v[234:235], v242 offset:13312
    s_waitcnt lgkmcnt(4)
    v_mfma_f32_16x16x32_bf16 v[176:179], v[224:227], v[88:91], v[176:179]
    v_mfma_f32_16x16x32_bf16 v[180:183], v[224:227], v[92:95], v[180:183]
    buffer_load_dwordx4 v[124:127], v5, s[28:31], s52 offen
    ds_read_b64_tr_b16 v[236:237], v243 offset:12288
    ds_read_b64_tr_b16 v[238:239], v243 offset:13312
    s_waitcnt lgkmcnt(4)
    v_mfma_f32_16x16x32_bf16 v[184:187], v[228:231], v[88:91], v[184:187]
    v_mfma_f32_16x16x32_bf16 v[188:191], v[228:231], v[92:95], v[188:191]
    ds_read_b64_tr_b16 v[224:225], v240 offset:16384
    ds_read_b64_tr_b16 v[226:227], v240 offset:17408
    s_waitcnt lgkmcnt(4)
    v_mfma_f32_16x16x32_bf16 v[192:195], v[232:235], v[88:91], v[192:195]
    v_mfma_f32_16x16x32_bf16 v[196:199], v[232:235], v[92:95], v[196:199]
    ds_read_b64_tr_b16 v[228:229], v241 offset:16384
    ds_read_b64_tr_b16 v[230:231], v241 offset:17408
    s_waitcnt lgkmcnt(4)
    v_mfma_f32_16x16x32_bf16 v[200:203], v[236:239], v[88:91], v[200:203]
    v_mfma_f32_16x16x32_bf16 v[204:207], v[236:239], v[92:95], v[204:207]
    s_waitcnt vmcnt(5)
    s_barrier
    ds_read_b64_tr_b16 v[232:233], v242 offset:16384
    ds_read_b64_tr_b16 v[234:235], v242 offset:17408
    s_waitcnt lgkmcnt(4)
    v_mfma_f32_16x16x32_bf16 v[144:147], v[224:227], v[96:99], v[144:147]
    v_mfma_f32_16x16x32_bf16 v[148:151], v[224:227], v[100:103], v[148:151]
    s_add_u32 m0, s20, 114688
    s_nop 0
    buffer_load_dwordx4 v6, s[24:27], s19 offen lds
    s_lshl_b32 s52, s54, 10
    s_add_u32 s54, s54, 1
    s_and_b32 s54, s54, 15
    s_mul_i32 s19, s54, s18
    ds_read_b64_tr_b16 v[236:237], v243 offset:16384
    ds_read_b64_tr_b16 v[238:239], v243 offset:17408
    s_waitcnt lgkmcnt(4)
    v_mfma_f32_16x16x32_bf16 v[152:155], v[228:231], v[96:99], v[152:155]
    v_mfma_f32_16x16x32_bf16 v[156:159], v[228:231], v[100:103], v[156:159]
    ds_read_b64_tr_b16 v[224:225], v240 offset:20480
    ds_read_b64_tr_b16 v[226:227], v240 offset:21504
    s_waitcnt lgkmcnt(4)
    v_mfma_f32_16x16x32_bf16 v[160:163], v[232:235], v[96:99], v[160:163]
    v_mfma_f32_16x16x32_bf16 v[164:167], v[232:235], v[100:103], v[164:167]
    buffer_load_dwordx4 v[128:131], v4, s[28:31], s52 offen
    ds_read_b64_tr_b16 v[228:229], v241 offset:20480
    ds_read_b64_tr_b16 v[230:231], v241 offset:21504
    s_waitcnt lgkmcnt(4)
    v_mfma_f32_16x16x32_bf16 v[168:171], v[236:239], v[96:99], v[168:171]
    v_mfma_f32_16x16x32_bf16 v[172:175], v[236:239], v[100:103], v[172:175]
    ds_read_b64_tr_b16 v[232:233], v242 offset:20480
    ds_read_b64_tr_b16 v[234:235], v242 offset:21504
    s_waitcnt lgkmcnt(4)
    v_mfma_f32_16x16x32_bf16 v[176:179], v[224:227], v[96:99], v[176:179]
    v_mfma_f32_16x16x32_bf16 v[180:183], v[224:227], v[100:103], v[180:183]
    buffer_load_dwordx4 v[132:135], v5, s[28:31], s52 offen
    ds_read_b64_tr_b16 v[236:237], v243 offset:20480
    ds_read_b64_tr_b16 v[238:239], v243 offset:21504
    s_waitcnt lgkmcnt(4)
    v_mfma_f32_16x16x32_bf16 v[184:187], v[228:231], v[96:99], v[184:187]
    v_mfma_f32_16x16x32_bf16 v[188:191], v[228:231], v[100:103], v[188:191]
    ds_read_b64_tr_b16 v[224:225], v240 offset:24576
    ds_read_b64_tr_b16 v[226:227], v240 offset:25600
    s_waitcnt lgkmcnt(4)
    v_mfma_f32_16x16x32_bf16 v[192:195], v[232:235], v[96:99], v[192:195]
    v_mfma_f32_16x16x32_bf16 v[196:199], v[232:235], v[100:103], v[196:199]
    ds_read_b64_tr_b16 v[228:229], v241 offset:24576
    ds_read_b64_tr_b16 v[230:231], v241 offset:25600
    s_waitcnt lgkmcnt(4)
    v_mfma_f32_16x16x32_bf16 v[200:203], v[236:239], v[96:99], v[200:203]
    v_mfma_f32_16x16x32_bf16 v[204:207], v[236:239], v[100:103], v[204:207]
    s_waitcnt vmcnt(9)
    ds_read_b64_tr_b16 v[232:233], v242 offset:24576
    ds_read_b64_tr_b16 v[234:235], v242 offset:25600
    s_waitcnt lgkmcnt(4)
    v_mfma_f32_16x16x32_bf16 v[144:147], v[224:227], v[104:107], v[144:147]
    v_mfma_f32_16x16x32_bf16 v[148:151], v[224:227], v[108:111], v[148:151]
    s_add_u32 m0, s20, 122880
    s_nop 0
    buffer_load_dwordx4 v6, s[24:27], s19 offen lds
    s_lshl_b32 s52, s54, 10
    s_add_u32 s54, s54, 1
    s_and_b32 s54, s54, 15
    s_mul_i32 s19, s54, s18
    ds_read_b64_tr_b16 v[236:237], v243 offset:24576
    ds_read_b64_tr_b16 v[238:239], v243 offset:25600
    s_waitcnt lgkmcnt(4)
    v_mfma_f32_16x16x32_bf16 v[152:155], v[228:231], v[104:107], v[152:155]
    v_mfma_f32_16x16x32_bf16 v[156:159], v[228:231], v[108:111], v[156:159]
    ds_read_b64_tr_b16 v[224:225], v240 offset:28672
    ds_read_b64_tr_b16 v[226:227], v240 offset:29696
    s_waitcnt lgkmcnt(4)
    v_mfma_f32_16x16x32_bf16 v[160:163], v[232:235], v[104:107], v[160:163]
    v_mfma_f32_16x16x32_bf16 v[164:167], v[232:235], v[108:111], v[164:167]
    buffer_load_dwordx4 v[136:139], v4, s[28:31], s52 offen
    ds_read_b64_tr_b16 v[228:229], v241 offset:28672
    ds_read_b64_tr_b16 v[230:231], v241 offset:29696
    s_waitcnt lgkmcnt(4)
    v_mfma_f32_16x16x32_bf16 v[168:171], v[236:239], v[104:107], v[168:171]
    v_mfma_f32_16x16x32_bf16 v[172:175], v[236:239], v[108:111], v[172:175]
    ds_read_b64_tr_b16 v[232:233], v242 offset:28672
    ds_read_b64_tr_b16 v[234:235], v242 offset:29696
    s_waitcnt lgkmcnt(4)
    v_mfma_f32_16x16x32_bf16 v[176:179], v[224:227], v[104:107], v[176:179]
    v_mfma_f32_16x16x32_bf16 v[180:183], v[224:227], v[108:111], v[180:183]
    buffer_load_dwordx4 v[140:143], v5, s[28:31], s52 offen
    ds_read_b64_tr_b16 v[236:237], v243 offset:28672
    ds_read_b64_tr_b16 v[238:239], v243 offset:29696
    s_waitcnt lgkmcnt(4)
    v_mfma_f32_16x16x32_bf16 v[184:187], v[228:231], v[104:107], v[184:187]
    v_mfma_f32_16x16x32_bf16 v[188:191], v[228:231], v[108:111], v[188:191]
    ds_read_b64_tr_b16 v[224:225], v240 offset:32768
    ds_read_b64_tr_b16 v[226:227], v240 offset:33792
    s_waitcnt lgkmcnt(4)
    v_mfma_f32_16x16x32_bf16 v[192:195], v[232:235], v[104:107], v[192:195]
    v_mfma_f32_16x16x32_bf16 v[196:199], v[232:235], v[108:111], v[196:199]
    ds_read_b64_tr_b16 v[228:229], v241 offset:32768
    ds_read_b64_tr_b16 v[230:231], v241 offset:33792
    s_waitcnt lgkmcnt(4)
    v_mfma_f32_16x16x32_bf16 v[200:203], v[236:239], v[104:107], v[200:203]
    v_mfma_f32_16x16x32_bf16 v[204:207], v[236:239], v[108:111], v[204:207]
    s_waitcnt vmcnt(5)
    s_barrier
    ds_read_b64_tr_b16 v[232:233], v242 offset:32768
    ds_read_b64_tr_b16 v[234:235], v242 offset:33792
    s_waitcnt lgkmcnt(4)
    v_mfma_f32_16x16x32_bf16 v[144:147], v[224:227], v[112:115], v[144:147]
    v_mfma_f32_16x16x32_bf16 v[148:151], v[224:227], v[116:119], v[148:151]
    ds_read_b64_tr_b16 v[236:237], v243 offset:32768
    ds_read_b64_tr_b16 v[238:239], v243 offset:33792
    s_waitcnt lgkmcnt(4)
    v_mfma_f32_16x16x32_bf16 v[152:155], v[228:231], v[112:115], v[152:155]
    v_mfma_f32_16x16x32_bf16 v[156:159], v[228:231], v[116:119], v[156:159]
    ds_read_b64_tr_b16 v[224:225], v240 offset:36864
    ds_read_b64_tr_b16 v[226:227], v240 offset:37888
    s_waitcnt lgkmcnt(4)
    v_mfma_f32_16x16x32_bf16 v[160:163], v[232:235], v[112:115], v[160:163]
    v_mfma_f32_16x16x32_bf16 v[164:167], v[232:235], v[116:119], v[164:167]
    ds_read_b64_tr_b16 v[228:229], v241 offset:36864
    ds_read_b64_tr_b16 v[230:231], v241 offset:37888
    s_waitcnt lgkmcnt(4)
    v_mfma_f32_16x16x32_bf16 v[168:171], v[236:239], v[112:115], v[168:171]
    v_mfma_f32_16x16x32_bf16 v[172:175], v[236:239], v[116:119], v[172:175]
    ds_read_b64_tr_b16 v[232:233], v242 offset:36864
    ds_read_b64_tr_b16 v[234:235], v242 offset:37888
    s_waitcnt lgkmcnt(4)
    v_mfma_f32_16x16x32_bf16 v[176:179], v[224:227], v[112:115], v[176:179]
    v_mfma_f32_16x16x32_bf16 v[180:183], v[224:227], v[116:119], v[180:183]
    ds_read_b64_tr_b16 v[236:237], v243 offset:36864
    ds_read_b64_tr_b16 v[238:239], v243 offset:37888
    s_waitcnt lgkmcnt(4)
    v_mfma_f32_16x16x32_bf16 v[184:187], v[228:231], v[112:115], v[184:187]
    v_mfma_f32_16x16x32_bf16 v[188:191], v[228:231], v[116:119], v[188:191]
    ds_read_b64_tr_b16 v[224:225], v240 offset:40960
    ds_read_b64_tr_b16 v[226:227], v240 offset:41984
    s_waitcnt lgkmcnt(4)
    v_mfma_f32_16x16x32_bf16 v[192:195], v[232:235], v[112:115], v[192:195]
    v_mfma_f32_16x16x32_bf16 v[196:199], v[232:235], v[116:119], v[196:199]
    ds_read_b64_tr_b16 v[228:229], v241 offset:40960
    ds_read_b64_tr_b16 v[230:231], v241 offset:41984
    s_waitcnt lgkmcnt(4)
    v_mfma_f32_16x16x32_bf16 v[200:203], v[236:239], v[112:115], v[200:203]
    v_mfma_f32_16x16x32_bf16 v[204:207], v[236:239], v[116:119], v[204:207]
    s_waitcnt vmcnt(6)
    ds_read_b64_tr_b16 v[232:233], v242 offset:40960
    ds_read_b64_tr_b16 v[234:235], v242 offset:41984
    s_waitcnt lgkmcnt(4)
    v_mfma_f32_16x16x32_bf16 v[144:147], v[224:227], v[120:123], v[144:147]
    v_mfma_f32_16x16x32_bf16 v[148:151], v[224:227], v[124:127], v[148:151]
    ds_read_b64_tr_b16 v[236:237], v243 offset:40960
    ds_read_b64_tr_b16 v[238:239], v243 offset:41984
    s_waitcnt lgkmcnt(4)
    v_mfma_f32_16x16x32_bf16 v[152:155], v[228:231], v[120:123], v[152:155]
    v_mfma_f32_16x16x32_bf16 v[156:159], v[228:231], v[124:127], v[156:159]
    ds_read_b64_tr_b16 v[224:225], v240 offset:45056
    ds_read_b64_tr_b16 v[226:227], v240 offset:46080
    s_waitcnt lgkmcnt(4)
    v_mfma_f32_16x16x32_bf16 v[160:163], v[232:235], v[120:123], v[160:163]
    v_mfma_f32_16x16x32_bf16 v[164:167], v[232:235], v[124:127], v[164:167]
    ds_read_b64_tr_b16 v[228:229], v241 offset:45056
    ds_read_b64_tr_b16 v[230:231], v241 offset:46080
    s_waitcnt lgkmcnt(4)
    v_mfma_f32_16x16x32_bf16 v[168:171], v[236:239], v[120:123], v[168:171]
    v_mfma_f32_16x16x32_bf16 v[172:175], v[236:239], v[124:127], v[172:175]
    ds_read_b64_tr_b16 v[232:233], v242 offset:45056
    ds_read_b64_tr_b16 v[234:235], v242 offset:46080
    s_waitcnt lgkmcnt(4)
    v_mfma_f32_16x16x32_bf16 v[176:179], v[224:227], v[120:123], v[176:179]
    v_mfma_f32_16x16x32_bf16 v[180:183], v[224:227], v[124:127], v[180:183]
    ds_read_b64_tr_b16 v[236:237], v243 offset:45056
    ds_read_b64_tr_b16 v[238:239], v243 offset:46080
    s_waitcnt lgkmcnt(4)
    v_mfma_f32_16x16x32_bf16 v[184:187], v[228:231], v[120:123], v[184:187]
    v_mfma_f32_16x16x32_bf16 v[188:191], v[228:231], v[124:127], v[188:191]
    ds_read_b64_tr_b16 v[224:225], v240 offset:49152
    ds_read_b64_tr_b16 v[226:227], v240 offset:50176
    s_waitcnt lgkmcnt(4)
    v_mfma_f32_16x16x32_bf16 v[192:195], v[232:235], v[120:123], v[192:195]
    v_mfma_f32_16x16x32_bf16 v[196:199], v[232:235], v[124:127], v[196:199]
    ds_read_b64_tr_b16 v[228:229], v241 offset:49152
    ds_read_b64_tr_b16 v[230:231], v241 offset:50176
    s_waitcnt lgkmcnt(4)
    v_mfma_f32_16x16x32_bf16 v[200:203], v[236:239], v[120:123], v[200:203]
    v_mfma_f32_16x16x32_bf16 v[204:207], v[236:239], v[124:127], v[204:207]
    s_waitcnt vmcnt(2)
    s_barrier
    ds_read_b64_tr_b16 v[232:233], v242 offset:49152
    ds_read_b64_tr_b16 v[234:235], v242 offset:50176
    s_waitcnt lgkmcnt(4)
    v_mfma_f32_16x16x32_bf16 v[144:147], v[224:227], v[128:131], v[144:147]
    v_mfma_f32_16x16x32_bf16 v[148:151], v[224:227], v[132:135], v[148:151]
    ds_read_b64_tr_b16 v[236:237], v243 offset:49152
    ds_read_b64_tr_b16 v[238:239], v243 offset:50176
    s_waitcnt lgkmcnt(4)
    v_mfma_f32_16x16x32_bf16 v[152:155], v[228:231], v[128:131], v[152:155]
    v_mfma_f32_16x16x32_bf16 v[156:159], v[228:231], v[132:135], v[156:159]
    ds_read_b64_tr_b16 v[224:225], v240 offset:53248
    ds_read_b64_tr_b16 v[226:227], v240 offset:54272
    s_waitcnt lgkmcnt(4)
    v_mfma_f32_16x16x32_bf16 v[160:163], v[232:235], v[128:131], v[160:163]
    v_mfma_f32_16x16x32_bf16 v[164:167], v[232:235], v[132:135], v[164:167]
    ds_read_b64_tr_b16 v[228:229], v241 offset:53248
    ds_read_b64_tr_b16 v[230:231], v241 offset:54272
    s_waitcnt lgkmcnt(4)
    v_mfma_f32_16x16x32_bf16 v[168:171], v[236:239], v[128:131], v[168:171]
    v_mfma_f32_16x16x32_bf16 v[172:175], v[236:239], v[132:135], v[172:175]
    ds_read_b64_tr_b16 v[232:233], v242 offset:53248
    ds_read_b64_tr_b16 v[234:235], v242 offset:54272
    s_waitcnt lgkmcnt(4)
    v_mfma_f32_16x16x32_bf16 v[176:179], v[224:227], v[128:131], v[176:179]
    v_mfma_f32_16x16x32_bf16 v[180:183], v[224:227], v[132:135], v[180:183]
    ds_read_b64_tr_b16 v[236:237], v243 offset:53248
    ds_read_b64_tr_b16 v[238:239], v243 offset:54272
    s_waitcnt lgkmcnt(4)
    v_mfma_f32_16x16x32_bf16 v[184:187], v[228:231], v[128:131], v[184:187]
    v_mfma_f32_16x16x32_bf16 v[188:191], v[228:231], v[132:135], v[188:191]
    ds_read_b64_tr_b16 v[224:225], v240 offset:57344
    ds_read_b64_tr_b16 v[226:227], v240 offset:58368
    s_waitcnt lgkmcnt(4)
    v_mfma_f32_16x16x32_bf16 v[192:195], v[232:235], v[128:131], v[192:195]
    v_mfma_f32_16x16x32_bf16 v[196:199], v[232:235], v[132:135], v[196:199]
    ds_read_b64_tr_b16 v[228:229], v241 offset:57344
    ds_read_b64_tr_b16 v[230:231], v241 offset:58368
    s_waitcnt lgkmcnt(4)
    v_mfma_f32_16x16x32_bf16 v[200:203], v[236:239], v[128:131], v[200:203]
    v_mfma_f32_16x16x32_bf16 v[204:207], v[236:239], v[132:135], v[204:207]
    s_waitcnt vmcnt(0)
    ds_read_b64_tr_b16 v[232:233], v242 offset:57344
    ds_read_b64_tr_b16 v[234:235], v242 offset:58368
    s_waitcnt lgkmcnt(4)
    v_mfma_f32_16x16x32_bf16 v[144:147], v[224:227], v[136:139], v[144:147]
    v_mfma_f32_16x16x32_bf16 v[148:151], v[224:227], v[140:143], v[148:151]
    ds_read_b64_tr_b16 v[236:237], v243 offset:57344
    ds_read_b64_tr_b16 v[238:239], v243 offset:58368
    s_waitcnt lgkmcnt(4)
    v_mfma_f32_16x16x32_bf16 v[152:155], v[228:231], v[136:139], v[152:155]
    v_mfma_f32_16x16x32_bf16 v[156:159], v[228:231], v[140:143], v[156:159]
    ds_read_b64_tr_b16 v[224:225], v240 offset:61440
    ds_read_b64_tr_b16 v[226:227], v240 offset:62464
    s_waitcnt lgkmcnt(4)
    v_mfma_f32_16x16x32_bf16 v[160:163], v[232:235], v[136:139], v[160:163]
    v_mfma_f32_16x16x32_bf16 v[164:167], v[232:235], v[140:143], v[164:167]
    ds_read_b64_tr_b16 v[228:229], v241 offset:61440
    ds_read_b64_tr_b16 v[230:231], v241 offset:62464
    s_waitcnt lgkmcnt(4)
    v_mfma_f32_16x16x32_bf16 v[168:171], v[236:239], v[136:139], v[168:171]
    v_mfma_f32_16x16x32_bf16 v[172:175], v[236:239], v[140:143], v[172:175]
    ds_read_b64_tr_b16 v[232:233], v242 offset:61440
    ds_read_b64_tr_b16 v[234:235], v242 offset:62464
    s_waitcnt lgkmcnt(4)
    v_mfma_f32_16x16x32_bf16 v[176:179], v[224:227], v[136:139], v[176:179]
    v_mfma_f32_16x16x32_bf16 v[180:183], v[224:227], v[140:143], v[180:183]
    ds_read_b64_tr_b16 v[236:237], v243 offset:61440
    ds_read_b64_tr_b16 v[238:239], v243 offset:62464
    s_waitcnt lgkmcnt(4)
    v_mfma_f32_16x16x32_bf16 v[184:187], v[228:231], v[136:139], v[184:187]
    v_mfma_f32_16x16x32_bf16 v[188:191], v[228:231], v[140:143], v[188:191]
    s_waitcnt lgkmcnt(2)
    v_mfma_f32_16x16x32_bf16 v[192:195], v[232:235], v[136:139], v[192:195]
    v_mfma_f32_16x16x32_bf16 v[196:199], v[232:235], v[140:143], v[196:199]
    s_waitcnt lgkmcnt(0)
    v_mfma_f32_16x16x32_bf16 v[200:203], v[236:239], v[136:139], v[200:203]
    v_mfma_f32_16x16x32_bf16 v[204:207], v[236:239], v[140:143], v[204:207]
    s_waitcnt vmcnt(0)
    s_cmp_lt_u32 s14, 4
    s_cbranch_scc0 K1_gu4_epi
    s_add_u32 s32, s12, 0x200000
    s_addc_u32 s33, s13, 0
    s_mov_b32 s34, 0x400000
    s_mov_b32 s35, 0x00020000
    v_lshrrev_b32 v12, 1, v3
    v_lshl_add_u32 v12, v12, 4, v2
    v_lshlrev_b32 v12, 4, v12
    v_and_b32 v13, 1, v3
    v_mul_u32_u24 v13, 32768, v13
    v_add_u32 v12, v13, v12
    s_lshl_b32 s3, s46, 11
    s_lshl_b32 s49, s14, 13
    s_add_u32 s3, s3, s49
    v_add_u32 v12, s3, v12
    v_add_u32 v13, 0x1000, v12
    v_lshrrev_b32 v16, 2, v2
    v_lshl_add_u32 v16, v3, 2, v16
    v_lshlrev_b32 v16, 5, v16
    v_and_b32 v17, 3, v1
    v_lshl_add_u32 v16, v17, 3, v16
    v_add_u32 v16, 131072, v16
    ds_read_b64_tr_b16 v[240:241], v16 offset:0
    ds_read_b64_tr_b16 v[242:243], v16 offset:512
    ds_read_b64_tr_b16 v[244:245], v16 offset:1024
    ds_read_b64_tr_b16 v[246:247], v16 offset:1536
    ds_read_b64_tr_b16 v[248:249], v16 offset:2048
    ds_read_b64_tr_b16 v[250:251], v16 offset:2560
    ds_read_b64_tr_b16 v[252:253], v16 offset:3072
    ds_read_b64_tr_b16 v[254:255], v16 offset:3584
    s_waitcnt lgkmcnt(0)
    s_mov_b32 s53, 0x3fb8aa3b
    v_cvt_pk_bf16_f32 v48, v144, v145
    v_cvt_pk_bf16_f32 v49, v146, v147
    v_cvt_pk_bf16_f32 v50, v148, v149
    v_cvt_pk_bf16_f32 v51, v150, v151
    v_mfma_f32_16x16x16_bf16 v[52:55], v[240:241], v[48:49], 0
    s_nop 0
    v_mfma_f32_16x16x16_bf16 v[68:71], v[240:241], v[50:51], 0
    s_nop 5
    v_cvt_pk_bf16_f32 v48, v52, v53
    v_cvt_pk_bf16_f32 v49, v54, v55
    v_cvt_pk_bf16_f32 v50, v68, v69
    v_cvt_pk_bf16_f32 v51, v70, v71
    v_lshlrev_b32 v52, 16, v48
    v_and_b32 v53, 0xffff0000, v48
    v_lshlrev_b32 v54, 16, v49
    v_and_b32 v55, 0xffff0000, v49
    v_lshlrev_b32 v68, 16, v50
    v_and_b32 v69, 0xffff0000, v50
    v_lshlrev_b32 v70, 16, v51
    v_and_b32 v71, 0xffff0000, v51
    v_max3_f32 v56, v52, v53, v54
    v_min3_f32 v57, v52, v53, v54
    v_max3_f32 v72, v68, v69, v70
    v_min3_f32 v73, v68, v69, v70
    v_max_f32 v56, v56, v55
    v_max_f32 v57, -v57, -v55
    v_max_f32 v72, v72, v71
    v_max_f32 v73, -v73, -v71
    v_permlane32_swap_b32 v56, v57
    s_nop 0
    v_permlane32_swap_b32 v72, v73
    v_max_f32 v56, v56, v57
    v_max_f32 v72, v72, v73
    v_mov_b32 v58, v56
    v_mov_b32 v74, v72
    s_nop 0
    v_permlane16_swap_b32 v56, v58
    v_permlane16_swap_b32 v72, v74
    v_max_f32 v56, v56, v58
    v_max_f32 v72, v72, v74
    v_mov_b32 v57, v56
    v_mov_b32 v73, v72
    s_nop 0
    v_permlane32_swap_b32 v56, v57
    v_permlane32_swap_b32 v72, v73
    v_mul_f32 v56, s53, v56
    v_mul_f32 v57, s53, v57
    v_mul_f32 v72, s53, v72
    v_mul_f32 v73, s53, v73
    v_fma_f32 v60, v52, s53, -v56
    v_fma_f32 v64, -v52, s53, -v57
    v_fma_f32 v61, v53, s53, -v56
    v_fma_f32 v65, -v53, s53, -v57
    v_fma_f32 v62, v54, s53, -v56
    v_fma_f32 v66, -v54, s53, -v57
    v_fma_f32 v63, v55, s53, -v56
    v_fma_f32 v67, -v55, s53, -v57
    v_fma_f32 v76, v68, s53, -v72
    v_fma_f32 v80, -v68, s53, -v73
    v_fma_f32 v77, v69, s53, -v72
    v_fma_f32 v81, -v69, s53, -v73
    v_fma_f32 v78, v70, s53, -v72
    v_fma_f32 v82, -v70, s53, -v73
    v_fma_f32 v79, v71, s53, -v72
    v_fma_f32 v83, -v71, s53, -v73
    v_exp_f32 v60, v60
    v_exp_f32 v61, v61
    v_exp_f32 v62, v62
    v_exp_f32 v63, v63
    v_exp_f32 v64, v64
    v_exp_f32 v65, v65
    v_exp_f32 v66, v66
    v_exp_f32 v67, v67
    v_exp_f32 v76, v76
    v_exp_f32 v77, v77
    v_exp_f32 v78, v78
    v_exp_f32 v79, v79
    v_exp_f32 v80, v80
    v_exp_f32 v81, v81
    v_exp_f32 v82, v82
    v_exp_f32 v83, v83
    v_add_f32 v56, v60, v61
    v_add_f32 v57, v64, v65
    v_add_f32 v58, v62, v63
    v_add_f32 v59, v66, v67
    v_add_f32 v72, v76, v77
    v_add_f32 v73, v80, v81
    v_add_f32 v74, v78, v79
    v_add_f32 v75, v82, v83
    v_add_f32 v56, v56, v58
    v_add_f32 v57, v57, v59
    v_add_f32 v72, v72, v74
    v_add_f32 v73, v73, v75
    v_permlane32_swap_b32 v56, v57
    s_nop 0
    v_permlane32_swap_b32 v72, v73
    v_add_f32 v56, v56, v57
    v_add_f32 v72, v72, v73
    v_mov_b32 v58, v56
    v_mov_b32 v74, v72
    s_nop 0
    v_permlane16_swap_b32 v56, v58
    v_permlane16_swap_b32 v72, v74
    v_add_f32 v56, v56, v58
    v_add_f32 v72, v72, v74
    v_mov_b32 v57, v56
    v_mov_b32 v73, v72
    s_nop 0
    v_permlane32_swap_b32 v56, v57
    v_permlane32_swap_b32 v72, v73
    v_rcp_f32 v56, v56
    v_rcp_f32 v57, v57
    v_rcp_f32 v72, v72
    v_rcp_f32 v73, v73
    v_mul_f32 v60, v60, v56
    v_mul_f32 v64, v64, v57
    v_mul_f32 v61, v61, v56
    v_mul_f32 v65, v65, v57
    v_mul_f32 v62, v62, v56
    v_mul_f32 v66, v66, v57
    v_mul_f32 v63, v63, v56
    v_mul_f32 v67, v67, v57
    v_mul_f32 v76, v76, v72
    v_mul_f32 v80, v80, v73
    v_mul_f32 v77, v77, v72
    v_mul_f32 v81, v81, v73
    v_mul_f32 v78, v78, v72
    v_mul_f32 v82, v82, v73
    v_mul_f32 v79, v79, v72
    v_mul_f32 v83, v83, v73
    v_cvt_pk_bf16_f32 v88, v60, v61
    v_cvt_pk_bf16_f32 v89, v62, v63
    v_cvt_pk_bf16_f32 v92, v64, v65
    v_cvt_pk_bf16_f32 v93, v66, v67
    v_cvt_pk_bf16_f32 v90, v76, v77
    v_cvt_pk_bf16_f32 v91, v78, v79
    v_cvt_pk_bf16_f32 v94, v80, v81
    v_cvt_pk_bf16_f32 v95, v82, v83
    v_permlane16_swap_b32 v88, v90
    v_permlane16_swap_b32 v89, v91
    v_permlane16_swap_b32 v92, v94
    v_permlane16_swap_b32 v93, v95
    buffer_store_dwordx4 v[88:91], v12, s[32:35], 0 offen offset:0 sc1
    buffer_store_dwordx4 v[92:95], v12, s[32:35], 0 offen offset:512 sc1
    v_cvt_pk_bf16_f32 v96, v152, v153
    v_cvt_pk_bf16_f32 v97, v154, v155
    v_cvt_pk_bf16_f32 v98, v156, v157
    v_cvt_pk_bf16_f32 v99, v158, v159
    v_mfma_f32_16x16x16_bf16 v[100:103], v[242:243], v[96:97], 0
    s_nop 0
    v_mfma_f32_16x16x16_bf16 v[116:119], v[242:243], v[98:99], 0
    s_nop 5
    v_cvt_pk_bf16_f32 v96, v100, v101
    v_cvt_pk_bf16_f32 v97, v102, v103
    v_cvt_pk_bf16_f32 v98, v116, v117
    v_cvt_pk_bf16_f32 v99, v118, v119
    v_lshlrev_b32 v100, 16, v96
    v_and_b32 v101, 0xffff0000, v96
    v_lshlrev_b32 v102, 16, v97
    v_and_b32 v103, 0xffff0000, v97
    v_lshlrev_b32 v116, 16, v98
    v_and_b32 v117, 0xffff0000, v98
    v_lshlrev_b32 v118, 16, v99
    v_and_b32 v119, 0xffff0000, v99
    v_max3_f32 v104, v100, v101, v102
    v_min3_f32 v105, v100, v101, v102
    v_max3_f32 v120, v116, v117, v118
    v_min3_f32 v121, v116, v117, v118
    v_max_f32 v104, v104, v103
    v_max_f32 v105, -v105, -v103
    v_max_f32 v120, v120, v119
    v_max_f32 v121, -v121, -v119
    v_permlane32_swap_b32 v104, v105
    s_nop 0
    v_permlane32_swap_b32 v120, v121
    v_max_f32 v104, v104, v105
    v_max_f32 v120, v120, v121
    v_mov_b32 v106, v104
    v_mov_b32 v122, v120
    s_nop 0
    v_permlane16_swap_b32 v104, v106
    v_permlane16_swap_b32 v120, v122
    v_max_f32 v104, v104, v106
    v_max_f32 v120, v120, v122
    v_mov_b32 v105, v104
    v_mov_b32 v121, v120
    s_nop 0
    v_permlane32_swap_b32 v104, v105
    v_permlane32_swap_b32 v120, v121
    v_mul_f32 v104, s53, v104
    v_mul_f32 v105, s53, v105
    v_mul_f32 v120, s53, v120
    v_mul_f32 v121, s53, v121
    v_fma_f32 v108, v100, s53, -v104
    v_fma_f32 v112, -v100, s53, -v105
    v_fma_f32 v109, v101, s53, -v104
    v_fma_f32 v113, -v101, s53, -v105
    v_fma_f32 v110, v102, s53, -v104
    v_fma_f32 v114, -v102, s53, -v105
    v_fma_f32 v111, v103, s53, -v104
    v_fma_f32 v115, -v103, s53, -v105
    v_fma_f32 v124, v116, s53, -v120
    v_fma_f32 v128, -v116, s53, -v121
    v_fma_f32 v125, v117, s53, -v120
    v_fma_f32 v129, -v117, s53, -v121
    v_fma_f32 v126, v118, s53, -v120
    v_fma_f32 v130, -v118, s53, -v121
    v_fma_f32 v127, v119, s53, -v120
    v_fma_f32 v131, -v119, s53, -v121
    v_exp_f32 v108, v108
    v_exp_f32 v109, v109
    v_exp_f32 v110, v110
    v_exp_f32 v111, v111
    v_exp_f32 v112, v112
    v_exp_f32 v113, v113
    v_exp_f32 v114, v114
    v_exp_f32 v115, v115
    v_exp_f32 v124, v124
    v_exp_f32 v125, v125
    v_exp_f32 v126, v126
    v_exp_f32 v127, v127
    v_exp_f32 v128, v128
    v_exp_f32 v129, v129
    v_exp_f32 v130, v130
    v_exp_f32 v131, v131
    v_add_f32 v104, v108, v109
    v_add_f32 v105, v112, v113
    v_add_f32 v106, v110, v111
    v_add_f32 v107, v114, v115
    v_add_f32 v120, v124, v125
    v_add_f32 v121, v128, v129
    v_add_f32 v122, v126, v127
    v_add_f32 v123, v130, v131
    v_add_f32 v104, v104, v106
    v_add_f32 v105, v105, v107
    v_add_f32 v120, v120, v122
    v_add_f32 v121, v121, v123
    v_permlane32_swap_b32 v104, v105
    s_nop 0
    v_permlane32_swap_b32 v120, v121
    v_add_f32 v104, v104, v105
    v_add_f32 v120, v120, v121
    v_mov_b32 v106, v104
    v_mov_b32 v122, v120
    s_nop 0
    v_permlane16_swap_b32 v104, v106
    v_permlane16_swap_b32 v120, v122
    v_add_f32 v104, v104, v106
    v_add_f32 v120, v120, v122
    v_mov_b32 v105, v104
    v_mov_b32 v121, v120
    s_nop 0
    v_permlane32_swap_b32 v104, v105
    v_permlane32_swap_b32 v120, v121
    v_rcp_f32 v104, v104
    v_rcp_f32 v105, v105
    v_rcp_f32 v120, v120
    v_rcp_f32 v121, v121
    v_mul_f32 v108, v108, v104
    v_mul_f32 v112, v112, v105
    v_mul_f32 v109, v109, v104
    v_mul_f32 v113, v113, v105
    v_mul_f32 v110, v110, v104
    v_mul_f32 v114, v114, v105
    v_mul_f32 v111, v111, v104
    v_mul_f32 v115, v115, v105
    v_mul_f32 v124, v124, v120
    v_mul_f32 v128, v128, v121
    v_mul_f32 v125, v125, v120
    v_mul_f32 v129, v129, v121
    v_mul_f32 v126, v126, v120
    v_mul_f32 v130, v130, v121
    v_mul_f32 v127, v127, v120
    v_mul_f32 v131, v131, v121
    v_cvt_pk_bf16_f32 v136, v108, v109
    v_cvt_pk_bf16_f32 v137, v110, v111
    v_cvt_pk_bf16_f32 v140, v112, v113
    v_cvt_pk_bf16_f32 v141, v114, v115
    v_cvt_pk_bf16_f32 v138, v124, v125
    v_cvt_pk_bf16_f32 v139, v126, v127
    v_cvt_pk_bf16_f32 v142, v128, v129
    v_cvt_pk_bf16_f32 v143, v130, v131
    v_permlane16_swap_b32 v136, v138
    v_permlane16_swap_b32 v137, v139
    v_permlane16_swap_b32 v140, v142
    v_permlane16_swap_b32 v141, v143
    buffer_store_dwordx4 v[136:139], v12, s[32:35], 0 offen offset:1024 sc1
    buffer_store_dwordx4 v[140:143], v12, s[32:35], 0 offen offset:1536 sc1
    v_cvt_pk_bf16_f32 v48, v160, v161
    v_cvt_pk_bf16_f32 v49, v162, v163
    v_cvt_pk_bf16_f32 v50, v164, v165
    v_cvt_pk_bf16_f32 v51, v166, v167
    v_mfma_f32_16x16x16_bf16 v[52:55], v[244:245], v[48:49], 0
    s_nop 0
    v_mfma_f32_16x16x16_bf16 v[68:71], v[244:245], v[50:51], 0
    s_nop 5
    v_cvt_pk_bf16_f32 v48, v52, v53
    v_cvt_pk_bf16_f32 v49, v54, v55
    v_cvt_pk_bf16_f32 v50, v68, v69
    v_cvt_pk_bf16_f32 v51, v70, v71
    v_lshlrev_b32 v52, 16, v48
    v_and_b32 v53, 0xffff0000, v48
    v_lshlrev_b32 v54, 16, v49
    v_and_b32 v55, 0xffff0000, v49
    v_lshlrev_b32 v68, 16, v50
    v_and_b32 v69, 0xffff0000, v50
    v_lshlrev_b32 v70, 16, v51
    v_and_b32 v71, 0xffff0000, v51
    v_max3_f32 v56, v52, v53, v54
    v_min3_f32 v57, v52, v53, v54
    v_max3_f32 v72, v68, v69, v70
    v_min3_f32 v73, v68, v69, v70
    v_max_f32 v56, v56, v55
    v_max_f32 v57, -v57, -v55
    v_max_f32 v72, v72, v71
    v_max_f32 v73, -v73, -v71
    v_permlane32_swap_b32 v56, v57
    s_nop 0
    v_permlane32_swap_b32 v72, v73
    v_max_f32 v56, v56, v57
    v_max_f32 v72, v72, v73
    v_mov_b32 v58, v56
    v_mov_b32 v74, v72
    s_nop 0
    v_permlane16_swap_b32 v56, v58
    v_permlane16_swap_b32 v72, v74
    v_max_f32 v56, v56, v58
    v_max_f32 v72, v72, v74
    v_mov_b32 v57, v56
    v_mov_b32 v73, v72
    s_nop 0
    v_permlane32_swap_b32 v56, v57
    v_permlane32_swap_b32 v72, v73
    v_mul_f32 v56, s53, v56
    v_mul_f32 v57, s53, v57
    v_mul_f32 v72, s53, v72
    v_mul_f32 v73, s53, v73
    v_fma_f32 v60, v52, s53, -v56
    v_fma_f32 v64, -v52, s53, -v57
    v_fma_f32 v61, v53, s53, -v56
    v_fma_f32 v65, -v53, s53, -v57
    v_fma_f32 v62, v54, s53, -v56
    v_fma_f32 v66, -v54, s53, -v57
    v_fma_f32 v63, v55, s53, -v56
    v_fma_f32 v67, -v55, s53, -v57
    v_fma_f32 v76, v68, s53, -v72
    v_fma_f32 v80, -v68, s53, -v73
    v_fma_f32 v77, v69, s53, -v72
    v_fma_f32 v81, -v69, s53, -v73
    v_fma_f32 v78, v70, s53, -v72
    v_fma_f32 v82, -v70, s53, -v73
    v_fma_f32 v79, v71, s53, -v72
    v_fma_f32 v83, -v71, s53, -v73
    v_exp_f32 v60, v60
    v_exp_f32 v61, v61
    v_exp_f32 v62, v62
    v_exp_f32 v63, v63
    v_exp_f32 v64, v64
    v_exp_f32 v65, v65
    v_exp_f32 v66, v66
    v_exp_f32 v67, v67
    v_exp_f32 v76, v76
    v_exp_f32 v77, v77
    v_exp_f32 v78, v78
    v_exp_f32 v79, v79
    v_exp_f32 v80, v80
    v_exp_f32 v81, v81
    v_exp_f32 v82, v82
    v_exp_f32 v83, v83
    v_add_f32 v56, v60, v61
    v_add_f32 v57, v64, v65
    v_add_f32 v58, v62, v63
    v_add_f32 v59, v66, v67
    v_add_f32 v72, v76, v77
    v_add_f32 v73, v80, v81
    v_add_f32 v74, v78, v79
    v_add_f32 v75, v82, v83
    v_add_f32 v56, v56, v58
    v_add_f32 v57, v57, v59
    v_add_f32 v72, v72, v74
    v_add_f32 v73, v73, v75
    v_permlane32_swap_b32 v56, v57
    s_nop 0
    v_permlane32_swap_b32 v72, v73
    v_add_f32 v56, v56, v57
    v_add_f32 v72, v72, v73
    v_mov_b32 v58, v56
    v_mov_b32 v74, v72
    s_nop 0
    v_permlane16_swap_b32 v56, v58
    v_permlane16_swap_b32 v72, v74
    v_add_f32 v56, v56, v58
    v_add_f32 v72, v72, v74
    v_mov_b32 v57, v56
    v_mov_b32 v73, v72
    s_nop 0
    v_permlane32_swap_b32 v56, v57
    v_permlane32_swap_b32 v72, v73
    v_rcp_f32 v56, v56
    v_rcp_f32 v57, v57
    v_rcp_f32 v72, v72
    v_rcp_f32 v73, v73
    v_mul_f32 v60, v60, v56
    v_mul_f32 v64, v64, v57
    v_mul_f32 v61, v61, v56
    v_mul_f32 v65, v65, v57
    v_mul_f32 v62, v62, v56
    v_mul_f32 v66, v66, v57
    v_mul_f32 v63, v63, v56
    v_mul_f32 v67, v67, v57
    v_mul_f32 v76, v76, v72
    v_mul_f32 v80, v80, v73
    v_mul_f32 v77, v77, v72
    v_mul_f32 v81, v81, v73
    v_mul_f32 v78, v78, v72
    v_mul_f32 v82, v82, v73
    v_mul_f32 v79, v79, v72
    v_mul_f32 v83, v83, v73
    v_cvt_pk_bf16_f32 v88, v60, v61
    v_cvt_pk_bf16_f32 v89, v62, v63
    v_cvt_pk_bf16_f32 v92, v64, v65
    v_cvt_pk_bf16_f32 v93, v66, v67
    v_cvt_pk_bf16_f32 v90, v76, v77
    v_cvt_pk_bf16_f32 v91, v78, v79
    v_cvt_pk_bf16_f32 v94, v80, v81
    v_cvt_pk_bf16_f32 v95, v82, v83
    v_permlane16_swap_b32 v88, v90
    v_permlane16_swap_b32 v89, v91
    v_permlane16_swap_b32 v92, v94
    v_permlane16_swap_b32 v93, v95
    buffer_store_dwordx4 v[88:91], v12, s[32:35], 0 offen offset:2048 sc1
    buffer_store_dwordx4 v[92:95], v12, s[32:35], 0 offen offset:2560 sc1
    v_cvt_pk_bf16_f32 v96, v168, v169
    v_cvt_pk_bf16_f32 v97, v170, v171
    v_cvt_pk_bf16_f32 v98, v172, v173
    v_cvt_pk_bf16_f32 v99, v174, v175
    v_mfma_f32_16x16x16_bf16 v[100:103], v[246:247], v[96:97], 0
    s_nop 0
    v_mfma_f32_16x16x16_bf16 v[116:119], v[246:247], v[98:99], 0
    s_nop 5
    v_cvt_pk_bf16_f32 v96, v100, v101
    v_cvt_pk_bf16_f32 v97, v102, v103
    v_cvt_pk_bf16_f32 v98, v116, v117
    v_cvt_pk_bf16_f32 v99, v118, v119
    v_lshlrev_b32 v100, 16, v96
    v_and_b32 v101, 0xffff0000, v96
    v_lshlrev_b32 v102, 16, v97
    v_and_b32 v103, 0xffff0000, v97
    v_lshlrev_b32 v116, 16, v98
    v_and_b32 v117, 0xffff0000, v98
    v_lshlrev_b32 v118, 16, v99
    v_and_b32 v119, 0xffff0000, v99
    v_max3_f32 v104, v100, v101, v102
    v_min3_f32 v105, v100, v101, v102
    v_max3_f32 v120, v116, v117, v118
    v_min3_f32 v121, v116, v117, v118
    v_max_f32 v104, v104, v103
    v_max_f32 v105, -v105, -v103
    v_max_f32 v120, v120, v119
    v_max_f32 v121, -v121, -v119
    v_permlane32_swap_b32 v104, v105
    s_nop 0
    v_permlane32_swap_b32 v120, v121
    v_max_f32 v104, v104, v105
    v_max_f32 v120, v120, v121
    v_mov_b32 v106, v104
    v_mov_b32 v122, v120
    s_nop 0
    v_permlane16_swap_b32 v104, v106
    v_permlane16_swap_b32 v120, v122
    v_max_f32 v104, v104, v106
    v_max_f32 v120, v120, v122
    v_mov_b32 v105, v104
    v_mov_b32 v121, v120
    s_nop 0
    v_permlane32_swap_b32 v104, v105
    v_permlane32_swap_b32 v120, v121
    v_mul_f32 v104, s53, v104
    v_mul_f32 v105, s53, v105
    v_mul_f32 v120, s53, v120
    v_mul_f32 v121, s53, v121
    v_fma_f32 v108, v100, s53, -v104
    v_fma_f32 v112, -v100, s53, -v105
    v_fma_f32 v109, v101, s53, -v104
    v_fma_f32 v113, -v101, s53, -v105
    v_fma_f32 v110, v102, s53, -v104
    v_fma_f32 v114, -v102, s53, -v105
    v_fma_f32 v111, v103, s53, -v104
    v_fma_f32 v115, -v103, s53, -v105
    v_fma_f32 v124, v116, s53, -v120
    v_fma_f32 v128, -v116, s53, -v121
    v_fma_f32 v125, v117, s53, -v120
    v_fma_f32 v129, -v117, s53, -v121
    v_fma_f32 v126, v118, s53, -v120
    v_fma_f32 v130, -v118, s53, -v121
    v_fma_f32 v127, v119, s53, -v120
    v_fma_f32 v131, -v119, s53, -v121
    v_exp_f32 v108, v108
    v_exp_f32 v109, v109
    v_exp_f32 v110, v110
    v_exp_f32 v111, v111
    v_exp_f32 v112, v112
    v_exp_f32 v113, v113
    v_exp_f32 v114, v114
    v_exp_f32 v115, v115
    v_exp_f32 v124, v124
    v_exp_f32 v125, v125
    v_exp_f32 v126, v126
    v_exp_f32 v127, v127
    v_exp_f32 v128, v128
    v_exp_f32 v129, v129
    v_exp_f32 v130, v130
    v_exp_f32 v131, v131
    v_add_f32 v104, v108, v109
    v_add_f32 v105, v112, v113
    v_add_f32 v106, v110, v111
    v_add_f32 v107, v114, v115
    v_add_f32 v120, v124, v125
    v_add_f32 v121, v128, v129
    v_add_f32 v122, v126, v127
    v_add_f32 v123, v130, v131
    v_add_f32 v104, v104, v106
    v_add_f32 v105, v105, v107
    v_add_f32 v120, v120, v122
    v_add_f32 v121, v121, v123
    v_permlane32_swap_b32 v104, v105
    s_nop 0
    v_permlane32_swap_b32 v120, v121
    v_add_f32 v104, v104, v105
    v_add_f32 v120, v120, v121
    v_mov_b32 v106, v104
    v_mov_b32 v122, v120
    s_nop 0
    v_permlane16_swap_b32 v104, v106
    v_permlane16_swap_b32 v120, v122
    v_add_f32 v104, v104, v106
    v_add_f32 v120, v120, v122
    v_mov_b32 v105, v104
    v_mov_b32 v121, v120
    s_nop 0
    v_permlane32_swap_b32 v104, v105
    v_permlane32_swap_b32 v120, v121
    v_rcp_f32 v104, v104
    v_rcp_f32 v105, v105
    v_rcp_f32 v120, v120
    v_rcp_f32 v121, v121
    v_mul_f32 v108, v108, v104
    v_mul_f32 v112, v112, v105
    v_mul_f32 v109, v109, v104
    v_mul_f32 v113, v113, v105
    v_mul_f32 v110, v110, v104
    v_mul_f32 v114, v114, v105
    v_mul_f32 v111, v111, v104
    v_mul_f32 v115, v115, v105
    v_mul_f32 v124, v124, v120
    v_mul_f32 v128, v128, v121
    v_mul_f32 v125, v125, v120
    v_mul_f32 v129, v129, v121
    v_mul_f32 v126, v126, v120
    v_mul_f32 v130, v130, v121
    v_mul_f32 v127, v127, v120
    v_mul_f32 v131, v131, v121
    v_cvt_pk_bf16_f32 v136, v108, v109
    v_cvt_pk_bf16_f32 v137, v110, v111
    v_cvt_pk_bf16_f32 v140, v112, v113
    v_cvt_pk_bf16_f32 v141, v114, v115
    v_cvt_pk_bf16_f32 v138, v124, v125
    v_cvt_pk_bf16_f32 v139, v126, v127
    v_cvt_pk_bf16_f32 v142, v128, v129
    v_cvt_pk_bf16_f32 v143, v130, v131
    v_permlane16_swap_b32 v136, v138
    v_permlane16_swap_b32 v137, v139
    v_permlane16_swap_b32 v140, v142
    v_permlane16_swap_b32 v141, v143
    buffer_store_dwordx4 v[136:139], v12, s[32:35], 0 offen offset:3072 sc1
    buffer_store_dwordx4 v[140:143], v12, s[32:35], 0 offen offset:3584 sc1
    v_cvt_pk_bf16_f32 v48, v176, v177
    v_cvt_pk_bf16_f32 v49, v178, v179
    v_cvt_pk_bf16_f32 v50, v180, v181
    v_cvt_pk_bf16_f32 v51, v182, v183
    v_mfma_f32_16x16x16_bf16 v[52:55], v[248:249], v[48:49], 0
    s_nop 0
    v_mfma_f32_16x16x16_bf16 v[68:71], v[248:249], v[50:51], 0
    s_nop 5
    v_cvt_pk_bf16_f32 v48, v52, v53
    v_cvt_pk_bf16_f32 v49, v54, v55
    v_cvt_pk_bf16_f32 v50, v68, v69
    v_cvt_pk_bf16_f32 v51, v70, v71
    v_lshlrev_b32 v52, 16, v48
    v_and_b32 v53, 0xffff0000, v48
    v_lshlrev_b32 v54, 16, v49
    v_and_b32 v55, 0xffff0000, v49
    v_lshlrev_b32 v68, 16, v50
    v_and_b32 v69, 0xffff0000, v50
    v_lshlrev_b32 v70, 16, v51
    v_and_b32 v71, 0xffff0000, v51
    v_max3_f32 v56, v52, v53, v54
    v_min3_f32 v57, v52, v53, v54
    v_max3_f32 v72, v68, v69, v70
    v_min3_f32 v73, v68, v69, v70
    v_max_f32 v56, v56, v55
    v_max_f32 v57, -v57, -v55
    v_max_f32 v72, v72, v71
    v_max_f32 v73, -v73, -v71
    v_permlane32_swap_b32 v56, v57
    s_nop 0
    v_permlane32_swap_b32 v72, v73
    v_max_f32 v56, v56, v57
    v_max_f32 v72, v72, v73
    v_mov_b32 v58, v56
    v_mov_b32 v74, v72
    s_nop 0
    v_permlane16_swap_b32 v56, v58
    v_permlane16_swap_b32 v72, v74
    v_max_f32 v56, v56, v58
    v_max_f32 v72, v72, v74
    v_mov_b32 v57, v56
    v_mov_b32 v73, v72
    s_nop 0
    v_permlane32_swap_b32 v56, v57
    v_permlane32_swap_b32 v72, v73
    v_mul_f32 v56, s53, v56
    v_mul_f32 v57, s53, v57
    v_mul_f32 v72, s53, v72
    v_mul_f32 v73, s53, v73
    v_fma_f32 v60, v52, s53, -v56
    v_fma_f32 v64, -v52, s53, -v57
    v_fma_f32 v61, v53, s53, -v56
    v_fma_f32 v65, -v53, s53, -v57
    v_fma_f32 v62, v54, s53, -v56
    v_fma_f32 v66, -v54, s53, -v57
    v_fma_f32 v63, v55, s53, -v56
    v_fma_f32 v67, -v55, s53, -v57
    v_fma_f32 v76, v68, s53, -v72
    v_fma_f32 v80, -v68, s53, -v73
    v_fma_f32 v77, v69, s53, -v72
    v_fma_f32 v81, -v69, s53, -v73
    v_fma_f32 v78, v70, s53, -v72
    v_fma_f32 v82, -v70, s53, -v73
    v_fma_f32 v79, v71, s53, -v72
    v_fma_f32 v83, -v71, s53, -v73
    v_exp_f32 v60, v60
    v_exp_f32 v61, v61
    v_exp_f32 v62, v62
    v_exp_f32 v63, v63
    v_exp_f32 v64, v64
    v_exp_f32 v65, v65
    v_exp_f32 v66, v66
    v_exp_f32 v67, v67
    v_exp_f32 v76, v76
    v_exp_f32 v77, v77
    v_exp_f32 v78, v78
    v_exp_f32 v79, v79
    v_exp_f32 v80, v80
    v_exp_f32 v81, v81
    v_exp_f32 v82, v82
    v_exp_f32 v83, v83
    v_add_f32 v56, v60, v61
    v_add_f32 v57, v64, v65
    v_add_f32 v58, v62, v63
    v_add_f32 v59, v66, v67
    v_add_f32 v72, v76, v77
    v_add_f32 v73, v80, v81
    v_add_f32 v74, v78, v79
    v_add_f32 v75, v82, v83
    v_add_f32 v56, v56, v58
    v_add_f32 v57, v57, v59
    v_add_f32 v72, v72, v74
    v_add_f32 v73, v73, v75
    v_permlane32_swap_b32 v56, v57
    s_nop 0
    v_permlane32_swap_b32 v72, v73
    v_add_f32 v56, v56, v57
    v_add_f32 v72, v72, v73
    v_mov_b32 v58, v56
    v_mov_b32 v74, v72
    s_nop 0
    v_permlane16_swap_b32 v56, v58
    v_permlane16_swap_b32 v72, v74
    v_add_f32 v56, v56, v58
    v_add_f32 v72, v72, v74
    v_mov_b32 v57, v56
    v_mov_b32 v73, v72
    s_nop 0
    v_permlane32_swap_b32 v56, v57
    v_permlane32_swap_b32 v72, v73
    v_rcp_f32 v56, v56
    v_rcp_f32 v57, v57
    v_rcp_f32 v72, v72
    v_rcp_f32 v73, v73
    v_mul_f32 v60, v60, v56
    v_mul_f32 v64, v64, v57
    v_mul_f32 v61, v61, v56
    v_mul_f32 v65, v65, v57
    v_mul_f32 v62, v62, v56
    v_mul_f32 v66, v66, v57
    v_mul_f32 v63, v63, v56
    v_mul_f32 v67, v67, v57
    v_mul_f32 v76, v76, v72
    v_mul_f32 v80, v80, v73
    v_mul_f32 v77, v77, v72
    v_mul_f32 v81, v81, v73
    v_mul_f32 v78, v78, v72
    v_mul_f32 v82, v82, v73
    v_mul_f32 v79, v79, v72
    v_mul_f32 v83, v83, v73
    v_cvt_pk_bf16_f32 v88, v60, v61
    v_cvt_pk_bf16_f32 v89, v62, v63
    v_cvt_pk_bf16_f32 v92, v64, v65
    v_cvt_pk_bf16_f32 v93, v66, v67
    v_cvt_pk_bf16_f32 v90, v76, v77
    v_cvt_pk_bf16_f32 v91, v78, v79
    v_cvt_pk_bf16_f32 v94, v80, v81
    v_cvt_pk_bf16_f32 v95, v82, v83
    v_permlane16_swap_b32 v88, v90
    v_permlane16_swap_b32 v89, v91
    v_permlane16_swap_b32 v92, v94
    v_permlane16_swap_b32 v93, v95
    buffer_store_dwordx4 v[88:91], v13, s[32:35], 0 offen offset:0 sc1
    buffer_store_dwordx4 v[92:95], v13, s[32:35], 0 offen offset:512 sc1
    v_cvt_pk_bf16_f32 v96, v184, v185
    v_cvt_pk_bf16_f32 v97, v186, v187
    v_cvt_pk_bf16_f32 v98, v188, v189
    v_cvt_pk_bf16_f32 v99, v190, v191
    v_mfma_f32_16x16x16_bf16 v[100:103], v[250:251], v[96:97], 0
    s_nop 0
    v_mfma_f32_16x16x16_bf16 v[116:119], v[250:251], v[98:99], 0
    s_nop 5
    v_cvt_pk_bf16_f32 v96, v100, v101
    v_cvt_pk_bf16_f32 v97, v102, v103
    v_cvt_pk_bf16_f32 v98, v116, v117
    v_cvt_pk_bf16_f32 v99, v118, v119
    v_lshlrev_b32 v100, 16, v96
    v_and_b32 v101, 0xffff0000, v96
    v_lshlrev_b32 v102, 16, v97
    v_and_b32 v103, 0xffff0000, v97
    v_lshlrev_b32 v116, 16, v98
    v_and_b32 v117, 0xffff0000, v98
    v_lshlrev_b32 v118, 16, v99
    v_and_b32 v119, 0xffff0000, v99
    v_max3_f32 v104, v100, v101, v102
    v_min3_f32 v105, v100, v101, v102
    v_max3_f32 v120, v116, v117, v118
    v_min3_f32 v121, v116, v117, v118
    v_max_f32 v104, v104, v103
    v_max_f32 v105, -v105, -v103
    v_max_f32 v120, v120, v119
    v_max_f32 v121, -v121, -v119
    v_permlane32_swap_b32 v104, v105
    s_nop 0
    v_permlane32_swap_b32 v120, v121
    v_max_f32 v104, v104, v105
    v_max_f32 v120, v120, v121
    v_mov_b32 v106, v104
    v_mov_b32 v122, v120
    s_nop 0
    v_permlane16_swap_b32 v104, v106
    v_permlane16_swap_b32 v120, v122
    v_max_f32 v104, v104, v106
    v_max_f32 v120, v120, v122
    v_mov_b32 v105, v104
    v_mov_b32 v121, v120
    s_nop 0
    v_permlane32_swap_b32 v104, v105
    v_permlane32_swap_b32 v120, v121
    v_mul_f32 v104, s53, v104
    v_mul_f32 v105, s53, v105
    v_mul_f32 v120, s53, v120
    v_mul_f32 v121, s53, v121
    v_fma_f32 v108, v100, s53, -v104
    v_fma_f32 v112, -v100, s53, -v105
    v_fma_f32 v109, v101, s53, -v104
    v_fma_f32 v113, -v101, s53, -v105
    v_fma_f32 v110, v102, s53, -v104
    v_fma_f32 v114, -v102, s53, -v105
    v_fma_f32 v111, v103, s53, -v104
    v_fma_f32 v115, -v103, s53, -v105
    v_fma_f32 v124, v116, s53, -v120
    v_fma_f32 v128, -v116, s53, -v121
    v_fma_f32 v125, v117, s53, -v120
    v_fma_f32 v129, -v117, s53, -v121
    v_fma_f32 v126, v118, s53, -v120
    v_fma_f32 v130, -v118, s53, -v121
    v_fma_f32 v127, v119, s53, -v120
    v_fma_f32 v131, -v119, s53, -v121
    v_exp_f32 v108, v108
    v_exp_f32 v109, v109
    v_exp_f32 v110, v110
    v_exp_f32 v111, v111
    v_exp_f32 v112, v112
    v_exp_f32 v113, v113
    v_exp_f32 v114, v114
    v_exp_f32 v115, v115
    v_exp_f32 v124, v124
    v_exp_f32 v125, v125
    v_exp_f32 v126, v126
    v_exp_f32 v127, v127
    v_exp_f32 v128, v128
    v_exp_f32 v129, v129
    v_exp_f32 v130, v130
    v_exp_f32 v131, v131
    v_add_f32 v104, v108, v109
    v_add_f32 v105, v112, v113
    v_add_f32 v106, v110, v111
    v_add_f32 v107, v114, v115
    v_add_f32 v120, v124, v125
    v_add_f32 v121, v128, v129
    v_add_f32 v122, v126, v127
    v_add_f32 v123, v130, v131
    v_add_f32 v104, v104, v106
    v_add_f32 v105, v105, v107
    v_add_f32 v120, v120, v122
    v_add_f32 v121, v121, v123
    v_permlane32_swap_b32 v104, v105
    s_nop 0
    v_permlane32_swap_b32 v120, v121
    v_add_f32 v104, v104, v105
    v_add_f32 v120, v120, v121
    v_mov_b32 v106, v104
    v_mov_b32 v122, v120
    s_nop 0
    v_permlane16_swap_b32 v104, v106
    v_permlane16_swap_b32 v120, v122
    v_add_f32 v104, v104, v106
    v_add_f32 v120, v120, v122
    v_mov_b32 v105, v104
    v_mov_b32 v121, v120
    s_nop 0
    v_permlane32_swap_b32 v104, v105
    v_permlane32_swap_b32 v120, v121
    v_rcp_f32 v104, v104
    v_rcp_f32 v105, v105
    v_rcp_f32 v120, v120
    v_rcp_f32 v121, v121
    v_mul_f32 v108, v108, v104
    v_mul_f32 v112, v112, v105
    v_mul_f32 v109, v109, v104
    v_mul_f32 v113, v113, v105
    v_mul_f32 v110, v110, v104
    v_mul_f32 v114, v114, v105
    v_mul_f32 v111, v111, v104
    v_mul_f32 v115, v115, v105
    v_mul_f32 v124, v124, v120
    v_mul_f32 v128, v128, v121
    v_mul_f32 v125, v125, v120
    v_mul_f32 v129, v129, v121
    v_mul_f32 v126, v126, v120
    v_mul_f32 v130, v130, v121
    v_mul_f32 v127, v127, v120
    v_mul_f32 v131, v131, v121
    v_cvt_pk_bf16_f32 v136, v108, v109
    v_cvt_pk_bf16_f32 v137, v110, v111
    v_cvt_pk_bf16_f32 v140, v112, v113
    v_cvt_pk_bf16_f32 v141, v114, v115
    v_cvt_pk_bf16_f32 v138, v124, v125
    v_cvt_pk_bf16_f32 v139, v126, v127
    v_cvt_pk_bf16_f32 v142, v128, v129
    v_cvt_pk_bf16_f32 v143, v130, v131
    v_permlane16_swap_b32 v136, v138
    v_permlane16_swap_b32 v137, v139
    v_permlane16_swap_b32 v140, v142
    v_permlane16_swap_b32 v141, v143
    buffer_store_dwordx4 v[136:139], v13, s[32:35], 0 offen offset:1024 sc1
    buffer_store_dwordx4 v[140:143], v13, s[32:35], 0 offen offset:1536 sc1
    v_cvt_pk_bf16_f32 v48, v192, v193
    v_cvt_pk_bf16_f32 v49, v194, v195
    v_cvt_pk_bf16_f32 v50, v196, v197
    v_cvt_pk_bf16_f32 v51, v198, v199
    v_mfma_f32_16x16x16_bf16 v[52:55], v[252:253], v[48:49], 0
    s_nop 0
    v_mfma_f32_16x16x16_bf16 v[68:71], v[252:253], v[50:51], 0
    s_nop 5
    v_cvt_pk_bf16_f32 v48, v52, v53
    v_cvt_pk_bf16_f32 v49, v54, v55
    v_cvt_pk_bf16_f32 v50, v68, v69
    v_cvt_pk_bf16_f32 v51, v70, v71
    v_lshlrev_b32 v52, 16, v48
    v_and_b32 v53, 0xffff0000, v48
    v_lshlrev_b32 v54, 16, v49
    v_and_b32 v55, 0xffff0000, v49
    v_lshlrev_b32 v68, 16, v50
    v_and_b32 v69, 0xffff0000, v50
    v_lshlrev_b32 v70, 16, v51
    v_and_b32 v71, 0xffff0000, v51
    v_max3_f32 v56, v52, v53, v54
    v_min3_f32 v57, v52, v53, v54
    v_max3_f32 v72, v68, v69, v70
    v_min3_f32 v73, v68, v69, v70
    v_max_f32 v56, v56, v55
    v_max_f32 v57, -v57, -v55
    v_max_f32 v72, v72, v71
    v_max_f32 v73, -v73, -v71
    v_permlane32_swap_b32 v56, v57
    s_nop 0
    v_permlane32_swap_b32 v72, v73
    v_max_f32 v56, v56, v57
    v_max_f32 v72, v72, v73
    v_mov_b32 v58, v56
    v_mov_b32 v74, v72
    s_nop 0
    v_permlane16_swap_b32 v56, v58
    v_permlane16_swap_b32 v72, v74
    v_max_f32 v56, v56, v58
    v_max_f32 v72, v72, v74
    v_mov_b32 v57, v56
    v_mov_b32 v73, v72
    s_nop 0
    v_permlane32_swap_b32 v56, v57
    v_permlane32_swap_b32 v72, v73
    v_mul_f32 v56, s53, v56
    v_mul_f32 v57, s53, v57
    v_mul_f32 v72, s53, v72
    v_mul_f32 v73, s53, v73
    v_fma_f32 v60, v52, s53, -v56
    v_fma_f32 v64, -v52, s53, -v57
    v_fma_f32 v61, v53, s53, -v56
    v_fma_f32 v65, -v53, s53, -v57
    v_fma_f32 v62, v54, s53, -v56
    v_fma_f32 v66, -v54, s53, -v57
    v_fma_f32 v63, v55, s53, -v56
    v_fma_f32 v67, -v55, s53, -v57
    v_fma_f32 v76, v68, s53, -v72
    v_fma_f32 v80, -v68, s53, -v73
    v_fma_f32 v77, v69, s53, -v72
    v_fma_f32 v81, -v69, s53, -v73
    v_fma_f32 v78, v70, s53, -v72
    v_fma_f32 v82, -v70, s53, -v73
    v_fma_f32 v79, v71, s53, -v72
    v_fma_f32 v83, -v71, s53, -v73
    v_exp_f32 v60, v60
    v_exp_f32 v61, v61
    v_exp_f32 v62, v62
    v_exp_f32 v63, v63
    v_exp_f32 v64, v64
    v_exp_f32 v65, v65
    v_exp_f32 v66, v66
    v_exp_f32 v67, v67
    v_exp_f32 v76, v76
    v_exp_f32 v77, v77
    v_exp_f32 v78, v78
    v_exp_f32 v79, v79
    v_exp_f32 v80, v80
    v_exp_f32 v81, v81
    v_exp_f32 v82, v82
    v_exp_f32 v83, v83
    v_add_f32 v56, v60, v61
    v_add_f32 v57, v64, v65
    v_add_f32 v58, v62, v63
    v_add_f32 v59, v66, v67
    v_add_f32 v72, v76, v77
    v_add_f32 v73, v80, v81
    v_add_f32 v74, v78, v79
    v_add_f32 v75, v82, v83
    v_add_f32 v56, v56, v58
    v_add_f32 v57, v57, v59
    v_add_f32 v72, v72, v74
    v_add_f32 v73, v73, v75
    v_permlane32_swap_b32 v56, v57
    s_nop 0
    v_permlane32_swap_b32 v72, v73
    v_add_f32 v56, v56, v57
    v_add_f32 v72, v72, v73
    v_mov_b32 v58, v56
    v_mov_b32 v74, v72
    s_nop 0
    v_permlane16_swap_b32 v56, v58
    v_permlane16_swap_b32 v72, v74
    v_add_f32 v56, v56, v58
    v_add_f32 v72, v72, v74
    v_mov_b32 v57, v56
    v_mov_b32 v73, v72
    s_nop 0
    v_permlane32_swap_b32 v56, v57
    v_permlane32_swap_b32 v72, v73
    v_rcp_f32 v56, v56
    v_rcp_f32 v57, v57
    v_rcp_f32 v72, v72
    v_rcp_f32 v73, v73
    v_mul_f32 v60, v60, v56
    v_mul_f32 v64, v64, v57
    v_mul_f32 v61, v61, v56
    v_mul_f32 v65, v65, v57
    v_mul_f32 v62, v62, v56
    v_mul_f32 v66, v66, v57
    v_mul_f32 v63, v63, v56
    v_mul_f32 v67, v67, v57
    v_mul_f32 v76, v76, v72
    v_mul_f32 v80, v80, v73
    v_mul_f32 v77, v77, v72
    v_mul_f32 v81, v81, v73
    v_mul_f32 v78, v78, v72
    v_mul_f32 v82, v82, v73
    v_mul_f32 v79, v79, v72
    v_mul_f32 v83, v83, v73
    v_cvt_pk_bf16_f32 v88, v60, v61
    v_cvt_pk_bf16_f32 v89, v62, v63
    v_cvt_pk_bf16_f32 v92, v64, v65
    v_cvt_pk_bf16_f32 v93, v66, v67
    v_cvt_pk_bf16_f32 v90, v76, v77
    v_cvt_pk_bf16_f32 v91, v78, v79
    v_cvt_pk_bf16_f32 v94, v80, v81
    v_cvt_pk_bf16_f32 v95, v82, v83
    v_permlane16_swap_b32 v88, v90
    v_permlane16_swap_b32 v89, v91
    v_permlane16_swap_b32 v92, v94
    v_permlane16_swap_b32 v93, v95
    buffer_store_dwordx4 v[88:91], v13, s[32:35], 0 offen offset:2048 sc1
    buffer_store_dwordx4 v[92:95], v13, s[32:35], 0 offen offset:2560 sc1
    v_cvt_pk_bf16_f32 v96, v200, v201
    v_cvt_pk_bf16_f32 v97, v202, v203
    v_cvt_pk_bf16_f32 v98, v204, v205
    v_cvt_pk_bf16_f32 v99, v206, v207
    v_mfma_f32_16x16x16_bf16 v[100:103], v[254:255], v[96:97], 0
    s_nop 0
    v_mfma_f32_16x16x16_bf16 v[116:119], v[254:255], v[98:99], 0
    s_nop 5
    v_cvt_pk_bf16_f32 v96, v100, v101
    v_cvt_pk_bf16_f32 v97, v102, v103
    v_cvt_pk_bf16_f32 v98, v116, v117
    v_cvt_pk_bf16_f32 v99, v118, v119
    v_lshlrev_b32 v100, 16, v96
    v_and_b32 v101, 0xffff0000, v96
    v_lshlrev_b32 v102, 16, v97
    v_and_b32 v103, 0xffff0000, v97
    v_lshlrev_b32 v116, 16, v98
    v_and_b32 v117, 0xffff0000, v98
    v_lshlrev_b32 v118, 16, v99
    v_and_b32 v119, 0xffff0000, v99
    v_max3_f32 v104, v100, v101, v102
    v_min3_f32 v105, v100, v101, v102
    v_max3_f32 v120, v116, v117, v118
    v_min3_f32 v121, v116, v117, v118
    v_max_f32 v104, v104, v103
    v_max_f32 v105, -v105, -v103
    v_max_f32 v120, v120, v119
    v_max_f32 v121, -v121, -v119
    v_permlane32_swap_b32 v104, v105
    s_nop 0
    v_permlane32_swap_b32 v120, v121
    v_max_f32 v104, v104, v105
    v_max_f32 v120, v120, v121
    v_mov_b32 v106, v104
    v_mov_b32 v122, v120
    s_nop 0
    v_permlane16_swap_b32 v104, v106
    v_permlane16_swap_b32 v120, v122
    v_max_f32 v104, v104, v106
    v_max_f32 v120, v120, v122
    v_mov_b32 v105, v104
    v_mov_b32 v121, v120
    s_nop 0
    v_permlane32_swap_b32 v104, v105
    v_permlane32_swap_b32 v120, v121
    v_mul_f32 v104, s53, v104
    v_mul_f32 v105, s53, v105
    v_mul_f32 v120, s53, v120
    v_mul_f32 v121, s53, v121
    v_fma_f32 v108, v100, s53, -v104
    v_fma_f32 v112, -v100, s53, -v105
    v_fma_f32 v109, v101, s53, -v104
    v_fma_f32 v113, -v101, s53, -v105
    v_fma_f32 v110, v102, s53, -v104
    v_fma_f32 v114, -v102, s53, -v105
    v_fma_f32 v111, v103, s53, -v104
    v_fma_f32 v115, -v103, s53, -v105
    v_fma_f32 v124, v116, s53, -v120
    v_fma_f32 v128, -v116, s53, -v121
    v_fma_f32 v125, v117, s53, -v120
    v_fma_f32 v129, -v117, s53, -v121
    v_fma_f32 v126, v118, s53, -v120
    v_fma_f32 v130, -v118, s53, -v121
    v_fma_f32 v127, v119, s53, -v120
    v_fma_f32 v131, -v119, s53, -v121
    v_exp_f32 v108, v108
    v_exp_f32 v109, v109
    v_exp_f32 v110, v110
    v_exp_f32 v111, v111
    v_exp_f32 v112, v112
    v_exp_f32 v113, v113
    v_exp_f32 v114, v114
    v_exp_f32 v115, v115
    v_exp_f32 v124, v124
    v_exp_f32 v125, v125
    v_exp_f32 v126, v126
    v_exp_f32 v127, v127
    v_exp_f32 v128, v128
    v_exp_f32 v129, v129
    v_exp_f32 v130, v130
    v_exp_f32 v131, v131
    v_add_f32 v104, v108, v109
    v_add_f32 v105, v112, v113
    v_add_f32 v106, v110, v111
    v_add_f32 v107, v114, v115
    v_add_f32 v120, v124, v125
    v_add_f32 v121, v128, v129
    v_add_f32 v122, v126, v127
    v_add_f32 v123, v130, v131
    v_add_f32 v104, v104, v106
    v_add_f32 v105, v105, v107
    v_add_f32 v120, v120, v122
    v_add_f32 v121, v121, v123
    v_permlane32_swap_b32 v104, v105
    s_nop 0
    v_permlane32_swap_b32 v120, v121
    v_add_f32 v104, v104, v105
    v_add_f32 v120, v120, v121
    v_mov_b32 v106, v104
    v_mov_b32 v122, v120
    s_nop 0
    v_permlane16_swap_b32 v104, v106
    v_permlane16_swap_b32 v120, v122
    v_add_f32 v104, v104, v106
    v_add_f32 v120, v120, v122
    v_mov_b32 v105, v104
    v_mov_b32 v121, v120
    s_nop 0
    v_permlane32_swap_b32 v104, v105
    v_permlane32_swap_b32 v120, v121
    v_rcp_f32 v104, v104
    v_rcp_f32 v105, v105
    v_rcp_f32 v120, v120
    v_rcp_f32 v121, v121
    v_mul_f32 v108, v108, v104
    v_mul_f32 v112, v112, v105
    v_mul_f32 v109, v109, v104
    v_mul_f32 v113, v113, v105
    v_mul_f32 v110, v110, v104
    v_mul_f32 v114, v114, v105
    v_mul_f32 v111, v111, v104
    v_mul_f32 v115, v115, v105
    v_mul_f32 v124, v124, v120
    v_mul_f32 v128, v128, v121
    v_mul_f32 v125, v125, v120
    v_mul_f32 v129, v129, v121
    v_mul_f32 v126, v126, v120
    v_mul_f32 v130, v130, v121
    v_mul_f32 v127, v127, v120
    v_mul_f32 v131, v131, v121
    v_cvt_pk_bf16_f32 v136, v108, v109
    v_cvt_pk_bf16_f32 v137, v110, v111
    v_cvt_pk_bf16_f32 v140, v112, v113
    v_cvt_pk_bf16_f32 v141, v114, v115
    v_cvt_pk_bf16_f32 v138, v124, v125
    v_cvt_pk_bf16_f32 v139, v126, v127
    v_cvt_pk_bf16_f32 v142, v128, v129
    v_cvt_pk_bf16_f32 v143, v130, v131
    v_permlane16_swap_b32 v136, v138
    v_permlane16_swap_b32 v137, v139
    v_permlane16_swap_b32 v140, v142
    v_permlane16_swap_b32 v141, v143
    buffer_store_dwordx4 v[136:139], v13, s[32:35], 0 offen offset:3072 sc1
    buffer_store_dwordx4 v[140:143], v13, s[32:35], 0 offen offset:3584 sc1
    s_branch K1_done
K1_gu4_epi:
    s_add_u32 s32, s12, 0x600000
    s_addc_u32 s33, s13, 0
    s_mov_b32 s34, 0x560000
    s_mov_b32 s35, 0x00020000
    v_lshrrev_b32 v12, 1, v3
    v_lshl_add_u32 v12, v12, 4, v2
    v_lshlrev_b32 v12, 4, v12
    v_and_b32 v13, 1, v3
    v_mul_u32_u24 v13, 44032, v13
    v_add_u32 v12, v13, v12
    s_mul_i32 s3, s46, 2752
    s_lshl_b32 s49, s50, 9
    s_add_u32 s3, s3, s49
    v_add_u32 v12, s3, v12
    v_cvt_pk_bf16_f32 v48, v144, v145
    v_cvt_pk_bf16_f32 v49, v146, v147
    v_cvt_pk_bf16_f32 v50, v176, v177
    v_cvt_pk_bf16_f32 v51, v178, v179
    v_lshlrev_b32 v52, 16, v48
    v_and_b32 v53, 0xffff0000, v48
    v_lshlrev_b32 v54, 16, v49
    v_and_b32 v55, 0xffff0000, v49
    v_lshlrev_b32 v56, 16, v50
    v_and_b32 v57, 0xffff0000, v50
    v_lshlrev_b32 v58, 16, v51
    v_and_b32 v59, 0xffff0000, v51
    v_mul_f32 v60, 0xbfb8aa3b, v52
    v_mul_f32 v61, 0xbfb8aa3b, v53
    v_mul_f32 v62, 0xbfb8aa3b, v54
    v_mul_f32 v63, 0xbfb8aa3b, v55
    v_exp_f32 v60, v60
    v_exp_f32 v61, v61
    v_exp_f32 v62, v62
    v_exp_f32 v63, v63
    v_add_f32 v60, 1.0, v60
    v_add_f32 v61, 1.0, v61
    v_add_f32 v62, 1.0, v62
    v_add_f32 v63, 1.0, v63
    v_rcp_f32 v60, v60
    v_rcp_f32 v61, v61
    v_rcp_f32 v62, v62
    v_rcp_f32 v63, v63
    v_mul_f32 v60, v60, v52
    v_mul_f32 v61, v61, v53
    v_mul_f32 v62, v62, v54
    v_mul_f32 v63, v63, v55
    v_cvt_pk_bf16_f32 v48, v60, v61
    v_cvt_pk_bf16_f32 v49, v62, v63
    v_lshlrev_b32 v52, 16, v48
    v_and_b32 v53, 0xffff0000, v48
    v_lshlrev_b32 v54, 16, v49
    v_and_b32 v55, 0xffff0000, v49
    v_mul_f32 v52, v52, v56
    v_mul_f32 v53, v53, v57
    v_mul_f32 v54, v54, v58
    v_mul_f32 v55, v55, v59
    v_cvt_pk_bf16_f32 v64, v52, v53
    v_cvt_pk_bf16_f32 v65, v54, v55
    v_cvt_pk_bf16_f32 v48, v148, v149
    v_cvt_pk_bf16_f32 v49, v150, v151
    v_cvt_pk_bf16_f32 v50, v180, v181
    v_cvt_pk_bf16_f32 v51, v182, v183
    v_lshlrev_b32 v52, 16, v48
    v_and_b32 v53, 0xffff0000, v48
    v_lshlrev_b32 v54, 16, v49
    v_and_b32 v55, 0xffff0000, v49
    v_lshlrev_b32 v56, 16, v50
    v_and_b32 v57, 0xffff0000, v50
    v_lshlrev_b32 v58, 16, v51
    v_and_b32 v59, 0xffff0000, v51
    v_mul_f32 v60, 0xbfb8aa3b, v52
    v_mul_f32 v61, 0xbfb8aa3b, v53
    v_mul_f32 v62, 0xbfb8aa3b, v54
    v_mul_f32 v63, 0xbfb8aa3b, v55
    v_exp_f32 v60, v60
    v_exp_f32 v61, v61
    v_exp_f32 v62, v62
    v_exp_f32 v63, v63
    v_add_f32 v60, 1.0, v60
    v_add_f32 v61, 1.0, v61
    v_add_f32 v62, 1.0, v62
    v_add_f32 v63, 1.0, v63
    v_rcp_f32 v60, v60
    v_rcp_f32 v61, v61
    v_rcp_f32 v62, v62
    v_rcp_f32 v63, v63
    v_mul_f32 v60, v60, v52
    v_mul_f32 v61, v61, v53
    v_mul_f32 v62, v62, v54
    v_mul_f32 v63, v63, v55
    v_cvt_pk_bf16_f32 v48, v60, v61
    v_cvt_pk_bf16_f32 v49, v62, v63
    v_lshlrev_b32 v52, 16, v48
    v_and_b32 v53, 0xffff0000, v48
    v_lshlrev_b32 v54, 16, v49
    v_and_b32 v55, 0xffff0000, v49
    v_mul_f32 v52, v52, v56
    v_mul_f32 v53, v53, v57
    v_mul_f32 v54, v54, v58
    v_mul_f32 v55, v55, v59
    v_cvt_pk_bf16_f32 v66, v52, v53
    v_cvt_pk_bf16_f32 v67, v54, v55
    s_nop 0
    v_permlane16_swap_b32 v64, v66
    v_permlane16_swap_b32 v65, v67
    buffer_store_dwordx4 v[64:67], v12, s[32:35], 0 offen offset:0 sc1
    v_cvt_pk_bf16_f32 v48, v152, v153
    v_cvt_pk_bf16_f32 v49, v154, v155
    v_cvt_pk_bf16_f32 v50, v184, v185
    v_cvt_pk_bf16_f32 v51, v186, v187
    v_lshlrev_b32 v52, 16, v48
    v_and_b32 v53, 0xffff0000, v48
    v_lshlrev_b32 v54, 16, v49
    v_and_b32 v55, 0xffff0000, v49
    v_lshlrev_b32 v56, 16, v50
    v_and_b32 v57, 0xffff0000, v50
    v_lshlrev_b32 v58, 16, v51
    v_and_b32 v59, 0xffff0000, v51
    v_mul_f32 v60, 0xbfb8aa3b, v52
    v_mul_f32 v61, 0xbfb8aa3b, v53
    v_mul_f32 v62, 0xbfb8aa3b, v54
    v_mul_f32 v63, 0xbfb8aa3b, v55
    v_exp_f32 v60, v60
    v_exp_f32 v61, v61
    v_exp_f32 v62, v62
    v_exp_f32 v63, v63
    v_add_f32 v60, 1.0, v60
    v_add_f32 v61, 1.0, v61
    v_add_f32 v62, 1.0, v62
    v_add_f32 v63, 1.0, v63
    v_rcp_f32 v60, v60
    v_rcp_f32 v61, v61
    v_rcp_f32 v62, v62
    v_rcp_f32 v63, v63
    v_mul_f32 v60, v60, v52
    v_mul_f32 v61, v61, v53
    v_mul_f32 v62, v62, v54
    v_mul_f32 v63, v63, v55
    v_cvt_pk_bf16_f32 v48, v60, v61
    v_cvt_pk_bf16_f32 v49, v62, v63
    v_lshlrev_b32 v52, 16, v48
    v_and_b32 v53, 0xffff0000, v48
    v_lshlrev_b32 v54, 16, v49
    v_and_b32 v55, 0xffff0000, v49
    v_mul_f32 v52, v52, v56
    v_mul_f32 v53, v53, v57
    v_mul_f32 v54, v54, v58
    v_mul_f32 v55, v55, v59
    v_cvt_pk_bf16_f32 v68, v52, v53
    v_cvt_pk_bf16_f32 v69, v54, v55
    v_cvt_pk_bf16_f32 v48, v156, v157
    v_cvt_pk_bf16_f32 v49, v158, v159
    v_cvt_pk_bf16_f32 v50, v188, v189
    v_cvt_pk_bf16_f32 v51, v190, v191
    v_lshlrev_b32 v52, 16, v48
    v_and_b32 v53, 0xffff0000, v48
    v_lshlrev_b32 v54, 16, v49
    v_and_b32 v55, 0xffff0000, v49
    v_lshlrev_b32 v56, 16, v50
    v_and_b32 v57, 0xffff0000, v50
    v_lshlrev_b32 v58, 16, v51
    v_and_b32 v59, 0xffff0000, v51
    v_mul_f32 v60, 0xbfb8aa3b, v52
    v_mul_f32 v61, 0xbfb8aa3b, v53
    v_mul_f32 v62, 0xbfb8aa3b, v54
    v_mul_f32 v63, 0xbfb8aa3b, v55
    v_exp_f32 v60, v60
    v_exp_f32 v61, v61
    v_exp_f32 v62, v62
    v_exp_f32 v63, v63
    v_add_f32 v60, 1.0, v60
    v_add_f32 v61, 1.0, v61
    v_add_f32 v62, 1.0, v62
    v_add_f32 v63, 1.0, v63
    v_rcp_f32 v60, v60
    v_rcp_f32 v61, v61
    v_rcp_f32 v62, v62
    v_rcp_f32 v63, v63
    v_mul_f32 v60, v60, v52
    v_mul_f32 v61, v61, v53
    v_mul_f32 v62, v62, v54
    v_mul_f32 v63, v63, v55
    v_cvt_pk_bf16_f32 v48, v60, v61
    v_cvt_pk_bf16_f32 v49, v62, v63
    v_lshlrev_b32 v52, 16, v48
    v_and_b32 v53, 0xffff0000, v48
    v_lshlrev_b32 v54, 16, v49
    v_and_b32 v55, 0xffff0000, v49
    v_mul_f32 v52, v52, v56
    v_mul_f32 v53, v53, v57
    v_mul_f32 v54, v54, v58
    v_mul_f32 v55, v55, v59
    v_cvt_pk_bf16_f32 v70, v52, v53
    v_cvt_pk_bf16_f32 v71, v54, v55
    s_nop 0
    v_permlane16_swap_b32 v68, v70
    v_permlane16_swap_b32 v69, v71
    buffer_store_dwordx4 v[68:71], v12, s[32:35], 0 offen offset:512 sc1
    v_cvt_pk_bf16_f32 v48, v160, v161
    v_cvt_pk_bf16_f32 v49, v162, v163
    v_cvt_pk_bf16_f32 v50, v192, v193
    v_cvt_pk_bf16_f32 v51, v194, v195
    v_lshlrev_b32 v52, 16, v48
    v_and_b32 v53, 0xffff0000, v48
    v_lshlrev_b32 v54, 16, v49
    v_and_b32 v55, 0xffff0000, v49
    v_lshlrev_b32 v56, 16, v50
    v_and_b32 v57, 0xffff0000, v50
    v_lshlrev_b32 v58, 16, v51
    v_and_b32 v59, 0xffff0000, v51
    v_mul_f32 v60, 0xbfb8aa3b, v52
    v_mul_f32 v61, 0xbfb8aa3b, v53
    v_mul_f32 v62, 0xbfb8aa3b, v54
    v_mul_f32 v63, 0xbfb8aa3b, v55
    v_exp_f32 v60, v60
    v_exp_f32 v61, v61
    v_exp_f32 v62, v62
    v_exp_f32 v63, v63
    v_add_f32 v60, 1.0, v60
    v_add_f32 v61, 1.0, v61
    v_add_f32 v62, 1.0, v62
    v_add_f32 v63, 1.0, v63
    v_rcp_f32 v60, v60
    v_rcp_f32 v61, v61
    v_rcp_f32 v62, v62
    v_rcp_f32 v63, v63
    v_mul_f32 v60, v60, v52
    v_mul_f32 v61, v61, v53
    v_mul_f32 v62, v62, v54
    v_mul_f32 v63, v63, v55
    v_cvt_pk_bf16_f32 v48, v60, v61
    v_cvt_pk_bf16_f32 v49, v62, v63
    v_lshlrev_b32 v52, 16, v48
    v_and_b32 v53, 0xffff0000, v48
    v_lshlrev_b32 v54, 16, v49
    v_and_b32 v55, 0xffff0000, v49
    v_mul_f32 v52, v52, v56
    v_mul_f32 v53, v53, v57
    v_mul_f32 v54, v54, v58
    v_mul_f32 v55, v55, v59
    v_cvt_pk_bf16_f32 v64, v52, v53
    v_cvt_pk_bf16_f32 v65, v54, v55
    v_cvt_pk_bf16_f32 v48, v164, v165
    v_cvt_pk_bf16_f32 v49, v166, v167
    v_cvt_pk_bf16_f32 v50, v196, v197
    v_cvt_pk_bf16_f32 v51, v198, v199
    v_lshlrev_b32 v52, 16, v48
    v_and_b32 v53, 0xffff0000, v48
    v_lshlrev_b32 v54, 16, v49
    v_and_b32 v55, 0xffff0000, v49
    v_lshlrev_b32 v56, 16, v50
    v_and_b32 v57, 0xffff0000, v50
    v_lshlrev_b32 v58, 16, v51
    v_and_b32 v59, 0xffff0000, v51
    v_mul_f32 v60, 0xbfb8aa3b, v52
    v_mul_f32 v61, 0xbfb8aa3b, v53
    v_mul_f32 v62, 0xbfb8aa3b, v54
    v_mul_f32 v63, 0xbfb8aa3b, v55
    v_exp_f32 v60, v60
    v_exp_f32 v61, v61
    v_exp_f32 v62, v62
    v_exp_f32 v63, v63
    v_add_f32 v60, 1.0, v60
    v_add_f32 v61, 1.0, v61
    v_add_f32 v62, 1.0, v62
    v_add_f32 v63, 1.0, v63
    v_rcp_f32 v60, v60
    v_rcp_f32 v61, v61
    v_rcp_f32 v62, v62
    v_rcp_f32 v63, v63
    v_mul_f32 v60, v60, v52
    v_mul_f32 v61, v61, v53
    v_mul_f32 v62, v62, v54
    v_mul_f32 v63, v63, v55
    v_cvt_pk_bf16_f32 v48, v60, v61
    v_cvt_pk_bf16_f32 v49, v62, v63
    v_lshlrev_b32 v52, 16, v48
    v_and_b32 v53, 0xffff0000, v48
    v_lshlrev_b32 v54, 16, v49
    v_and_b32 v55, 0xffff0000, v49
    v_mul_f32 v52, v52, v56
    v_mul_f32 v53, v53, v57
    v_mul_f32 v54, v54, v58
    v_mul_f32 v55, v55, v59
    v_cvt_pk_bf16_f32 v66, v52, v53
    v_cvt_pk_bf16_f32 v67, v54, v55
    s_nop 0
    v_permlane16_swap_b32 v64, v66
    v_permlane16_swap_b32 v65, v67
    buffer_store_dwordx4 v[64:67], v12, s[32:35], 0 offen offset:1024 sc1
    v_cvt_pk_bf16_f32 v48, v168, v169
    v_cvt_pk_bf16_f32 v49, v170, v171
    v_cvt_pk_bf16_f32 v50, v200, v201
    v_cvt_pk_bf16_f32 v51, v202, v203
    v_lshlrev_b32 v52, 16, v48
    v_and_b32 v53, 0xffff0000, v48
    v_lshlrev_b32 v54, 16, v49
    v_and_b32 v55, 0xffff0000, v49
    v_lshlrev_b32 v56, 16, v50
    v_and_b32 v57, 0xffff0000, v50
    v_lshlrev_b32 v58, 16, v51
    v_and_b32 v59, 0xffff0000, v51
    v_mul_f32 v60, 0xbfb8aa3b, v52
    v_mul_f32 v61, 0xbfb8aa3b, v53
    v_mul_f32 v62, 0xbfb8aa3b, v54
    v_mul_f32 v63, 0xbfb8aa3b, v55
    v_exp_f32 v60, v60
    v_exp_f32 v61, v61
    v_exp_f32 v62, v62
    v_exp_f32 v63, v63
    v_add_f32 v60, 1.0, v60
    v_add_f32 v61, 1.0, v61
    v_add_f32 v62, 1.0, v62
    v_add_f32 v63, 1.0, v63
    v_rcp_f32 v60, v60
    v_rcp_f32 v61, v61
    v_rcp_f32 v62, v62
    v_rcp_f32 v63, v63
    v_mul_f32 v60, v60, v52
    v_mul_f32 v61, v61, v53
    v_mul_f32 v62, v62, v54
    v_mul_f32 v63, v63, v55
    v_cvt_pk_bf16_f32 v48, v60, v61
    v_cvt_pk_bf16_f32 v49, v62, v63
    v_lshlrev_b32 v52, 16, v48
    v_and_b32 v53, 0xffff0000, v48
    v_lshlrev_b32 v54, 16, v49
    v_and_b32 v55, 0xffff0000, v49
    v_mul_f32 v52, v52, v56
    v_mul_f32 v53, v53, v57
    v_mul_f32 v54, v54, v58
    v_mul_f32 v55, v55, v59
    v_cvt_pk_bf16_f32 v68, v52, v53
    v_cvt_pk_bf16_f32 v69, v54, v55
    v_cvt_pk_bf16_f32 v48, v172, v173
    v_cvt_pk_bf16_f32 v49, v174, v175
    v_cvt_pk_bf16_f32 v50, v204, v205
    v_cvt_pk_bf16_f32 v51, v206, v207
    v_lshlrev_b32 v52, 16, v48
    v_and_b32 v53, 0xffff0000, v48
    v_lshlrev_b32 v54, 16, v49
    v_and_b32 v55, 0xffff0000, v49
    v_lshlrev_b32 v56, 16, v50
    v_and_b32 v57, 0xffff0000, v50
    v_lshlrev_b32 v58, 16, v51
    v_and_b32 v59, 0xffff0000, v51
    v_mul_f32 v60, 0xbfb8aa3b, v52
    v_mul_f32 v61, 0xbfb8aa3b, v53
    v_mul_f32 v62, 0xbfb8aa3b, v54
    v_mul_f32 v63, 0xbfb8aa3b, v55
    v_exp_f32 v60, v60
    v_exp_f32 v61, v61
    v_exp_f32 v62, v62
    v_exp_f32 v63, v63
    v_add_f32 v60, 1.0, v60
    v_add_f32 v61, 1.0, v61
    v_add_f32 v62, 1.0, v62
    v_add_f32 v63, 1.0, v63
    v_rcp_f32 v60, v60
    v_rcp_f32 v61, v61
    v_rcp_f32 v62, v62
    v_rcp_f32 v63, v63
    v_mul_f32 v60, v60, v52
    v_mul_f32 v61, v61, v53
    v_mul_f32 v62, v62, v54
    v_mul_f32 v63, v63, v55
    v_cvt_pk_bf16_f32 v48, v60, v61
    v_cvt_pk_bf16_f32 v49, v62, v63
    v_lshlrev_b32 v52, 16, v48
    v_and_b32 v53, 0xffff0000, v48
    v_lshlrev_b32 v54, 16, v49
    v_and_b32 v55, 0xffff0000, v49
    v_mul_f32 v52, v52, v56
    v_mul_f32 v53, v53, v57
    v_mul_f32 v54, v54, v58
    v_mul_f32 v55, v55, v59
    v_cvt_pk_bf16_f32 v70, v52, v53
    v_cvt_pk_bf16_f32 v71, v54, v55
    s_nop 0
    v_permlane16_swap_b32 v68, v70
    v_permlane16_swap_b32 v69, v71
    buffer_store_dwordx4 v[68:71], v12, s[32:35], 0 offen offset:1536 sc1
    s_branch K1_done
K1_w5_setup:
    s_lshl_b32 s18, s17, 5
    s_mul_i32 s3, s48, 80
    v_add_u32 v13, s3, v1
    v_mul_u32_u24 v14, 205, v13
    v_lshrrev_b32 v14, 11, v14
    v_mul_u32_u24 v15, 10, v14
    v_sub_u32 v15, v13, v15
    v_and_b32 v16, 0x13, v14
    v_and_b32 v17, 8, v14
    v_lshrrev_b32 v17, 1, v17
    v_or_b32 v16, v16, v17
    v_and_b32 v17, 4, v14
    v_lshlrev_b32 v17, 1, v17
    v_or_b32 v16, v16, v17
    v_lshlrev_b32 v15, 4, v15
    v_mad_u32_u24 v6, v16, s17, v15
    v_add_u32 v13, 40, v13
    v_mul_u32_u24 v14, 205, v13
    v_lshrrev_b32 v14, 11, v14
    v_mul_u32_u24 v15, 10, v14
    v_sub_u32 v15, v13, v15
    v_and_b32 v16, 0x13, v14
    v_and_b32 v17, 8, v14
    v_lshrrev_b32 v17, 1, v17
    v_or_b32 v16, v16, v17
    v_and_b32 v17, 4, v14
    v_lshlrev_b32 v17, 1, v17
    v_or_b32 v16, v16, v17
    v_lshlrev_b32 v15, 4, v15
    v_mad_u32_u24 v7, v16, s17, v15
    s_mul_i32 s20, s47, 5120
    s_mul_i32 s3, s48, 1280
    s_add_u32 s20, s20, s3
    v_lshrrev_b32 v13, 2, v2
    v_and_b32 v14, 1, v3
    v_lshrrev_b32 v15, 1, v3
    v_lshlrev_b32 v15, 4, v15
    v_lshl_add_u32 v15, v14, 2, v15
    v_add_u32 v15, v15, v13
    v_mul_u32_u24 v15, 160, v15
    v_and_b32 v14, 3, v1
    v_lshl_add_u32 v8, v14, 3, v15
    s_and_b32 s54, s14, 3
    s_lshl_b32 s54, s54, 1
    s_add_u32 s54, s54, s15
    s_lshl_b32 s54, s54, 1
    s_and_b32 s54, s54, 0
    s_mul_i32 s19, s54, s18
    s_mov_b32 exec_hi, 0xff
    s_add_u32 m0, s20, 0
    s_nop 0
    buffer_load_dwordx4 v6, s[24:27], s19 offen lds
    s_add_u32 m0, s20, 640
    s_nop 0
    buffer_load_dwordx4 v7, s[24:27], s19 offen lds
    s_mov_b32 exec_hi, -1
    s_lshl_b32 s52, s54, 10
    s_add_u32 s54, s54, 1
    s_and_b32 s54, s54, 15
    s_mul_i32 s19, s54, s18
    buffer_load_dwordx4 v[16:19], v4, s[28:31], s52 offen
    buffer_load_dwordx4 v[20:23], v5, s[28:31], s52 offen
    s_mov_b32 exec_hi, 0xff
    s_add_u32 m0, s20, 10240
    s_nop 0
    buffer_load_dwordx4 v6, s[24:27], s19 offen lds
    s_add_u32 m0, s20, 10880
    s_nop 0
    buffer_load_dwordx4 v7, s[24:27], s19 offen lds
    s_mov_b32 exec_hi, -1
    s_lshl_b32 s52, s54, 10
    s_add_u32 s54, s54, 1
    s_and_b32 s54, s54, 15
    s_mul_i32 s19, s54, s18
    buffer_load_dwordx4 v[24:27], v4, s[28:31], s52 offen
    buffer_load_dwordx4 v[28:31], v5, s[28:31], s52 offen
    s_mov_b32 exec_hi, 0xff
    s_add_u32 m0, s20, 20480
    s_nop 0
    buffer_load_dwordx4 v6, s[24:27], s19 offen lds
    s_add_u32 m0, s20, 21120
    s_nop 0
    buffer_load_dwordx4 v7, s[24:27], s19 offen lds
    s_mov_b32 exec_hi, -1
    s_lshl_b32 s52, s54, 10
    s_add_u32 s54, s54, 1
    s_and_b32 s54, s54, 15
    s_mul_i32 s19, s54, s18
    buffer_load_dwordx4 v[32:35], v4, s[28:31], s52 offen
    buffer_load_dwordx4 v[36:39], v5, s[28:31], s52 offen
    s_mov_b32 exec_hi, 0xff
    s_add_u32 m0, s20, 30720
    s_nop 0
    buffer_load_dwordx4 v6, s[24:27], s19 offen lds
    s_add_u32 m0, s20, 31360
    s_nop 0
    buffer_load_dwordx4 v7, s[24:27], s19 offen lds
    s_mov_b32 exec_hi, -1
    s_lshl_b32 s52, s54, 10
    s_add_u32 s54, s54, 1
    s_and_b32 s54, s54, 15
    s_mul_i32 s19, s54, s18
    buffer_load_dwordx4 v[40:43], v4, s[28:31], s52 offen
    buffer_load_dwordx4 v[44:47], v5, s[28:31], s52 offen
    v_add_u32 v9, 61440, v8
    v_add_u32 v10, 122880, v8
    v_mov_b32 v144, 0
    v_mov_b32 v145, 0
    v_mov_b32 v146, 0
    v_mov_b32 v147, 0
    v_mov_b32 v148, 0
    v_mov_b32 v149, 0
    v_mov_b32 v150, 0
    v_mov_b32 v151, 0
    v_mov_b32 v152, 0
    v_mov_b32 v153, 0
    v_mov_b32 v154, 0
    v_mov_b32 v155, 0
    v_mov_b32 v156, 0
    v_mov_b32 v157, 0
    v_mov_b32 v158, 0
    v_mov_b32 v159, 0
    v_mov_b32 v160, 0
    v_mov_b32 v161, 0
    v_mov_b32 v162, 0
    v_mov_b32 v163, 0
    v_mov_b32 v164, 0
    v_mov_b32 v165, 0
    v_mov_b32 v166, 0
    v_mov_b32 v167, 0
    v_mov_b32 v168, 0
    v_mov_b32 v169, 0
    v_mov_b32 v170, 0
    v_mov_b32 v171, 0
    v_mov_b32 v172, 0
    v_mov_b32 v173, 0
    v_mov_b32 v174, 0
    v_mov_b32 v175, 0
    v_mov_b32 v176, 0
    v_mov_b32 v177, 0
    v_mov_b32 v178, 0
    v_mov_b32 v179, 0
    v_mov_b32 v180, 0
    v_mov_b32 v181, 0
    v_mov_b32 v182, 0
    v_mov_b32 v183, 0
    v_mov_b32 v184, 0
    v_mov_b32 v185, 0
    v_mov_b32 v186, 0
    v_mov_b32 v187, 0
    v_mov_b32 v188, 0
    v_mov_b32 v189, 0
    v_mov_b32 v190, 0
    v_mov_b32 v191, 0
    v_mov_b32 v192, 0
    v_mov_b32 v193, 0
    v_mov_b32 v194, 0
    v_mov_b32 v195, 0
    v_mov_b32 v196, 0
    v_mov_b32 v197, 0
    v_mov_b32 v198, 0
    v_mov_b32 v199, 0
    v_mov_b32 v200, 0
    v_mov_b32 v201, 0
    v_mov_b32 v202, 0
    v_mov_b32 v203, 0
    v_mov_b32 v204, 0
    v_mov_b32 v205, 0
    v_mov_b32 v206, 0
    v_mov_b32 v207, 0
    v_mov_b32 v208, 0
    v_mov_b32 v209, 0
    v_mov_b32 v210, 0
    v_mov_b32 v211, 0
    v_mov_b32 v212, 0
    v_mov_b32 v213, 0
    v_mov_b32 v214, 0
    v_mov_b32 v215, 0
    v_mov_b32 v216, 0
    v_mov_b32 v217, 0
    v_mov_b32 v218, 0
    v_mov_b32 v219, 0
    v_mov_b32 v220, 0
    v_mov_b32 v221, 0
    v_mov_b32 v222, 0
    v_mov_b32 v223, 0
    s_waitcnt vmcnt(14)
    s_barrier
    ds_read_b64_tr_b16 v[224:225], v8 offset:0
    ds_read_b64_tr_b16 v[226:227], v8 offset:1280
    ds_read_b64_tr_b16 v[228:229], v8 offset:32
    ds_read_b64_tr_b16 v[230:231], v8 offset:1312
    s_waitcnt vmcnt(6)
    s_barrier
    ds_read_b64_tr_b16 v[232:233], v8 offset:64
    ds_read_b64_tr_b16 v[234:235], v8 offset:1344
    s_waitcnt lgkmcnt(4)
    v_mfma_f32_16x16x32_bf16 v[144:147], v[224:227], v[16:19], v[144:147]
    v_mfma_f32_16x16x32_bf16 v[148:151], v[224:227], v[20:23], v[148:151]
    s_mov_b32 exec_hi, 0xff
    s_add_u32 m0, s20, 40960
    s_nop 0
    buffer_load_dwordx4 v6, s[24:27], s19 offen lds
    s_add_u32 m0, s20, 41600
    s_nop 0
    buffer_load_dwordx4 v7, s[24:27], s19 offen lds
    s_mov_b32 exec_hi, -1
    s_lshl_b32 s52, s54, 10
    s_add_u32 s54, s54, 1
    s_and_b32 s54, s54, 15
    s_mul_i32 s19, s54, s18
    ds_read_b64_tr_b16 v[236:237], v8 offset:96
    ds_read_b64_tr_b16 v[238:239], v8 offset:1376
    s_waitcnt lgkmcnt(4)
    v_mfma_f32_16x16x32_bf16 v[152:155], v[228:231], v[16:19], v[152:155]
    v_mfma_f32_16x16x32_bf16 v[156:159], v[228:231], v[20:23], v[156:159]
    ds_read_b64_tr_b16 v[224:225], v8 offset:128
    ds_read_b64_tr_b16 v[226:227], v8 offset:1408
    s_waitcnt lgkmcnt(4)
    v_mfma_f32_16x16x32_bf16 v[160:163], v[232:235], v[16:19], v[160:163]
    v_mfma_f32_16x16x32_bf16 v[164:167], v[232:235], v[20:23], v[164:167]
    buffer_load_dwordx4 v[48:51], v4, s[28:31], s52 offen
    ds_read_b64_tr_b16 v[228:229], v8 offset:5120
    ds_read_b64_tr_b16 v[230:231], v8 offset:6400
    s_waitcnt lgkmcnt(4)
    v_mfma_f32_16x16x32_bf16 v[168:171], v[236:239], v[16:19], v[168:171]
    v_mfma_f32_16x16x32_bf16 v[172:175], v[236:239], v[20:23], v[172:175]
    ds_read_b64_tr_b16 v[232:233], v8 offset:5152
    ds_read_b64_tr_b16 v[234:235], v8 offset:6432
    s_waitcnt lgkmcnt(4)
    v_mfma_f32_16x16x32_bf16 v[176:179], v[224:227], v[16:19], v[176:179]
    v_mfma_f32_16x16x32_bf16 v[180:183], v[224:227], v[20:23], v[180:183]
    buffer_load_dwordx4 v[52:55], v5, s[28:31], s52 offen
    ds_read_b64_tr_b16 v[236:237], v8 offset:5184
    ds_read_b64_tr_b16 v[238:239], v8 offset:6464
    s_waitcnt lgkmcnt(4)
    v_mfma_f32_16x16x32_bf16 v[184:187], v[228:231], v[16:19], v[184:187]
    v_mfma_f32_16x16x32_bf16 v[188:191], v[228:231], v[20:23], v[188:191]
    ds_read_b64_tr_b16 v[224:225], v8 offset:5216
    ds_read_b64_tr_b16 v[226:227], v8 offset:6496
    s_waitcnt lgkmcnt(4)
    v_mfma_f32_16x16x32_bf16 v[192:195], v[232:235], v[16:19], v[192:195]
    v_mfma_f32_16x16x32_bf16 v[196:199], v[232:235], v[20:23], v[196:199]
    ds_read_b64_tr_b16 v[228:229], v8 offset:5248
    ds_read_b64_tr_b16 v[230:231], v8 offset:6528
    s_waitcnt lgkmcnt(4)
    v_mfma_f32_16x16x32_bf16 v[200:203], v[236:239], v[16:19], v[200:203]
    v_mfma_f32_16x16x32_bf16 v[204:207], v[236:239], v[20:23], v[204:207]
    ds_read_b64_tr_b16 v[232:233], v8 offset:10240
    ds_read_b64_tr_b16 v[234:235], v8 offset:11520
    s_waitcnt lgkmcnt(4)
    v_mfma_f32_16x16x32_bf16 v[208:211], v[224:227], v[16:19], v[208:211]
    v_mfma_f32_16x16x32_bf16 v[212:215], v[224:227], v[20:23], v[212:215]
    ds_read_b64_tr_b16 v[236:237], v8 offset:10272
    ds_read_b64_tr_b16 v[238:239], v8 offset:11552
    s_waitcnt lgkmcnt(4)
    v_mfma_f32_16x16x32_bf16 v[216:219], v[228:231], v[16:19], v[216:219]
    v_mfma_f32_16x16x32_bf16 v[220:223], v[228:231], v[20:23], v[220:223]
    s_waitcnt vmcnt(12)
    ds_read_b64_tr_b16 v[224:225], v8 offset:10304
    ds_read_b64_tr_b16 v[226:227], v8 offset:11584
    s_waitcnt lgkmcnt(4)
    v_mfma_f32_16x16x32_bf16 v[144:147], v[232:235], v[24:27], v[144:147]
    v_mfma_f32_16x16x32_bf16 v[148:151], v[232:235], v[28:31], v[148:151]
    s_mov_b32 exec_hi, 0xff
    s_add_u32 m0, s20, 51200
    s_nop 0
    buffer_load_dwordx4 v6, s[24:27], s19 offen lds
    s_add_u32 m0, s20, 51840
    s_nop 0
    buffer_load_dwordx4 v7, s[24:27], s19 offen lds
    s_mov_b32 exec_hi, -1
    s_lshl_b32 s52, s54, 10
    s_add_u32 s54, s54, 1
    s_and_b32 s54, s54, 15
    s_mul_i32 s19, s54, s18
    ds_read_b64_tr_b16 v[228:229], v8 offset:10336
    ds_read_b64_tr_b16 v[230:231], v8 offset:11616
    s_waitcnt lgkmcnt(4)
    v_mfma_f32_16x16x32_bf16 v[152:155], v[236:239], v[24:27], v[152:155]
    v_mfma_f32_16x16x32_bf16 v[156:159], v[236:239], v[28:31], v[156:159]
    ds_read_b64_tr_b16 v[232:233], v8 offset:10368
    ds_read_b64_tr_b16 v[234:235], v8 offset:11648
    s_waitcnt lgkmcnt(4)
    v_mfma_f32_16x16x32_bf16 v[160:163], v[224:227], v[24:27], v[160:163]
    v_mfma_f32_16x16x32_bf16 v[164:167], v[224:227], v[28:31], v[164:167]
    buffer_load_dwordx4 v[56:59], v4, s[28:31], s52 offen
    ds_read_b64_tr_b16 v[236:237], v8 offset:15360
    ds_read_b64_tr_b16 v[238:239], v8 offset:16640
    s_waitcnt lgkmcnt(4)
    v_mfma_f32_16x16x32_bf16 v[168:171], v[228:231], v[24:27], v[168:171]
    v_mfma_f32_16x16x32_bf16 v[172:175], v[228:231], v[28:31], v[172:175]
    ds_read_b64_tr_b16 v[224:225], v8 offset:15392
    ds_read_b64_tr_b16 v[226:227], v8 offset:16672
    s_waitcnt lgkmcnt(4)
    v_mfma_f32_16x16x32_bf16 v[176:179], v[232:235], v[24:27], v[176:179]
    v_mfma_f32_16x16x32_bf16 v[180:183], v[232:235], v[28:31], v[180:183]
    buffer_load_dwordx4 v[60:63], v5, s[28:31], s52 offen
    ds_read_b64_tr_b16 v[228:229], v8 offset:15424
    ds_read_b64_tr_b16 v[230:231], v8 offset:16704
    s_waitcnt lgkmcnt(4)
    v_mfma_f32_16x16x32_bf16 v[184:187], v[236:239], v[24:27], v[184:187]
    v_mfma_f32_16x16x32_bf16 v[188:191], v[236:239], v[28:31], v[188:191]
    ds_read_b64_tr_b16 v[232:233], v8 offset:15456
    ds_read_b64_tr_b16 v[234:235], v8 offset:16736
    s_waitcnt lgkmcnt(4)
    v_mfma_f32_16x16x32_bf16 v[192:195], v[224:227], v[24:27], v[192:195]
    v_mfma_f32_16x16x32_bf16 v[196:199], v[224:227], v[28:31], v[196:199]
    ds_read_b64_tr_b16 v[236:237], v8 offset:15488
    ds_read_b64_tr_b16 v[238:239], v8 offset:16768
    s_waitcnt lgkmcnt(4)
    v_mfma_f32_16x16x32_bf16 v[200:203], v[228:231], v[24:27], v[200:203]
    v_mfma_f32_16x16x32_bf16 v[204:207], v[228:231], v[28:31], v[204:207]
    ds_read_b64_tr_b16 v[224:225], v8 offset:20480
    ds_read_b64_tr_b16 v[226:227], v8 offset:21760
    s_waitcnt lgkmcnt(4)
    v_mfma_f32_16x16x32_bf16 v[208:211], v[232:235], v[24:27], v[208:211]
    v_mfma_f32_16x16x32_bf16 v[212:215], v[232:235], v[28:31], v[212:215]
    ds_read_b64_tr_b16 v[228:229], v8 offset:20512
    ds_read_b64_tr_b16 v[230:231], v8 offset:21792
    s_waitcnt lgkmcnt(4)
    v_mfma_f32_16x16x32_bf16 v[216:219], v[236:239], v[24:27], v[216:219]
    v_mfma_f32_16x16x32_bf16 v[220:223], v[236:239], v[28:31], v[220:223]
    s_waitcnt vmcnt(6)
    s_barrier
    ds_read_b64_tr_b16 v[232:233], v8 offset:20544
    ds_read_b64_tr_b16 v[234:235], v8 offset:21824
    s_waitcnt lgkmcnt(4)
    v_mfma_f32_16x16x32_bf16 v[144:147], v[224:227], v[32:35], v[144:147]
    v_mfma_f32_16x16x32_bf16 v[148:151], v[224:227], v[36:39], v[148:151]
    s_mov_b32 exec_hi, 0xff
    s_add_u32 m0, s20, 61440
    s_nop 0
    buffer_load_dwordx4 v6, s[24:27], s19 offen lds
    s_add_u32 m0, s20, 62080
    s_nop 0
    buffer_load_dwordx4 v7, s[24:27], s19 offen lds
    s_mov_b32 exec_hi, -1
    s_lshl_b32 s52, s54, 10
    s_add_u32 s54, s54, 1
    s_and_b32 s54, s54, 15
    s_mul_i32 s19, s54, s18
    ds_read_b64_tr_b16 v[236:237], v8 offset:20576
    ds_read_b64_tr_b16 v[238:239], v8 offset:21856
    s_waitcnt lgkmcnt(4)
    v_mfma_f32_16x16x32_bf16 v[152:155], v[228:231], v[32:35], v[152:155]
    v_mfma_f32_16x16x32_bf16 v[156:159], v[228:231], v[36:39], v[156:159]
    ds_read_b64_tr_b16 v[224:225], v8 offset:20608
    ds_read_b64_tr_b16 v[226:227], v8 offset:21888
    s_waitcnt lgkmcnt(4)
    v_mfma_f32_16x16x32_bf16 v[160:163], v[232:235], v[32:35], v[160:163]
    v_mfma_f32_16x16x32_bf16 v[164:167], v[232:235], v[36:39], v[164:167]
    buffer_load_dwordx4 v[64:67], v4, s[28:31], s52 offen
    ds_read_b64_tr_b16 v[228:229], v8 offset:25600
    ds_read_b64_tr_b16 v[230:231], v8 offset:26880
    s_waitcnt lgkmcnt(4)
    v_mfma_f32_16x16x32_bf16 v[168:171], v[236:239], v[32:35], v[168:171]
    v_mfma_f32_16x16x32_bf16 v[172:175], v[236:239], v[36:39], v[172:175]
    ds_read_b64_tr_b16 v[232:233], v8 offset:25632
    ds_read_b64_tr_b16 v[234:235], v8 offset:26912
    s_waitcnt lgkmcnt(4)
    v_mfma_f32_16x16x32_bf16 v[176:179], v[224:227], v[32:35], v[176:179]
    v_mfma_f32_16x16x32_bf16 v[180:183], v[224:227], v[36:39], v[180:183]
    buffer_load_dwordx4 v[68:71], v5, s[28:31], s52 offen
    ds_read_b64_tr_b16 v[236:237], v8 offset:25664
    ds_read_b64_tr_b16 v[238:239], v8 offset:26944
    s_waitcnt lgkmcnt(4)
    v_mfma_f32_16x16x32_bf16 v[184:187], v[228:231], v[32:35], v[184:187]
    v_mfma_f32_16x16x32_bf16 v[188:191], v[228:231], v[36:39], v[188:191]
    ds_read_b64_tr_b16 v[224:225], v8 offset:25696
    ds_read_b64_tr_b16 v[226:227], v8 offset:26976
    s_waitcnt lgkmcnt(4)
    v_mfma_f32_16x16x32_bf16 v[192:195], v[232:235], v[32:35], v[192:195]
    v_mfma_f32_16x16x32_bf16 v[196:199], v[232:235], v[36:39], v[196:199]
    ds_read_b64_tr_b16 v[228:229], v8 offset:25728
    ds_read_b64_tr_b16 v[230:231], v8 offset:27008
    s_waitcnt lgkmcnt(4)
    v_mfma_f32_16x16x32_bf16 v[200:203], v[236:239], v[32:35], v[200:203]
    v_mfma_f32_16x16x32_bf16 v[204:207], v[236:239], v[36:39], v[204:207]
    ds_read_b64_tr_b16 v[232:233], v8 offset:30720
    ds_read_b64_tr_b16 v[234:235], v8 offset:32000
    s_waitcnt lgkmcnt(4)
    v_mfma_f32_16x16x32_bf16 v[208:211], v[224:227], v[32:35], v[208:211]
    v_mfma_f32_16x16x32_bf16 v[212:215], v[224:227], v[36:39], v[212:215]
    ds_read_b64_tr_b16 v[236:237], v8 offset:30752
    ds_read_b64_tr_b16 v[238:239], v8 offset:32032
    s_waitcnt lgkmcnt(4)
    v_mfma_f32_16x16x32_bf16 v[216:219], v[228:231], v[32:35], v[216:219]
    v_mfma_f32_16x16x32_bf16 v[220:223], v[228:231], v[36:39], v[220:223]
    s_waitcnt vmcnt(12)
    ds_read_b64_tr_b16 v[224:225], v8 offset:30784
    ds_read_b64_tr_b16 v[226:227], v8 offset:32064
    s_waitcnt lgkmcnt(4)
    v_mfma_f32_16x16x32_bf16 v[144:147], v[232:235], v[40:43], v[144:147]
    v_mfma_f32_16x16x32_bf16 v[148:151], v[232:235], v[44:47], v[148:151]
    s_mov_b32 exec_hi, 0xff
    s_add_u32 m0, s20, 71680
    s_nop 0
    buffer_load_dwordx4 v6, s[24:27], s19 offen lds
    s_add_u32 m0, s20, 72320
    s_nop 0
    buffer_load_dwordx4 v7, s[24:27], s19 offen lds
    s_mov_b32 exec_hi, -1
    s_lshl_b32 s52, s54, 10
    s_add_u32 s54, s54, 1
    s_and_b32 s54, s54, 15
    s_mul_i32 s19, s54, s18
    ds_read_b64_tr_b16 v[228:229], v8 offset:30816
    ds_read_b64_tr_b16 v[230:231], v8 offset:32096
    s_waitcnt lgkmcnt(4)
    v_mfma_f32_16x16x32_bf16 v[152:155], v[236:239], v[40:43], v[152:155]
    v_mfma_f32_16x16x32_bf16 v[156:159], v[236:239], v[44:47], v[156:159]
    ds_read_b64_tr_b16 v[232:233], v8 offset:30848
    ds_read_b64_tr_b16 v[234:235], v8 offset:32128
    s_waitcnt lgkmcnt(4)
    v_mfma_f32_16x16x32_bf16 v[160:163], v[224:227], v[40:43], v[160:163]
    v_mfma_f32_16x16x32_bf16 v[164:167], v[224:227], v[44:47], v[164:167]
    buffer_load_dwordx4 v[72:75], v4, s[28:31], s52 offen
    ds_read_b64_tr_b16 v[236:237], v8 offset:35840
    ds_read_b64_tr_b16 v[238:239], v8 offset:37120
    s_waitcnt lgkmcnt(4)
    v_mfma_f32_16x16x32_bf16 v[168:171], v[228:231], v[40:43], v[168:171]
    v_mfma_f32_16x16x32_bf16 v[172:175], v[228:231], v[44:47], v[172:175]
    ds_read_b64_tr_b16 v[224:225], v8 offset:35872
    ds_read_b64_tr_b16 v[226:227], v8 offset:37152
    s_waitcnt lgkmcnt(4)
    v_mfma_f32_16x16x32_bf16 v[176:179], v[232:235], v[40:43], v[176:179]
    v_mfma_f32_16x16x32_bf16 v[180:183], v[232:235], v[44:47], v[180:183]
    buffer_load_dwordx4 v[76:79], v5, s[28:31], s52 offen
    ds_read_b64_tr_b16 v[228:229], v8 offset:35904
    ds_read_b64_tr_b16 v[230:231], v8 offset:37184
    s_waitcnt lgkmcnt(4)
    v_mfma_f32_16x16x32_bf16 v[184:187], v[236:239], v[40:43], v[184:187]
    v_mfma_f32_16x16x32_bf16 v[188:191], v[236:239], v[44:47], v[188:191]
    ds_read_b64_tr_b16 v[232:233], v8 offset:35936
    ds_read_b64_tr_b16 v[234:235], v8 offset:37216
    s_waitcnt lgkmcnt(4)
    v_mfma_f32_16x16x32_bf16 v[192:195], v[224:227], v[40:43], v[192:195]
    v_mfma_f32_16x16x32_bf16 v[196:199], v[224:227], v[44:47], v[196:199]
    ds_read_b64_tr_b16 v[236:237], v8 offset:35968
    ds_read_b64_tr_b16 v[238:239], v8 offset:37248
    s_waitcnt lgkmcnt(4)
    v_mfma_f32_16x16x32_bf16 v[200:203], v[228:231], v[40:43], v[200:203]
    v_mfma_f32_16x16x32_bf16 v[204:207], v[228:231], v[44:47], v[204:207]
    ds_read_b64_tr_b16 v[224:225], v8 offset:40960
    ds_read_b64_tr_b16 v[226:227], v8 offset:42240
    s_waitcnt lgkmcnt(4)
    v_mfma_f32_16x16x32_bf16 v[208:211], v[232:235], v[40:43], v[208:211]
    v_mfma_f32_16x16x32_bf16 v[212:215], v[232:235], v[44:47], v[212:215]
    ds_read_b64_tr_b16 v[228:229], v8 offset:40992
    ds_read_b64_tr_b16 v[230:231], v8 offset:42272
    s_waitcnt lgkmcnt(4)
    v_mfma_f32_16x16x32_bf16 v[216:219], v[236:239], v[40:43], v[216:219]
    v_mfma_f32_16x16x32_bf16 v[220:223], v[236:239], v[44:47], v[220:223]
    s_waitcnt vmcnt(6)
    s_barrier
    ds_read_b64_tr_b16 v[232:233], v8 offset:41024
    ds_read_b64_tr_b16 v[234:235], v8 offset:42304
    s_waitcnt lgkmcnt(4)
    v_mfma_f32_16x16x32_bf16 v[144:147], v[224:227], v[48:51], v[144:147]
    v_mfma_f32_16x16x32_bf16 v[148:151], v[224:227], v[52:55], v[148:151]
    s_mov_b32 exec_hi, 0xff
    s_add_u32 m0, s20, 81920
    s_nop 0
    buffer_load_dwordx4 v6, s[24:27], s19 offen lds
    s_add_u32 m0, s20, 82560
    s_nop 0
    buffer_load_dwordx4 v7, s[24:27], s19 offen lds
    s_mov_b32 exec_hi, -1
    s_lshl_b32 s52, s54, 10
    s_add_u32 s54, s54, 1
    s_and_b32 s54, s54, 15
    s_mul_i32 s19, s54, s18
    ds_read_b64_tr_b16 v[236:237], v8 offset:41056
    ds_read_b64_tr_b16 v[238:239], v8 offset:42336
    s_waitcnt lgkmcnt(4)
    v_mfma_f32_16x16x32_bf16 v[152:155], v[228:231], v[48:51], v[152:155]
    v_mfma_f32_16x16x32_bf16 v[156:159], v[228:231], v[52:55], v[156:159]
    ds_read_b64_tr_b16 v[224:225], v8 offset:41088
    ds_read_b64_tr_b16 v[226:227], v8 offset:42368
    s_waitcnt lgkmcnt(4)
    v_mfma_f32_16x16x32_bf16 v[160:163], v[232:235], v[48:51], v[160:163]
    v_mfma_f32_16x16x32_bf16 v[164:167], v[232:235], v[52:55], v[164:167]
    buffer_load_dwordx4 v[80:83], v4, s[28:31], s52 offen
    ds_read_b64_tr_b16 v[228:229], v8 offset:46080
    ds_read_b64_tr_b16 v[230:231], v8 offset:47360
    s_waitcnt lgkmcnt(4)
    v_mfma_f32_16x16x32_bf16 v[168:171], v[236:239], v[48:51], v[168:171]
    v_mfma_f32_16x16x32_bf16 v[172:175], v[236:239], v[52:55], v[172:175]
    ds_read_b64_tr_b16 v[232:233], v8 offset:46112
    ds_read_b64_tr_b16 v[234:235], v8 offset:47392
    s_waitcnt lgkmcnt(4)
    v_mfma_f32_16x16x32_bf16 v[176:179], v[224:227], v[48:51], v[176:179]
    v_mfma_f32_16x16x32_bf16 v[180:183], v[224:227], v[52:55], v[180:183]
    buffer_load_dwordx4 v[84:87], v5, s[28:31], s52 offen
    ds_read_b64_tr_b16 v[236:237], v8 offset:46144
    ds_read_b64_tr_b16 v[238:239], v8 offset:47424
    s_waitcnt lgkmcnt(4)
    v_mfma_f32_16x16x32_bf16 v[184:187], v[228:231], v[48:51], v[184:187]
    v_mfma_f32_16x16x32_bf16 v[188:191], v[228:231], v[52:55], v[188:191]
    ds_read_b64_tr_b16 v[224:225], v8 offset:46176
    ds_read_b64_tr_b16 v[226:227], v8 offset:47456
    s_waitcnt lgkmcnt(4)
    v_mfma_f32_16x16x32_bf16 v[192:195], v[232:235], v[48:51], v[192:195]
    v_mfma_f32_16x16x32_bf16 v[196:199], v[232:235], v[52:55], v[196:199]
    ds_read_b64_tr_b16 v[228:229], v8 offset:46208
    ds_read_b64_tr_b16 v[230:231], v8 offset:47488
    s_waitcnt lgkmcnt(4)
    v_mfma_f32_16x16x32_bf16 v[200:203], v[236:239], v[48:51], v[200:203]
    v_mfma_f32_16x16x32_bf16 v[204:207], v[236:239], v[52:55], v[204:207]
    ds_read_b64_tr_b16 v[232:233], v8 offset:51200
    ds_read_b64_tr_b16 v[234:235], v8 offset:52480
    s_waitcnt lgkmcnt(4)
    v_mfma_f32_16x16x32_bf16 v[208:211], v[224:227], v[48:51], v[208:211]
    v_mfma_f32_16x16x32_bf16 v[212:215], v[224:227], v[52:55], v[212:215]
    ds_read_b64_tr_b16 v[236:237], v8 offset:51232
    ds_read_b64_tr_b16 v[238:239], v8 offset:52512
    s_waitcnt lgkmcnt(4)
    v_mfma_f32_16x16x32_bf16 v[216:219], v[228:231], v[48:51], v[216:219]
    v_mfma_f32_16x16x32_bf16 v[220:223], v[228:231], v[52:55], v[220:223]
    s_waitcnt vmcnt(12)
    ds_read_b64_tr_b16 v[224:225], v8 offset:51264
    ds_read_b64_tr_b16 v[226:227], v8 offset:52544
    s_waitcnt lgkmcnt(4)
    v_mfma_f32_16x16x32_bf16 v[144:147], v[232:235], v[56:59], v[144:147]
    v_mfma_f32_16x16x32_bf16 v[148:151], v[232:235], v[60:63], v[148:151]
    s_mov_b32 exec_hi, 0xff
    s_add_u32 m0, s20, 92160
    s_nop 0
    buffer_load_dwordx4 v6, s[24:27], s19 offen lds
    s_add_u32 m0, s20, 92800
    s_nop 0
    buffer_load_dwordx4 v7, s[24:27], s19 offen lds
    s_mov_b32 exec_hi, -1
    s_lshl_b32 s52, s54, 10
    s_add_u32 s54, s54, 1
    s_and_b32 s54, s54, 15
    s_mul_i32 s19, s54, s18
    ds_read_b64_tr_b16 v[228:229], v8 offset:51296
    ds_read_b64_tr_b16 v[230:231], v8 offset:52576
    s_waitcnt lgkmcnt(4)
    v_mfma_f32_16x16x32_bf16 v[152:155], v[236:239], v[56:59], v[152:155]
    v_mfma_f32_16x16x32_bf16 v[156:159], v[236:239], v[60:63], v[156:159]
    ds_read_b64_tr_b16 v[232:233], v8 offset:51328
    ds_read_b64_tr_b16 v[234:235], v8 offset:52608
    s_waitcnt lgkmcnt(4)
    v_mfma_f32_16x16x32_bf16 v[160:163], v[224:227], v[56:59], v[160:163]
    v_mfma_f32_16x16x32_bf16 v[164:167], v[224:227], v[60:63], v[164:167]
    buffer_load_dwordx4 v[88:91], v4, s[28:31], s52 offen
    ds_read_b64_tr_b16 v[236:237], v8 offset:56320
    ds_read_b64_tr_b16 v[238:239], v8 offset:57600
    s_waitcnt lgkmcnt(4)
    v_mfma_f32_16x16x32_bf16 v[168:171], v[228:231], v[56:59], v[168:171]
    v_mfma_f32_16x16x32_bf16 v[172:175], v[228:231], v[60:63], v[172:175]
    ds_read_b64_tr_b16 v[224:225], v8 offset:56352
    ds_read_b64_tr_b16 v[226:227], v8 offset:57632
    s_waitcnt lgkmcnt(4)
    v_mfma_f32_16x16x32_bf16 v[176:179], v[232:235], v[56:59], v[176:179]
    v_mfma_f32_16x16x32_bf16 v[180:183], v[232:235], v[60:63], v[180:183]
    buffer_load_dwordx4 v[92:95], v5, s[28:31], s52 offen
    ds_read_b64_tr_b16 v[228:229], v8 offset:56384
    ds_read_b64_tr_b16 v[230:231], v8 offset:57664
    s_waitcnt lgkmcnt(4)
    v_mfma_f32_16x16x32_bf16 v[184:187], v[236:239], v[56:59], v[184:187]
    v_mfma_f32_16x16x32_bf16 v[188:191], v[236:239], v[60:63], v[188:191]
    ds_read_b64_tr_b16 v[232:233], v8 offset:56416
    ds_read_b64_tr_b16 v[234:235], v8 offset:57696
    s_waitcnt lgkmcnt(4)
    v_mfma_f32_16x16x32_bf16 v[192:195], v[224:227], v[56:59], v[192:195]
    v_mfma_f32_16x16x32_bf16 v[196:199], v[224:227], v[60:63], v[196:199]
    ds_read_b64_tr_b16 v[236:237], v8 offset:56448
    ds_read_b64_tr_b16 v[238:239], v8 offset:57728
    s_waitcnt lgkmcnt(4)
    v_mfma_f32_16x16x32_bf16 v[200:203], v[228:231], v[56:59], v[200:203]
    v_mfma_f32_16x16x32_bf16 v[204:207], v[228:231], v[60:63], v[204:207]
    ds_read_b64_tr_b16 v[224:225], v9 offset:0
    ds_read_b64_tr_b16 v[226:227], v9 offset:1280
    s_waitcnt lgkmcnt(4)
    v_mfma_f32_16x16x32_bf16 v[208:211], v[232:235], v[56:59], v[208:211]
    v_mfma_f32_16x16x32_bf16 v[212:215], v[232:235], v[60:63], v[212:215]
    ds_read_b64_tr_b16 v[228:229], v9 offset:32
    ds_read_b64_tr_b16 v[230:231], v9 offset:1312
    s_waitcnt lgkmcnt(4)
    v_mfma_f32_16x16x32_bf16 v[216:219], v[236:239], v[56:59], v[216:219]
    v_mfma_f32_16x16x32_bf16 v[220:223], v[236:239], v[60:63], v[220:223]
    s_waitcnt vmcnt(6)
    s_barrier
    ds_read_b64_tr_b16 v[232:233], v9 offset:64
    ds_read_b64_tr_b16 v[234:235], v9 offset:1344
    s_waitcnt lgkmcnt(4)
    v_mfma_f32_16x16x32_bf16 v[144:147], v[224:227], v[64:67], v[144:147]
    v_mfma_f32_16x16x32_bf16 v[148:151], v[224:227], v[68:71], v[148:151]
    s_mov_b32 exec_hi, 0xff
    s_add_u32 m0, s20, 102400
    s_nop 0
    buffer_load_dwordx4 v6, s[24:27], s19 offen lds
    s_add_u32 m0, s20, 103040
    s_nop 0
    buffer_load_dwordx4 v7, s[24:27], s19 offen lds
    s_mov_b32 exec_hi, -1
    s_lshl_b32 s52, s54, 10
    s_add_u32 s54, s54, 1
    s_and_b32 s54, s54, 15
    s_mul_i32 s19, s54, s18
    ds_read_b64_tr_b16 v[236:237], v9 offset:96
    ds_read_b64_tr_b16 v[238:239], v9 offset:1376
    s_waitcnt lgkmcnt(4)
    v_mfma_f32_16x16x32_bf16 v[152:155], v[228:231], v[64:67], v[152:155]
    v_mfma_f32_16x16x32_bf16 v[156:159], v[228:231], v[68:71], v[156:159]
    ds_read_b64_tr_b16 v[224:225], v9 offset:128
    ds_read_b64_tr_b16 v[226:227], v9 offset:1408
    s_waitcnt lgkmcnt(4)
    v_mfma_f32_16x16x32_bf16 v[160:163], v[232:235], v[64:67], v[160:163]
    v_mfma_f32_16x16x32_bf16 v[164:167], v[232:235], v[68:71], v[164:167]
    buffer_load_dwordx4 v[96:99], v4, s[28:31], s52 offen
    ds_read_b64_tr_b16 v[228:229], v9 offset:5120
    ds_read_b64_tr_b16 v[230:231], v9 offset:6400
    s_waitcnt lgkmcnt(4)
    v_mfma_f32_16x16x32_bf16 v[168:171], v[236:239], v[64:67], v[168:171]
    v_mfma_f32_16x16x32_bf16 v[172:175], v[236:239], v[68:71], v[172:175]
    ds_read_b64_tr_b16 v[232:233], v9 offset:5152
    ds_read_b64_tr_b16 v[234:235], v9 offset:6432
    s_waitcnt lgkmcnt(4)
    v_mfma_f32_16x16x32_bf16 v[176:179], v[224:227], v[64:67], v[176:179]
    v_mfma_f32_16x16x32_bf16 v[180:183], v[224:227], v[68:71], v[180:183]
    buffer_load_dwordx4 v[100:103], v5, s[28:31], s52 offen
    ds_read_b64_tr_b16 v[236:237], v9 offset:5184
    ds_read_b64_tr_b16 v[238:239], v9 offset:6464
    s_waitcnt lgkmcnt(4)
    v_mfma_f32_16x16x32_bf16 v[184:187], v[228:231], v[64:67], v[184:187]
    v_mfma_f32_16x16x32_bf16 v[188:191], v[228:231], v[68:71], v[188:191]
    ds_read_b64_tr_b16 v[224:225], v9 offset:5216
    ds_read_b64_tr_b16 v[226:227], v9 offset:6496
    s_waitcnt lgkmcnt(4)
    v_mfma_f32_16x16x32_bf16 v[192:195], v[232:235], v[64:67], v[192:195]
    v_mfma_f32_16x16x32_bf16 v[196:199], v[232:235], v[68:71], v[196:199]
    ds_read_b64_tr_b16 v[228:229], v9 offset:5248
    ds_read_b64_tr_b16 v[230:231], v9 offset:6528
    s_waitcnt lgkmcnt(4)
    v_mfma_f32_16x16x32_bf16 v[200:203], v[236:239], v[64:67], v[200:203]
    v_mfma_f32_16x16x32_bf16 v[204:207], v[236:239], v[68:71], v[204:207]
    ds_read_b64_tr_b16 v[232:233], v9 offset:10240
    ds_read_b64_tr_b16 v[234:235], v9 offset:11520
    s_waitcnt lgkmcnt(4)
    v_mfma_f32_16x16x32_bf16 v[208:211], v[224:227], v[64:67], v[208:211]
    v_mfma_f32_16x16x32_bf16 v[212:215], v[224:227], v[68:71], v[212:215]
    ds_read_b64_tr_b16 v[236:237], v9 offset:10272
    ds_read_b64_tr_b16 v[238:239], v9 offset:11552
    s_waitcnt lgkmcnt(4)
    v_mfma_f32_16x16x32_bf16 v[216:219], v[228:231], v[64:67], v[216:219]
    v_mfma_f32_16x16x32_bf16 v[220:223], v[228:231], v[68:71], v[220:223]
    s_waitcnt vmcnt(12)
    ds_read_b64_tr_b16 v[224:225], v9 offset:10304
    ds_read_b64_tr_b16 v[226:227], v9 offset:11584
    s_waitcnt lgkmcnt(4)
    v_mfma_f32_16x16x32_bf16 v[144:147], v[232:235], v[72:75], v[144:147]
    v_mfma_f32_16x16x32_bf16 v[148:151], v[232:235], v[76:79], v[148:151]
    s_mov_b32 exec_hi, 0xff
    s_add_u32 m0, s20, 112640
    s_nop 0
    buffer_load_dwordx4 v6, s[24:27], s19 offen lds
    s_add_u32 m0, s20, 113280
    s_nop 0
    buffer_load_dwordx4 v7, s[24:27], s19 offen lds
    s_mov_b32 exec_hi, -1
    s_lshl_b32 s52, s54, 10
    s_add_u32 s54, s54, 1
    s_and_b32 s54, s54, 15
    s_mul_i32 s19, s54, s18
    ds_read_b64_tr_b16 v[228:229], v9 offset:10336
    ds_read_b64_tr_b16 v[230:231], v9 offset:11616
    s_waitcnt lgkmcnt(4)
    v_mfma_f32_16x16x32_bf16 v[152:155], v[236:239], v[72:75], v[152:155]
    v_mfma_f32_16x16x32_bf16 v[156:159], v[236:239], v[76:79], v[156:159]
    ds_read_b64_tr_b16 v[232:233], v9 offset:10368
    ds_read_b64_tr_b16 v[234:235], v9 offset:11648
    s_waitcnt lgkmcnt(4)
    v_mfma_f32_16x16x32_bf16 v[160:163], v[224:227], v[72:75], v[160:163]
    v_mfma_f32_16x16x32_bf16 v[164:167], v[224:227], v[76:79], v[164:167]
    buffer_load_dwordx4 v[104:107], v4, s[28:31], s52 offen
    ds_read_b64_tr_b16 v[236:237], v9 offset:15360
    ds_read_b64_tr_b16 v[238:239], v9 offset:16640
    s_waitcnt lgkmcnt(4)
    v_mfma_f32_16x16x32_bf16 v[168:171], v[228:231], v[72:75], v[168:171]
    v_mfma_f32_16x16x32_bf16 v[172:175], v[228:231], v[76:79], v[172:175]
    ds_read_b64_tr_b16 v[224:225], v9 offset:15392
    ds_read_b64_tr_b16 v[226:227], v9 offset:16672
    s_waitcnt lgkmcnt(4)
    v_mfma_f32_16x16x32_bf16 v[176:179], v[232:235], v[72:75], v[176:179]
    v_mfma_f32_16x16x32_bf16 v[180:183], v[232:235], v[76:79], v[180:183]
    buffer_load_dwordx4 v[108:111], v5, s[28:31], s52 offen
    ds_read_b64_tr_b16 v[228:229], v9 offset:15424
    ds_read_b64_tr_b16 v[230:231], v9 offset:16704
    s_waitcnt lgkmcnt(4)
    v_mfma_f32_16x16x32_bf16 v[184:187], v[236:239], v[72:75], v[184:187]
    v_mfma_f32_16x16x32_bf16 v[188:191], v[236:239], v[76:79], v[188:191]
    ds_read_b64_tr_b16 v[232:233], v9 offset:15456
    ds_read_b64_tr_b16 v[234:235], v9 offset:16736
    s_waitcnt lgkmcnt(4)
    v_mfma_f32_16x16x32_bf16 v[192:195], v[224:227], v[72:75], v[192:195]
    v_mfma_f32_16x16x32_bf16 v[196:199], v[224:227], v[76:79], v[196:199]
    ds_read_b64_tr_b16 v[236:237], v9 offset:15488
    ds_read_b64_tr_b16 v[238:239], v9 offset:16768
    s_waitcnt lgkmcnt(4)
    v_mfma_f32_16x16x32_bf16 v[200:203], v[228:231], v[72:75], v[200:203]
    v_mfma_f32_16x16x32_bf16 v[204:207], v[228:231], v[76:79], v[204:207]
    ds_read_b64_tr_b16 v[224:225], v9 offset:20480
    ds_read_b64_tr_b16 v[226:227], v9 offset:21760
    s_waitcnt lgkmcnt(4)
    v_mfma_f32_16x16x32_bf16 v[208:211], v[232:235], v[72:75], v[208:211]
    v_mfma_f32_16x16x32_bf16 v[212:215], v[232:235], v[76:79], v[212:215]
    ds_read_b64_tr_b16 v[228:229], v9 offset:20512
    ds_read_b64_tr_b16 v[230:231], v9 offset:21792
    s_waitcnt lgkmcnt(4)
    v_mfma_f32_16x16x32_bf16 v[216:219], v[236:239], v[72:75], v[216:219]
    v_mfma_f32_16x16x32_bf16 v[220:223], v[236:239], v[76:79], v[220:223]
    s_waitcnt vmcnt(6)
    s_barrier
    ds_read_b64_tr_b16 v[232:233], v9 offset:20544
    ds_read_b64_tr_b16 v[234:235], v9 offset:21824
    s_waitcnt lgkmcnt(4)
    v_mfma_f32_16x16x32_bf16 v[144:147], v[224:227], v[80:83], v[144:147]
    v_mfma_f32_16x16x32_bf16 v[148:151], v[224:227], v[84:87], v[148:151]
    s_mov_b32 exec_hi, 0xff
    s_add_u32 m0, s20, 122880
    s_nop 0
    buffer_load_dwordx4 v6, s[24:27], s19 offen lds
    s_add_u32 m0, s20, 123520
    s_nop 0
    buffer_load_dwordx4 v7, s[24:27], s19 offen lds
    s_mov_b32 exec_hi, -1
    s_lshl_b32 s52, s54, 10
    s_add_u32 s54, s54, 1
    s_and_b32 s54, s54, 15
    s_mul_i32 s19, s54, s18
    ds_read_b64_tr_b16 v[236:237], v9 offset:20576
    ds_read_b64_tr_b16 v[238:239], v9 offset:21856
    s_waitcnt lgkmcnt(4)
    v_mfma_f32_16x16x32_bf16 v[152:155], v[228:231], v[80:83], v[152:155]
    v_mfma_f32_16x16x32_bf16 v[156:159], v[228:231], v[84:87], v[156:159]
    ds_read_b64_tr_b16 v[224:225], v9 offset:20608
    ds_read_b64_tr_b16 v[226:227], v9 offset:21888
    s_waitcnt lgkmcnt(4)
    v_mfma_f32_16x16x32_bf16 v[160:163], v[232:235], v[80:83], v[160:163]
    v_mfma_f32_16x16x32_bf16 v[164:167], v[232:235], v[84:87], v[164:167]
    buffer_load_dwordx4 v[112:115], v4, s[28:31], s52 offen
    ds_read_b64_tr_b16 v[228:229], v9 offset:25600
    ds_read_b64_tr_b16 v[230:231], v9 offset:26880
    s_waitcnt lgkmcnt(4)
    v_mfma_f32_16x16x32_bf16 v[168:171], v[236:239], v[80:83], v[168:171]
    v_mfma_f32_16x16x32_bf16 v[172:175], v[236:239], v[84:87], v[172:175]
    ds_read_b64_tr_b16 v[232:233], v9 offset:25632
    ds_read_b64_tr_b16 v[234:235], v9 offset:26912
    s_waitcnt lgkmcnt(4)
    v_mfma_f32_16x16x32_bf16 v[176:179], v[224:227], v[80:83], v[176:179]
    v_mfma_f32_16x16x32_bf16 v[180:183], v[224:227], v[84:87], v[180:183]
    buffer_load_dwordx4 v[116:119], v5, s[28:31], s52 offen
    ds_read_b64_tr_b16 v[236:237], v9 offset:25664
    ds_read_b64_tr_b16 v[238:239], v9 offset:26944
    s_waitcnt lgkmcnt(4)
    v_mfma_f32_16x16x32_bf16 v[184:187], v[228:231], v[80:83], v[184:187]
    v_mfma_f32_16x16x32_bf16 v[188:191], v[228:231], v[84:87], v[188:191]
    ds_read_b64_tr_b16 v[224:225], v9 offset:25696
    ds_read_b64_tr_b16 v[226:227], v9 offset:26976
    s_waitcnt lgkmcnt(4)
    v_mfma_f32_16x16x32_bf16 v[192:195], v[232:235], v[80:83], v[192:195]
    v_mfma_f32_16x16x32_bf16 v[196:199], v[232:235], v[84:87], v[196:199]
    ds_read_b64_tr_b16 v[228:229], v9 offset:25728
    ds_read_b64_tr_b16 v[230:231], v9 offset:27008
    s_waitcnt lgkmcnt(4)
    v_mfma_f32_16x16x32_bf16 v[200:203], v[236:239], v[80:83], v[200:203]
    v_mfma_f32_16x16x32_bf16 v[204:207], v[236:239], v[84:87], v[204:207]
    ds_read_b64_tr_b16 v[232:233], v9 offset:30720
    ds_read_b64_tr_b16 v[234:235], v9 offset:32000
    s_waitcnt lgkmcnt(4)
    v_mfma_f32_16x16x32_bf16 v[208:211], v[224:227], v[80:83], v[208:211]
    v_mfma_f32_16x16x32_bf16 v[212:215], v[224:227], v[84:87], v[212:215]
    ds_read_b64_tr_b16 v[236:237], v9 offset:30752
    ds_read_b64_tr_b16 v[238:239], v9 offset:32032
    s_waitcnt lgkmcnt(4)
    v_mfma_f32_16x16x32_bf16 v[216:219], v[228:231], v[80:83], v[216:219]
    v_mfma_f32_16x16x32_bf16 v[220:223], v[228:231], v[84:87], v[220:223]
    s_waitcnt vmcnt(12)
    ds_read_b64_tr_b16 v[224:225], v9 offset:30784
    ds_read_b64_tr_b16 v[226:227], v9 offset:32064
    s_waitcnt lgkmcnt(4)
    v_mfma_f32_16x16x32_bf16 v[144:147], v[232:235], v[88:91], v[144:147]
    v_mfma_f32_16x16x32_bf16 v[148:151], v[232:235], v[92:95], v[148:151]
    s_mov_b32 exec_hi, 0xff
    s_add_u32 m0, s20, 133120
    s_nop 0
    buffer_load_dwordx4 v6, s[24:27], s19 offen lds
    s_add_u32 m0, s20, 133760
    s_nop 0
    buffer_load_dwordx4 v7, s[24:27], s19 offen lds
    s_mov_b32 exec_hi, -1
    s_lshl_b32 s52, s54, 10
    s_add_u32 s54, s54, 1
    s_and_b32 s54, s54, 15
    s_mul_i32 s19, s54, s18
    ds_read_b64_tr_b16 v[228:229], v9 offset:30816
    ds_read_b64_tr_b16 v[230:231], v9 offset:32096
    s_waitcnt lgkmcnt(4)
    v_mfma_f32_16x16x32_bf16 v[152:155], v[236:239], v[88:91], v[152:155]
    v_mfma_f32_16x16x32_bf16 v[156:159], v[236:239], v[92:95], v[156:159]
    ds_read_b64_tr_b16 v[232:233], v9 offset:30848
    ds_read_b64_tr_b16 v[234:235], v9 offset:32128
    s_waitcnt lgkmcnt(4)
    v_mfma_f32_16x16x32_bf16 v[160:163], v[224:227], v[88:91], v[160:163]
    v_mfma_f32_16x16x32_bf16 v[164:167], v[224:227], v[92:95], v[164:167]
    buffer_load_dwordx4 v[120:123], v4, s[28:31], s52 offen
    ds_read_b64_tr_b16 v[236:237], v9 offset:35840
    ds_read_b64_tr_b16 v[238:239], v9 offset:37120
    s_waitcnt lgkmcnt(4)
    v_mfma_f32_16x16x32_bf16 v[168:171], v[228:231], v[88:91], v[168:171]
    v_mfma_f32_16x16x32_bf16 v[172:175], v[228:231], v[92:95], v[172:175]
    ds_read_b64_tr_b16 v[224:225], v9 offset:35872
    ds_read_b64_tr_b16 v[226:227], v9 offset:37152
    s_waitcnt lgkmcnt(4)
    v_mfma_f32_16x16x32_bf16 v[176:179], v[232:235], v[88:91], v[176:179]
    v_mfma_f32_16x16x32_bf16 v[180:183], v[232:235], v[92:95], v[180:183]
    buffer_load_dwordx4 v[124:127], v5, s[28:31], s52 offen
    ds_read_b64_tr_b16 v[228:229], v9 offset:35904
    ds_read_b64_tr_b16 v[230:231], v9 offset:37184
    s_waitcnt lgkmcnt(4)
    v_mfma_f32_16x16x32_bf16 v[184:187], v[236:239], v[88:91], v[184:187]
    v_mfma_f32_16x16x32_bf16 v[188:191], v[236:239], v[92:95], v[188:191]
    ds_read_b64_tr_b16 v[232:233], v9 offset:35936
    ds_read_b64_tr_b16 v[234:235], v9 offset:37216
    s_waitcnt lgkmcnt(4)
    v_mfma_f32_16x16x32_bf16 v[192:195], v[224:227], v[88:91], v[192:195]
    v_mfma_f32_16x16x32_bf16 v[196:199], v[224:227], v[92:95], v[196:199]
    ds_read_b64_tr_b16 v[236:237], v9 offset:35968
    ds_read_b64_tr_b16 v[238:239], v9 offset:37248
    s_waitcnt lgkmcnt(4)
    v_mfma_f32_16x16x32_bf16 v[200:203], v[228:231], v[88:91], v[200:203]
    v_mfma_f32_16x16x32_bf16 v[204:207], v[228:231], v[92:95], v[204:207]
    ds_read_b64_tr_b16 v[224:225], v9 offset:40960
    ds_read_b64_tr_b16 v[226:227], v9 offset:42240
    s_waitcnt lgkmcnt(4)
    v_mfma_f32_16x16x32_bf16 v[208:211], v[232:235], v[88:91], v[208:211]
    v_mfma_f32_16x16x32_bf16 v[212:215], v[232:235], v[92:95], v[212:215]
    ds_read_b64_tr_b16 v[228:229], v9 offset:40992
    ds_read_b64_tr_b16 v[230:231], v9 offset:42272
    s_waitcnt lgkmcnt(4)
    v_mfma_f32_16x16x32_bf16 v[216:219], v[236:239], v[88:91], v[216:219]
    v_mfma_f32_16x16x32_bf16 v[220:223], v[236:239], v[92:95], v[220:223]
    s_waitcnt vmcnt(6)
    s_barrier
    ds_read_b64_tr_b16 v[232:233], v9 offset:41024
    ds_read_b64_tr_b16 v[234:235], v9 offset:42304
    s_waitcnt lgkmcnt(4)
    v_mfma_f32_16x16x32_bf16 v[144:147], v[224:227], v[96:99], v[144:147]
    v_mfma_f32_16x16x32_bf16 v[148:151], v[224:227], v[100:103], v[148:151]
    s_mov_b32 exec_hi, 0xff
    s_add_u32 m0, s20, 143360
    s_nop 0
    buffer_load_dwordx4 v6, s[24:27], s19 offen lds
    s_add_u32 m0, s20, 144000
    s_nop 0
    buffer_load_dwordx4 v7, s[24:27], s19 offen lds
    s_mov_b32 exec_hi, -1
    s_lshl_b32 s52, s54, 10
    s_add_u32 s54, s54, 1
    s_and_b32 s54, s54, 15
    s_mul_i32 s19, s54, s18
    ds_read_b64_tr_b16 v[236:237], v9 offset:41056
    ds_read_b64_tr_b16 v[238:239], v9 offset:42336
    s_waitcnt lgkmcnt(4)
    v_mfma_f32_16x16x32_bf16 v[152:155], v[228:231], v[96:99], v[152:155]
    v_mfma_f32_16x16x32_bf16 v[156:159], v[228:231], v[100:103], v[156:159]
    ds_read_b64_tr_b16 v[224:225], v9 offset:41088
    ds_read_b64_tr_b16 v[226:227], v9 offset:42368
    s_waitcnt lgkmcnt(4)
    v_mfma_f32_16x16x32_bf16 v[160:163], v[232:235], v[96:99], v[160:163]
    v_mfma_f32_16x16x32_bf16 v[164:167], v[232:235], v[100:103], v[164:167]
    buffer_load_dwordx4 v[128:131], v4, s[28:31], s52 offen
    ds_read_b64_tr_b16 v[228:229], v9 offset:46080
    ds_read_b64_tr_b16 v[230:231], v9 offset:47360
    s_waitcnt lgkmcnt(4)
    v_mfma_f32_16x16x32_bf16 v[168:171], v[236:239], v[96:99], v[168:171]
    v_mfma_f32_16x16x32_bf16 v[172:175], v[236:239], v[100:103], v[172:175]
    ds_read_b64_tr_b16 v[232:233], v9 offset:46112
    ds_read_b64_tr_b16 v[234:235], v9 offset:47392
    s_waitcnt lgkmcnt(4)
    v_mfma_f32_16x16x32_bf16 v[176:179], v[224:227], v[96:99], v[176:179]
    v_mfma_f32_16x16x32_bf16 v[180:183], v[224:227], v[100:103], v[180:183]
    buffer_load_dwordx4 v[132:135], v5, s[28:31], s52 offen
    ds_read_b64_tr_b16 v[236:237], v9 offset:46144
    ds_read_b64_tr_b16 v[238:239], v9 offset:47424
    s_waitcnt lgkmcnt(4)
    v_mfma_f32_16x16x32_bf16 v[184:187], v[228:231], v[96:99], v[184:187]
    v_mfma_f32_16x16x32_bf16 v[188:191], v[228:231], v[100:103], v[188:191]
    ds_read_b64_tr_b16 v[224:225], v9 offset:46176
    ds_read_b64_tr_b16 v[226:227], v9 offset:47456
    s_waitcnt lgkmcnt(4)
    v_mfma_f32_16x16x32_bf16 v[192:195], v[232:235], v[96:99], v[192:195]
    v_mfma_f32_16x16x32_bf16 v[196:199], v[232:235], v[100:103], v[196:199]
    ds_read_b64_tr_b16 v[228:229], v9 offset:46208
    ds_read_b64_tr_b16 v[230:231], v9 offset:47488
    s_waitcnt lgkmcnt(4)
    v_mfma_f32_16x16x32_bf16 v[200:203], v[236:239], v[96:99], v[200:203]
    v_mfma_f32_16x16x32_bf16 v[204:207], v[236:239], v[100:103], v[204:207]
    ds_read_b64_tr_b16 v[232:233], v9 offset:51200
    ds_read_b64_tr_b16 v[234:235], v9 offset:52480
    s_waitcnt lgkmcnt(4)
    v_mfma_f32_16x16x32_bf16 v[208:211], v[224:227], v[96:99], v[208:211]
    v_mfma_f32_16x16x32_bf16 v[212:215], v[224:227], v[100:103], v[212:215]
    ds_read_b64_tr_b16 v[236:237], v9 offset:51232
    ds_read_b64_tr_b16 v[238:239], v9 offset:52512
    s_waitcnt lgkmcnt(4)
    v_mfma_f32_16x16x32_bf16 v[216:219], v[228:231], v[96:99], v[216:219]
    v_mfma_f32_16x16x32_bf16 v[220:223], v[228:231], v[100:103], v[220:223]
    s_waitcnt vmcnt(12)
    ds_read_b64_tr_b16 v[224:225], v9 offset:51264
    ds_read_b64_tr_b16 v[226:227], v9 offset:52544
    s_waitcnt lgkmcnt(4)
    v_mfma_f32_16x16x32_bf16 v[144:147], v[232:235], v[104:107], v[144:147]
    v_mfma_f32_16x16x32_bf16 v[148:151], v[232:235], v[108:111], v[148:151]
    s_mov_b32 exec_hi, 0xff
    s_add_u32 m0, s20, 153600
    s_nop 0
    buffer_load_dwordx4 v6, s[24:27], s19 offen lds
    s_add_u32 m0, s20, 154240
    s_nop 0
    buffer_load_dwordx4 v7, s[24:27], s19 offen lds
    s_mov_b32 exec_hi, -1
    s_lshl_b32 s52, s54, 10
    s_add_u32 s54, s54, 1
    s_and_b32 s54, s54, 15
    s_mul_i32 s19, s54, s18
    ds_read_b64_tr_b16 v[228:229], v9 offset:51296
    ds_read_b64_tr_b16 v[230:231], v9 offset:52576
    s_waitcnt lgkmcnt(4)
    v_mfma_f32_16x16x32_bf16 v[152:155], v[236:239], v[104:107], v[152:155]
    v_mfma_f32_16x16x32_bf16 v[156:159], v[236:239], v[108:111], v[156:159]
    ds_read_b64_tr_b16 v[232:233], v9 offset:51328
    ds_read_b64_tr_b16 v[234:235], v9 offset:52608
    s_waitcnt lgkmcnt(4)
    v_mfma_f32_16x16x32_bf16 v[160:163], v[224:227], v[104:107], v[160:163]
    v_mfma_f32_16x16x32_bf16 v[164:167], v[224:227], v[108:111], v[164:167]
    buffer_load_dwordx4 v[136:139], v4, s[28:31], s52 offen
    ds_read_b64_tr_b16 v[236:237], v9 offset:56320
    ds_read_b64_tr_b16 v[238:239], v9 offset:57600
    s_waitcnt lgkmcnt(4)
    v_mfma_f32_16x16x32_bf16 v[168:171], v[228:231], v[104:107], v[168:171]
    v_mfma_f32_16x16x32_bf16 v[172:175], v[228:231], v[108:111], v[172:175]
    ds_read_b64_tr_b16 v[224:225], v9 offset:56352
    ds_read_b64_tr_b16 v[226:227], v9 offset:57632
    s_waitcnt lgkmcnt(4)
    v_mfma_f32_16x16x32_bf16 v[176:179], v[232:235], v[104:107], v[176:179]
    v_mfma_f32_16x16x32_bf16 v[180:183], v[232:235], v[108:111], v[180:183]
    buffer_load_dwordx4 v[140:143], v5, s[28:31], s52 offen
    ds_read_b64_tr_b16 v[228:229], v9 offset:56384
    ds_read_b64_tr_b16 v[230:231], v9 offset:57664
    s_waitcnt lgkmcnt(4)
    v_mfma_f32_16x16x32_bf16 v[184:187], v[236:239], v[104:107], v[184:187]
    v_mfma_f32_16x16x32_bf16 v[188:191], v[236:239], v[108:111], v[188:191]
    ds_read_b64_tr_b16 v[232:233], v9 offset:56416
    ds_read_b64_tr_b16 v[234:235], v9 offset:57696
    s_waitcnt lgkmcnt(4)
    v_mfma_f32_16x16x32_bf16 v[192:195], v[224:227], v[104:107], v[192:195]
    v_mfma_f32_16x16x32_bf16 v[196:199], v[224:227], v[108:111], v[196:199]
    ds_read_b64_tr_b16 v[236:237], v9 offset:56448
    ds_read_b64_tr_b16 v[238:239], v9 offset:57728
    s_waitcnt lgkmcnt(4)
    v_mfma_f32_16x16x32_bf16 v[200:203], v[228:231], v[104:107], v[200:203]
    v_mfma_f32_16x16x32_bf16 v[204:207], v[228:231], v[108:111], v[204:207]
    ds_read_b64_tr_b16 v[224:225], v10 offset:0
    ds_read_b64_tr_b16 v[226:227], v10 offset:1280
    s_waitcnt lgkmcnt(4)
    v_mfma_f32_16x16x32_bf16 v[208:211], v[232:235], v[104:107], v[208:211]
    v_mfma_f32_16x16x32_bf16 v[212:215], v[232:235], v[108:111], v[212:215]
    ds_read_b64_tr_b16 v[228:229], v10 offset:32
    ds_read_b64_tr_b16 v[230:231], v10 offset:1312
    s_waitcnt lgkmcnt(4)
    v_mfma_f32_16x16x32_bf16 v[216:219], v[236:239], v[104:107], v[216:219]
    v_mfma_f32_16x16x32_bf16 v[220:223], v[236:239], v[108:111], v[220:223]
    s_waitcnt vmcnt(6)
    s_barrier
    ds_read_b64_tr_b16 v[232:233], v10 offset:64
    ds_read_b64_tr_b16 v[234:235], v10 offset:1344
    s_waitcnt lgkmcnt(4)
    v_mfma_f32_16x16x32_bf16 v[144:147], v[224:227], v[112:115], v[144:147]
    v_mfma_f32_16x16x32_bf16 v[148:151], v[224:227], v[116:119], v[148:151]
    ds_read_b64_tr_b16 v[236:237], v10 offset:96
    ds_read_b64_tr_b16 v[238:239], v10 offset:1376
    s_waitcnt lgkmcnt(4)
    v_mfma_f32_16x16x32_bf16 v[152:155], v[228:231], v[112:115], v[152:155]
    v_mfma_f32_16x16x32_bf16 v[156:159], v[228:231], v[116:119], v[156:159]
    ds_read_b64_tr_b16 v[224:225], v10 offset:128
    ds_read_b64_tr_b16 v[226:227], v10 offset:1408
    s_waitcnt lgkmcnt(4)
    v_mfma_f32_16x16x32_bf16 v[160:163], v[232:235], v[112:115], v[160:163]
    v_mfma_f32_16x16x32_bf16 v[164:167], v[232:235], v[116:119], v[164:167]
    ds_read_b64_tr_b16 v[228:229], v10 offset:5120
    ds_read_b64_tr_b16 v[230:231], v10 offset:6400
    s_waitcnt lgkmcnt(4)
    v_mfma_f32_16x16x32_bf16 v[168:171], v[236:239], v[112:115], v[168:171]
    v_mfma_f32_16x16x32_bf16 v[172:175], v[236:239], v[116:119], v[172:175]
    ds_read_b64_tr_b16 v[232:233], v10 offset:5152
    ds_read_b64_tr_b16 v[234:235], v10 offset:6432
    s_waitcnt lgkmcnt(4)
    v_mfma_f32_16x16x32_bf16 v[176:179], v[224:227], v[112:115], v[176:179]
    v_mfma_f32_16x16x32_bf16 v[180:183], v[224:227], v[116:119], v[180:183]
    ds_read_b64_tr_b16 v[236:237], v10 offset:5184
    ds_read_b64_tr_b16 v[238:239], v10 offset:6464
    s_waitcnt lgkmcnt(4)
    v_mfma_f32_16x16x32_bf16 v[184:187], v[228:231], v[112:115], v[184:187]
    v_mfma_f32_16x16x32_bf16 v[188:191], v[228:231], v[116:119], v[188:191]
    ds_read_b64_tr_b16 v[224:225], v10 offset:5216
    ds_read_b64_tr_b16 v[226:227], v10 offset:6496
    s_waitcnt lgkmcnt(4)
    v_mfma_f32_16x16x32_bf16 v[192:195], v[232:235], v[112:115], v[192:195]
    v_mfma_f32_16x16x32_bf16 v[196:199], v[232:235], v[116:119], v[196:199]
    ds_read_b64_tr_b16 v[228:229], v10 offset:5248
    ds_read_b64_tr_b16 v[230:231], v10 offset:6528
    s_waitcnt lgkmcnt(4)
    v_mfma_f32_16x16x32_bf16 v[200:203], v[236:239], v[112:115], v[200:203]
    v_mfma_f32_16x16x32_bf16 v[204:207], v[236:239], v[116:119], v[204:207]
    ds_read_b64_tr_b16 v[232:233], v10 offset:10240
    ds_read_b64_tr_b16 v[234:235], v10 offset:11520
    s_waitcnt lgkmcnt(4)
    v_mfma_f32_16x16x32_bf16 v[208:211], v[224:227], v[112:115], v[208:211]
    v_mfma_f32_16x16x32_bf16 v[212:215], v[224:227], v[116:119], v[212:215]
    ds_read_b64_tr_b16 v[236:237], v10 offset:10272
    ds_read_b64_tr_b16 v[238:239], v10 offset:11552
    s_waitcnt lgkmcnt(4)
    v_mfma_f32_16x16x32_bf16 v[216:219], v[228:231], v[112:115], v[216:219]
    v_mfma_f32_16x16x32_bf16 v[220:223], v[228:231], v[116:119], v[220:223]
    s_waitcnt vmcnt(8)
    ds_read_b64_tr_b16 v[224:225], v10 offset:10304
    ds_read_b64_tr_b16 v[226:227], v10 offset:11584
    s_waitcnt lgkmcnt(4)
    v_mfma_f32_16x16x32_bf16 v[144:147], v[232:235], v[120:123], v[144:147]
    v_mfma_f32_16x16x32_bf16 v[148:151], v[232:235], v[124:127], v[148:151]
    ds_read_b64_tr_b16 v[228:229], v10 offset:10336
    ds_read_b64_tr_b16 v[230:231], v10 offset:11616
    s_waitcnt lgkmcnt(4)
    v_mfma_f32_16x16x32_bf16 v[152:155], v[236:239], v[120:123], v[152:155]
    v_mfma_f32_16x16x32_bf16 v[156:159], v[236:239], v[124:127], v[156:159]
    ds_read_b64_tr_b16 v[232:233], v10 offset:10368
    ds_read_b64_tr_b16 v[234:235], v10 offset:11648
    s_waitcnt lgkmcnt(4)
    v_mfma_f32_16x16x32_bf16 v[160:163], v[224:227], v[120:123], v[160:163]
    v_mfma_f32_16x16x32_bf16 v[164:167], v[224:227], v[124:127], v[164:167]
    ds_read_b64_tr_b16 v[236:237], v10 offset:15360
    ds_read_b64_tr_b16 v[238:239], v10 offset:16640
    s_waitcnt lgkmcnt(4)
    v_mfma_f32_16x16x32_bf16 v[168:171], v[228:231], v[120:123], v[168:171]
    v_mfma_f32_16x16x32_bf16 v[172:175], v[228:231], v[124:127], v[172:175]
    ds_read_b64_tr_b16 v[224:225], v10 offset:15392
    ds_read_b64_tr_b16 v[226:227], v10 offset:16672
    s_waitcnt lgkmcnt(4)
    v_mfma_f32_16x16x32_bf16 v[176:179], v[232:235], v[120:123], v[176:179]
    v_mfma_f32_16x16x32_bf16 v[180:183], v[232:235], v[124:127], v[180:183]
    ds_read_b64_tr_b16 v[228:229], v10 offset:15424
    ds_read_b64_tr_b16 v[230:231], v10 offset:16704
    s_waitcnt lgkmcnt(4)
    v_mfma_f32_16x16x32_bf16 v[184:187], v[236:239], v[120:123], v[184:187]
    v_mfma_f32_16x16x32_bf16 v[188:191], v[236:239], v[124:127], v[188:191]
    ds_read_b64_tr_b16 v[232:233], v10 offset:15456
    ds_read_b64_tr_b16 v[234:235], v10 offset:16736
    s_waitcnt lgkmcnt(4)
    v_mfma_f32_16x16x32_bf16 v[192:195], v[224:227], v[120:123], v[192:195]
    v_mfma_f32_16x16x32_bf16 v[196:199], v[224:227], v[124:127], v[196:199]
    ds_read_b64_tr_b16 v[236:237], v10 offset:15488
    ds_read_b64_tr_b16 v[238:239], v10 offset:16768
    s_waitcnt lgkmcnt(4)
    v_mfma_f32_16x16x32_bf16 v[200:203], v[228:231], v[120:123], v[200:203]
    v_mfma_f32_16x16x32_bf16 v[204:207], v[228:231], v[124:127], v[204:207]
    ds_read_b64_tr_b16 v[224:225], v10 offset:20480
    ds_read_b64_tr_b16 v[226:227], v10 offset:21760
    s_waitcnt lgkmcnt(4)
    v_mfma_f32_16x16x32_bf16 v[208:211], v[232:235], v[120:123], v[208:211]
    v_mfma_f32_16x16x32_bf16 v[212:215], v[232:235], v[124:127], v[212:215]
    ds_read_b64_tr_b16 v[228:229], v10 offset:20512
    ds_read_b64_tr_b16 v[230:231], v10 offset:21792
    s_waitcnt lgkmcnt(4)
    v_mfma_f32_16x16x32_bf16 v[216:219], v[236:239], v[120:123], v[216:219]
    v_mfma_f32_16x16x32_bf16 v[220:223], v[236:239], v[124:127], v[220:223]
    s_waitcnt vmcnt(2)
    s_barrier
    ds_read_b64_tr_b16 v[232:233], v10 offset:20544
    ds_read_b64_tr_b16 v[234:235], v10 offset:21824
    s_waitcnt lgkmcnt(4)
    v_mfma_f32_16x16x32_bf16 v[144:147], v[224:227], v[128:131], v[144:147]
    v_mfma_f32_16x16x32_bf16 v[148:151], v[224:227], v[132:135], v[148:151]
    ds_read_b64_tr_b16 v[236:237], v10 offset:20576
    ds_read_b64_tr_b16 v[238:239], v10 offset:21856
    s_waitcnt lgkmcnt(4)
    v_mfma_f32_16x16x32_bf16 v[152:155], v[228:231], v[128:131], v[152:155]
    v_mfma_f32_16x16x32_bf16 v[156:159], v[228:231], v[132:135], v[156:159]
    ds_read_b64_tr_b16 v[224:225], v10 offset:20608
    ds_read_b64_tr_b16 v[226:227], v10 offset:21888
    s_waitcnt lgkmcnt(4)
    v_mfma_f32_16x16x32_bf16 v[160:163], v[232:235], v[128:131], v[160:163]
    v_mfma_f32_16x16x32_bf16 v[164:167], v[232:235], v[132:135], v[164:167]
    ds_read_b64_tr_b16 v[228:229], v10 offset:25600
    ds_read_b64_tr_b16 v[230:231], v10 offset:26880
    s_waitcnt lgkmcnt(4)
    v_mfma_f32_16x16x32_bf16 v[168:171], v[236:239], v[128:131], v[168:171]
    v_mfma_f32_16x16x32_bf16 v[172:175], v[236:239], v[132:135], v[172:175]
    ds_read_b64_tr_b16 v[232:233], v10 offset:25632
    ds_read_b64_tr_b16 v[234:235], v10 offset:26912
    s_waitcnt lgkmcnt(4)
    v_mfma_f32_16x16x32_bf16 v[176:179], v[224:227], v[128:131], v[176:179]
    v_mfma_f32_16x16x32_bf16 v[180:183], v[224:227], v[132:135], v[180:183]
    ds_read_b64_tr_b16 v[236:237], v10 offset:25664
    ds_read_b64_tr_b16 v[238:239], v10 offset:26944
    s_waitcnt lgkmcnt(4)
    v_mfma_f32_16x16x32_bf16 v[184:187], v[228:231], v[128:131], v[184:187]
    v_mfma_f32_16x16x32_bf16 v[188:191], v[228:231], v[132:135], v[188:191]
    ds_read_b64_tr_b16 v[224:225], v10 offset:25696
    ds_read_b64_tr_b16 v[226:227], v10 offset:26976
    s_waitcnt lgkmcnt(4)
    v_mfma_f32_16x16x32_bf16 v[192:195], v[232:235], v[128:131], v[192:195]
    v_mfma_f32_16x16x32_bf16 v[196:199], v[232:235], v[132:135], v[196:199]
    ds_read_b64_tr_b16 v[228:229], v10 offset:25728
    ds_read_b64_tr_b16 v[230:231], v10 offset:27008
    s_waitcnt lgkmcnt(4)
    v_mfma_f32_16x16x32_bf16 v[200:203], v[236:239], v[128:131], v[200:203]
    v_mfma_f32_16x16x32_bf16 v[204:207], v[236:239], v[132:135], v[204:207]
    ds_read_b64_tr_b16 v[232:233], v10 offset:30720
    ds_read_b64_tr_b16 v[234:235], v10 offset:32000
    s_waitcnt lgkmcnt(4)
    v_mfma_f32_16x16x32_bf16 v[208:211], v[224:227], v[128:131], v[208:211]
    v_mfma_f32_16x16x32_bf16 v[212:215], v[224:227], v[132:135], v[212:215]
    ds_read_b64_tr_b16 v[236:237], v10 offset:30752
    ds_read_b64_tr_b16 v[238:239], v10 offset:32032
    s_waitcnt lgkmcnt(4)
    v_mfma_f32_16x16x32_bf16 v[216:219], v[228:231], v[128:131], v[216:219]
    v_mfma_f32_16x16x32_bf16 v[220:223], v[228:231], v[132:135], v[220:223]
    s_waitcnt vmcnt(0)
    ds_read_b64_tr_b16 v[224:225], v10 offset:30784
    ds_read_b64_tr_b16 v[226:227], v10 offset:32064
    s_waitcnt lgkmcnt(4)
    v_mfma_f32_16x16x32_bf16 v[144:147], v[232:235], v[136:139], v[144:147]
    v_mfma_f32_16x16x32_bf16 v[148:151], v[232:235], v[140:143], v[148:151]
    ds_read_b64_tr_b16 v[228:229], v10 offset:30816
    ds_read_b64_tr_b16 v[230:231], v10 offset:32096
    s_waitcnt lgkmcnt(4)
    v_mfma_f32_16x16x32_bf16 v[152:155], v[236:239], v[136:139], v[152:155]
    v_mfma_f32_16x16x32_bf16 v[156:159], v[236:239], v[140:143], v[156:159]
    ds_read_b64_tr_b16 v[232:233], v10 offset:30848
    ds_read_b64_tr_b16 v[234:235], v10 offset:32128
    s_waitcnt lgkmcnt(4)
    v_mfma_f32_16x16x32_bf16 v[160:163], v[224:227], v[136:139], v[160:163]
    v_mfma_f32_16x16x32_bf16 v[164:167], v[224:227], v[140:143], v[164:167]
    ds_read_b64_tr_b16 v[236:237], v10 offset:35840
    ds_read_b64_tr_b16 v[238:239], v10 offset:37120
    s_waitcnt lgkmcnt(4)
    v_mfma_f32_16x16x32_bf16 v[168:171], v[228:231], v[136:139], v[168:171]
    v_mfma_f32_16x16x32_bf16 v[172:175], v[228:231], v[140:143], v[172:175]
    ds_read_b64_tr_b16 v[224:225], v10 offset:35872
    ds_read_b64_tr_b16 v[226:227], v10 offset:37152
    s_waitcnt lgkmcnt(4)
    v_mfma_f32_16x16x32_bf16 v[176:179], v[232:235], v[136:139], v[176:179]
    v_mfma_f32_16x16x32_bf16 v[180:183], v[232:235], v[140:143], v[180:183]
    ds_read_b64_tr_b16 v[228:229], v10 offset:35904
    ds_read_b64_tr_b16 v[230:231], v10 offset:37184
    s_waitcnt lgkmcnt(4)
    v_mfma_f32_16x16x32_bf16 v[184:187], v[236:239], v[136:139], v[184:187]
    v_mfma_f32_16x16x32_bf16 v[188:191], v[236:239], v[140:143], v[188:191]
    ds_read_b64_tr_b16 v[232:233], v10 offset:35936
    ds_read_b64_tr_b16 v[234:235], v10 offset:37216
    s_waitcnt lgkmcnt(4)
    v_mfma_f32_16x16x32_bf16 v[192:195], v[224:227], v[136:139], v[192:195]
    v_mfma_f32_16x16x32_bf16 v[196:199], v[224:227], v[140:143], v[196:199]
    ds_read_b64_tr_b16 v[236:237], v10 offset:35968
    ds_read_b64_tr_b16 v[238:239], v10 offset:37248
    s_waitcnt lgkmcnt(4)
    v_mfma_f32_16x16x32_bf16 v[200:203], v[228:231], v[136:139], v[200:203]
    v_mfma_f32_16x16x32_bf16 v[204:207], v[228:231], v[140:143], v[204:207]
    s_waitcnt lgkmcnt(2)
    v_mfma_f32_16x16x32_bf16 v[208:211], v[232:235], v[136:139], v[208:211]
    v_mfma_f32_16x16x32_bf16 v[212:215], v[232:235], v[140:143], v[212:215]
    s_waitcnt lgkmcnt(0)
    v_mfma_f32_16x16x32_bf16 v[216:219], v[236:239], v[136:139], v[216:219]
    v_mfma_f32_16x16x32_bf16 v[220:223], v[236:239], v[140:143], v[220:223]
    s_waitcnt vmcnt(0)
    s_add_u32 s32, s12, 0x600000
    s_addc_u32 s33, s13, 0
    s_mov_b32 s34, 0x560000
    s_mov_b32 s35, 0x00020000
    v_lshrrev_b32 v12, 1, v3
    v_lshl_add_u32 v12, v12, 4, v2
    v_lshlrev_b32 v12, 4, v12
    v_and_b32 v13, 1, v3
    v_mul_u32_u24 v13, 44032, v13
    v_add_u32 v12, v13, v12
    s_mul_i32 s3, s46, 2752
    s_lshl_b32 s49, s50, 9
    s_add_u32 s3, s3, s49
    v_add_u32 v12, s3, v12
    v_cvt_pk_bf16_f32 v48, v144, v145
    v_cvt_pk_bf16_f32 v49, v146, v147
    v_cvt_pk_bf16_f32 v50, v184, v185
    v_cvt_pk_bf16_f32 v51, v186, v187
    v_lshlrev_b32 v52, 16, v48
    v_and_b32 v53, 0xffff0000, v48
    v_lshlrev_b32 v54, 16, v49
    v_and_b32 v55, 0xffff0000, v49
    v_lshlrev_b32 v56, 16, v50
    v_and_b32 v57, 0xffff0000, v50
    v_lshlrev_b32 v58, 16, v51
    v_and_b32 v59, 0xffff0000, v51
    v_mul_f32 v60, 0xbfb8aa3b, v52
    v_mul_f32 v61, 0xbfb8aa3b, v53
    v_mul_f32 v62, 0xbfb8aa3b, v54
    v_mul_f32 v63, 0xbfb8aa3b, v55
    v_exp_f32 v60, v60
    v_exp_f32 v61, v61
    v_exp_f32 v62, v62
    v_exp_f32 v63, v63
    v_add_f32 v60, 1.0, v60
    v_add_f32 v61, 1.0, v61
    v_add_f32 v62, 1.0, v62
    v_add_f32 v63, 1.0, v63
    v_rcp_f32 v60, v60
    v_rcp_f32 v61, v61
    v_rcp_f32 v62, v62
    v_rcp_f32 v63, v63
    v_mul_f32 v60, v60, v52
    v_mul_f32 v61, v61, v53
    v_mul_f32 v62, v62, v54
    v_mul_f32 v63, v63, v55
    v_cvt_pk_bf16_f32 v48, v60, v61
    v_cvt_pk_bf16_f32 v49, v62, v63
    v_lshlrev_b32 v52, 16, v48
    v_and_b32 v53, 0xffff0000, v48
    v_lshlrev_b32 v54, 16, v49
    v_and_b32 v55, 0xffff0000, v49
    v_mul_f32 v52, v52, v56
    v_mul_f32 v53, v53, v57
    v_mul_f32 v54, v54, v58
    v_mul_f32 v55, v55, v59
    v_cvt_pk_bf16_f32 v64, v52, v53
    v_cvt_pk_bf16_f32 v65, v54, v55
    v_cvt_pk_bf16_f32 v48, v148, v149
    v_cvt_pk_bf16_f32 v49, v150, v151
    v_cvt_pk_bf16_f32 v50, v188, v189
    v_cvt_pk_bf16_f32 v51, v190, v191
    v_lshlrev_b32 v52, 16, v48
    v_and_b32 v53, 0xffff0000, v48
    v_lshlrev_b32 v54, 16, v49
    v_and_b32 v55, 0xffff0000, v49
    v_lshlrev_b32 v56, 16, v50
    v_and_b32 v57, 0xffff0000, v50
    v_lshlrev_b32 v58, 16, v51
    v_and_b32 v59, 0xffff0000, v51
    v_mul_f32 v60, 0xbfb8aa3b, v52
    v_mul_f32 v61, 0xbfb8aa3b, v53
    v_mul_f32 v62, 0xbfb8aa3b, v54
    v_mul_f32 v63, 0xbfb8aa3b, v55
    v_exp_f32 v60, v60
    v_exp_f32 v61, v61
    v_exp_f32 v62, v62
    v_exp_f32 v63, v63
    v_add_f32 v60, 1.0, v60
    v_add_f32 v61, 1.0, v61
    v_add_f32 v62, 1.0, v62
    v_add_f32 v63, 1.0, v63
    v_rcp_f32 v60, v60
    v_rcp_f32 v61, v61
    v_rcp_f32 v62, v62
    v_rcp_f32 v63, v63
    v_mul_f32 v60, v60, v52
    v_mul_f32 v61, v61, v53
    v_mul_f32 v62, v62, v54
    v_mul_f32 v63, v63, v55
    v_cvt_pk_bf16_f32 v48, v60, v61
    v_cvt_pk_bf16_f32 v49, v62, v63
    v_lshlrev_b32 v52, 16, v48
    v_and_b32 v53, 0xffff0000, v48
    v_lshlrev_b32 v54, 16, v49
    v_and_b32 v55, 0xffff0000, v49
    v_mul_f32 v52, v52, v56
    v_mul_f32 v53, v53, v57
    v_mul_f32 v54, v54, v58
    v_mul_f32 v55, v55, v59
    v_cvt_pk_bf16_f32 v66, v52, v53
    v_cvt_pk_bf16_f32 v67, v54, v55
    s_nop 0
    v_permlane16_swap_b32 v64, v66
    v_permlane16_swap_b32 v65, v67
    buffer_store_dwordx4 v[64:67], v12, s[32:35], 0 offen offset:0 sc1
    v_cvt_pk_bf16_f32 v48, v152, v153
    v_cvt_pk_bf16_f32 v49, v154, v155
    v_cvt_pk_bf16_f32 v50, v192, v193
    v_cvt_pk_bf16_f32 v51, v194, v195
    v_lshlrev_b32 v52, 16, v48
    v_and_b32 v53, 0xffff0000, v48
    v_lshlrev_b32 v54, 16, v49
    v_and_b32 v55, 0xffff0000, v49
    v_lshlrev_b32 v56, 16, v50
    v_and_b32 v57, 0xffff0000, v50
    v_lshlrev_b32 v58, 16, v51
    v_and_b32 v59, 0xffff0000, v51
    v_mul_f32 v60, 0xbfb8aa3b, v52
    v_mul_f32 v61, 0xbfb8aa3b, v53
    v_mul_f32 v62, 0xbfb8aa3b, v54
    v_mul_f32 v63, 0xbfb8aa3b, v55
    v_exp_f32 v60, v60
    v_exp_f32 v61, v61
    v_exp_f32 v62, v62
    v_exp_f32 v63, v63
    v_add_f32 v60, 1.0, v60
    v_add_f32 v61, 1.0, v61
    v_add_f32 v62, 1.0, v62
    v_add_f32 v63, 1.0, v63
    v_rcp_f32 v60, v60
    v_rcp_f32 v61, v61
    v_rcp_f32 v62, v62
    v_rcp_f32 v63, v63
    v_mul_f32 v60, v60, v52
    v_mul_f32 v61, v61, v53
    v_mul_f32 v62, v62, v54
    v_mul_f32 v63, v63, v55
    v_cvt_pk_bf16_f32 v48, v60, v61
    v_cvt_pk_bf16_f32 v49, v62, v63
    v_lshlrev_b32 v52, 16, v48
    v_and_b32 v53, 0xffff0000, v48
    v_lshlrev_b32 v54, 16, v49
    v_and_b32 v55, 0xffff0000, v49
    v_mul_f32 v52, v52, v56
    v_mul_f32 v53, v53, v57
    v_mul_f32 v54, v54, v58
    v_mul_f32 v55, v55, v59
    v_cvt_pk_bf16_f32 v68, v52, v53
    v_cvt_pk_bf16_f32 v69, v54, v55
    v_cvt_pk_bf16_f32 v48, v156, v157
    v_cvt_pk_bf16_f32 v49, v158, v159
    v_cvt_pk_bf16_f32 v50, v196, v197
    v_cvt_pk_bf16_f32 v51, v198, v199
    v_lshlrev_b32 v52, 16, v48
    v_and_b32 v53, 0xffff0000, v48
    v_lshlrev_b32 v54, 16, v49
    v_and_b32 v55, 0xffff0000, v49
    v_lshlrev_b32 v56, 16, v50
    v_and_b32 v57, 0xffff0000, v50
    v_lshlrev_b32 v58, 16, v51
    v_and_b32 v59, 0xffff0000, v51
    v_mul_f32 v60, 0xbfb8aa3b, v52
    v_mul_f32 v61, 0xbfb8aa3b, v53
    v_mul_f32 v62, 0xbfb8aa3b, v54
    v_mul_f32 v63, 0xbfb8aa3b, v55
    v_exp_f32 v60, v60
    v_exp_f32 v61, v61
    v_exp_f32 v62, v62
    v_exp_f32 v63, v63
    v_add_f32 v60, 1.0, v60
    v_add_f32 v61, 1.0, v61
    v_add_f32 v62, 1.0, v62
    v_add_f32 v63, 1.0, v63
    v_rcp_f32 v60, v60
    v_rcp_f32 v61, v61
    v_rcp_f32 v62, v62
    v_rcp_f32 v63, v63
    v_mul_f32 v60, v60, v52
    v_mul_f32 v61, v61, v53
    v_mul_f32 v62, v62, v54
    v_mul_f32 v63, v63, v55
    v_cvt_pk_bf16_f32 v48, v60, v61
    v_cvt_pk_bf16_f32 v49, v62, v63
    v_lshlrev_b32 v52, 16, v48
    v_and_b32 v53, 0xffff0000, v48
    v_lshlrev_b32 v54, 16, v49
    v_and_b32 v55, 0xffff0000, v49
    v_mul_f32 v52, v52, v56
    v_mul_f32 v53, v53, v57
    v_mul_f32 v54, v54, v58
    v_mul_f32 v55, v55, v59
    v_cvt_pk_bf16_f32 v70, v52, v53
    v_cvt_pk_bf16_f32 v71, v54, v55
    s_nop 0
    v_permlane16_swap_b32 v68, v70
    v_permlane16_swap_b32 v69, v71
    buffer_store_dwordx4 v[68:71], v12, s[32:35], 0 offen offset:512 sc1
    v_cvt_pk_bf16_f32 v48, v160, v161
    v_cvt_pk_bf16_f32 v49, v162, v163
    v_cvt_pk_bf16_f32 v50, v200, v201
    v_cvt_pk_bf16_f32 v51, v202, v203
    v_lshlrev_b32 v52, 16, v48
    v_and_b32 v53, 0xffff0000, v48
    v_lshlrev_b32 v54, 16, v49
    v_and_b32 v55, 0xffff0000, v49
    v_lshlrev_b32 v56, 16, v50
    v_and_b32 v57, 0xffff0000, v50
    v_lshlrev_b32 v58, 16, v51
    v_and_b32 v59, 0xffff0000, v51
    v_mul_f32 v60, 0xbfb8aa3b, v52
    v_mul_f32 v61, 0xbfb8aa3b, v53
    v_mul_f32 v62, 0xbfb8aa3b, v54
    v_mul_f32 v63, 0xbfb8aa3b, v55
    v_exp_f32 v60, v60
    v_exp_f32 v61, v61
    v_exp_f32 v62, v62
    v_exp_f32 v63, v63
    v_add_f32 v60, 1.0, v60
    v_add_f32 v61, 1.0, v61
    v_add_f32 v62, 1.0, v62
    v_add_f32 v63, 1.0, v63
    v_rcp_f32 v60, v60
    v_rcp_f32 v61, v61
    v_rcp_f32 v62, v62
    v_rcp_f32 v63, v63
    v_mul_f32 v60, v60, v52
    v_mul_f32 v61, v61, v53
    v_mul_f32 v62, v62, v54
    v_mul_f32 v63, v63, v55
    v_cvt_pk_bf16_f32 v48, v60, v61
    v_cvt_pk_bf16_f32 v49, v62, v63
    v_lshlrev_b32 v52, 16, v48
    v_and_b32 v53, 0xffff0000, v48
    v_lshlrev_b32 v54, 16, v49
    v_and_b32 v55, 0xffff0000, v49
    v_mul_f32 v52, v52, v56
    v_mul_f32 v53, v53, v57
    v_mul_f32 v54, v54, v58
    v_mul_f32 v55, v55, v59
    v_cvt_pk_bf16_f32 v64, v52, v53
    v_cvt_pk_bf16_f32 v65, v54, v55
    v_cvt_pk_bf16_f32 v48, v164, v165
    v_cvt_pk_bf16_f32 v49, v166, v167
    v_cvt_pk_bf16_f32 v50, v204, v205
    v_cvt_pk_bf16_f32 v51, v206, v207
    v_lshlrev_b32 v52, 16, v48
    v_and_b32 v53, 0xffff0000, v48
    v_lshlrev_b32 v54, 16, v49
    v_and_b32 v55, 0xffff0000, v49
    v_lshlrev_b32 v56, 16, v50
    v_and_b32 v57, 0xffff0000, v50
    v_lshlrev_b32 v58, 16, v51
    v_and_b32 v59, 0xffff0000, v51
    v_mul_f32 v60, 0xbfb8aa3b, v52
    v_mul_f32 v61, 0xbfb8aa3b, v53
    v_mul_f32 v62, 0xbfb8aa3b, v54
    v_mul_f32 v63, 0xbfb8aa3b, v55
    v_exp_f32 v60, v60
    v_exp_f32 v61, v61
    v_exp_f32 v62, v62
    v_exp_f32 v63, v63
    v_add_f32 v60, 1.0, v60
    v_add_f32 v61, 1.0, v61
    v_add_f32 v62, 1.0, v62
    v_add_f32 v63, 1.0, v63
    v_rcp_f32 v60, v60
    v_rcp_f32 v61, v61
    v_rcp_f32 v62, v62
    v_rcp_f32 v63, v63
    v_mul_f32 v60, v60, v52
    v_mul_f32 v61, v61, v53
    v_mul_f32 v62, v62, v54
    v_mul_f32 v63, v63, v55
    v_cvt_pk_bf16_f32 v48, v60, v61
    v_cvt_pk_bf16_f32 v49, v62, v63
    v_lshlrev_b32 v52, 16, v48
    v_and_b32 v53, 0xffff0000, v48
    v_lshlrev_b32 v54, 16, v49
    v_and_b32 v55, 0xffff0000, v49
    v_mul_f32 v52, v52, v56
    v_mul_f32 v53, v53, v57
    v_mul_f32 v54, v54, v58
    v_mul_f32 v55, v55, v59
    v_cvt_pk_bf16_f32 v66, v52, v53
    v_cvt_pk_bf16_f32 v67, v54, v55
    s_nop 0
    v_permlane16_swap_b32 v64, v66
    v_permlane16_swap_b32 v65, v67
    buffer_store_dwordx4 v[64:67], v12, s[32:35], 0 offen offset:1024 sc1
    v_cvt_pk_bf16_f32 v48, v168, v169
    v_cvt_pk_bf16_f32 v49, v170, v171
    v_cvt_pk_bf16_f32 v50, v208, v209
    v_cvt_pk_bf16_f32 v51, v210, v211
    v_lshlrev_b32 v52, 16, v48
    v_and_b32 v53, 0xffff0000, v48
    v_lshlrev_b32 v54, 16, v49
    v_and_b32 v55, 0xffff0000, v49
    v_lshlrev_b32 v56, 16, v50
    v_and_b32 v57, 0xffff0000, v50
    v_lshlrev_b32 v58, 16, v51
    v_and_b32 v59, 0xffff0000, v51
    v_mul_f32 v60, 0xbfb8aa3b, v52
    v_mul_f32 v61, 0xbfb8aa3b, v53
    v_mul_f32 v62, 0xbfb8aa3b, v54
    v_mul_f32 v63, 0xbfb8aa3b, v55
    v_exp_f32 v60, v60
    v_exp_f32 v61, v61
    v_exp_f32 v62, v62
    v_exp_f32 v63, v63
    v_add_f32 v60, 1.0, v60
    v_add_f32 v61, 1.0, v61
    v_add_f32 v62, 1.0, v62
    v_add_f32 v63, 1.0, v63
    v_rcp_f32 v60, v60
    v_rcp_f32 v61, v61
    v_rcp_f32 v62, v62
    v_rcp_f32 v63, v63
    v_mul_f32 v60, v60, v52
    v_mul_f32 v61, v61, v53
    v_mul_f32 v62, v62, v54
    v_mul_f32 v63, v63, v55
    v_cvt_pk_bf16_f32 v48, v60, v61
    v_cvt_pk_bf16_f32 v49, v62, v63
    v_lshlrev_b32 v52, 16, v48
    v_and_b32 v53, 0xffff0000, v48
    v_lshlrev_b32 v54, 16, v49
    v_and_b32 v55, 0xffff0000, v49
    v_mul_f32 v52, v52, v56
    v_mul_f32 v53, v53, v57
    v_mul_f32 v54, v54, v58
    v_mul_f32 v55, v55, v59
    v_cvt_pk_bf16_f32 v68, v52, v53
    v_cvt_pk_bf16_f32 v69, v54, v55
    v_cvt_pk_bf16_f32 v48, v172, v173
    v_cvt_pk_bf16_f32 v49, v174, v175
    v_cvt_pk_bf16_f32 v50, v212, v213
    v_cvt_pk_bf16_f32 v51, v214, v215
    v_lshlrev_b32 v52, 16, v48
    v_and_b32 v53, 0xffff0000, v48
    v_lshlrev_b32 v54, 16, v49
    v_and_b32 v55, 0xffff0000, v49
    v_lshlrev_b32 v56, 16, v50
    v_and_b32 v57, 0xffff0000, v50
    v_lshlrev_b32 v58, 16, v51
    v_and_b32 v59, 0xffff0000, v51
    v_mul_f32 v60, 0xbfb8aa3b, v52
    v_mul_f32 v61, 0xbfb8aa3b, v53
    v_mul_f32 v62, 0xbfb8aa3b, v54
    v_mul_f32 v63, 0xbfb8aa3b, v55
    v_exp_f32 v60, v60
    v_exp_f32 v61, v61
    v_exp_f32 v62, v62
    v_exp_f32 v63, v63
    v_add_f32 v60, 1.0, v60
    v_add_f32 v61, 1.0, v61
    v_add_f32 v62, 1.0, v62
    v_add_f32 v63, 1.0, v63
    v_rcp_f32 v60, v60
    v_rcp_f32 v61, v61
    v_rcp_f32 v62, v62
    v_rcp_f32 v63, v63
    v_mul_f32 v60, v60, v52
    v_mul_f32 v61, v61, v53
    v_mul_f32 v62, v62, v54
    v_mul_f32 v63, v63, v55
    v_cvt_pk_bf16_f32 v48, v60, v61
    v_cvt_pk_bf16_f32 v49, v62, v63
    v_lshlrev_b32 v52, 16, v48
    v_and_b32 v53, 0xffff0000, v48
    v_lshlrev_b32 v54, 16, v49
    v_and_b32 v55, 0xffff0000, v49
    v_mul_f32 v52, v52, v56
    v_mul_f32 v53, v53, v57
    v_mul_f32 v54, v54, v58
    v_mul_f32 v55, v55, v59
    v_cvt_pk_bf16_f32 v70, v52, v53
    v_cvt_pk_bf16_f32 v71, v54, v55
    s_nop 0
    v_permlane16_swap_b32 v68, v70
    v_permlane16_swap_b32 v69, v71
    buffer_store_dwordx4 v[68:71], v12, s[32:35], 0 offen offset:1536 sc1
    v_cvt_pk_bf16_f32 v48, v176, v177
    v_cvt_pk_bf16_f32 v49, v178, v179
    v_cvt_pk_bf16_f32 v50, v216, v217
    v_cvt_pk_bf16_f32 v51, v218, v219
    v_lshlrev_b32 v52, 16, v48
    v_and_b32 v53, 0xffff0000, v48
    v_lshlrev_b32 v54, 16, v49
    v_and_b32 v55, 0xffff0000, v49
    v_lshlrev_b32 v56, 16, v50
    v_and_b32 v57, 0xffff0000, v50
    v_lshlrev_b32 v58, 16, v51
    v_and_b32 v59, 0xffff0000, v51
    v_mul_f32 v60, 0xbfb8aa3b, v52
    v_mul_f32 v61, 0xbfb8aa3b, v53
    v_mul_f32 v62, 0xbfb8aa3b, v54
    v_mul_f32 v63, 0xbfb8aa3b, v55
    v_exp_f32 v60, v60
    v_exp_f32 v61, v61
    v_exp_f32 v62, v62
    v_exp_f32 v63, v63
    v_add_f32 v60, 1.0, v60
    v_add_f32 v61, 1.0, v61
    v_add_f32 v62, 1.0, v62
    v_add_f32 v63, 1.0, v63
    v_rcp_f32 v60, v60
    v_rcp_f32 v61, v61
    v_rcp_f32 v62, v62
    v_rcp_f32 v63, v63
    v_mul_f32 v60, v60, v52
    v_mul_f32 v61, v61, v53
    v_mul_f32 v62, v62, v54
    v_mul_f32 v63, v63, v55
    v_cvt_pk_bf16_f32 v48, v60, v61
    v_cvt_pk_bf16_f32 v49, v62, v63
    v_lshlrev_b32 v52, 16, v48
    v_and_b32 v53, 0xffff0000, v48
    v_lshlrev_b32 v54, 16, v49
    v_and_b32 v55, 0xffff0000, v49
    v_mul_f32 v52, v52, v56
    v_mul_f32 v53, v53, v57
    v_mul_f32 v54, v54, v58
    v_mul_f32 v55, v55, v59
    v_cvt_pk_bf16_f32 v64, v52, v53
    v_cvt_pk_bf16_f32 v65, v54, v55
    v_cvt_pk_bf16_f32 v48, v180, v181
    v_cvt_pk_bf16_f32 v49, v182, v183
    v_cvt_pk_bf16_f32 v50, v220, v221
    v_cvt_pk_bf16_f32 v51, v222, v223
    v_lshlrev_b32 v52, 16, v48
    v_and_b32 v53, 0xffff0000, v48
    v_lshlrev_b32 v54, 16, v49
    v_and_b32 v55, 0xffff0000, v49
    v_lshlrev_b32 v56, 16, v50
    v_and_b32 v57, 0xffff0000, v50
    v_lshlrev_b32 v58, 16, v51
    v_and_b32 v59, 0xffff0000, v51
    v_mul_f32 v60, 0xbfb8aa3b, v52
    v_mul_f32 v61, 0xbfb8aa3b, v53
    v_mul_f32 v62, 0xbfb8aa3b, v54
    v_mul_f32 v63, 0xbfb8aa3b, v55
    v_exp_f32 v60, v60
    v_exp_f32 v61, v61
    v_exp_f32 v62, v62
    v_exp_f32 v63, v63
    v_add_f32 v60, 1.0, v60
    v_add_f32 v61, 1.0, v61
    v_add_f32 v62, 1.0, v62
    v_add_f32 v63, 1.0, v63
    v_rcp_f32 v60, v60
    v_rcp_f32 v61, v61
    v_rcp_f32 v62, v62
    v_rcp_f32 v63, v63
    v_mul_f32 v60, v60, v52
    v_mul_f32 v61, v61, v53
    v_mul_f32 v62, v62, v54
    v_mul_f32 v63, v63, v55
    v_cvt_pk_bf16_f32 v48, v60, v61
    v_cvt_pk_bf16_f32 v49, v62, v63
    v_lshlrev_b32 v52, 16, v48
    v_and_b32 v53, 0xffff0000, v48
    v_lshlrev_b32 v54, 16, v49
    v_and_b32 v55, 0xffff0000, v49
    v_mul_f32 v52, v52, v56
    v_mul_f32 v53, v53, v57
    v_mul_f32 v54, v54, v58
    v_mul_f32 v55, v55, v59
    v_cvt_pk_bf16_f32 v66, v52, v53
    v_cvt_pk_bf16_f32 v67, v54, v55
    s_nop 0
    v_permlane16_swap_b32 v64, v66
    v_permlane16_swap_b32 v65, v67
    buffer_store_dwordx4 v[64:67], v12, s[32:35], 0 offen offset:2048 sc1
K1_done:
    s_endpgm
.text
.globl k2_kernel
.p2align 8
.type k2_kernel,@function
k2_kernel:
    s_cmp_ge_u32 s2, 256
    s_cbranch_scc1 K2_done
    s_load_dwordx2 s[4:5], s[0:1], 0
    s_load_dwordx2 s[6:7], s[0:1], 24
    s_load_dwordx4 s[8:11], s[0:1], 56
    s_load_dwordx2 s[12:13], s[0:1], 80
    v_lshrrev_b32 v12, 6, v0
    v_and_b32 v1, 63, v0
    v_readfirstlane_b32 s16, v12
    v_and_b32 v2, 15, v1
    v_lshrrev_b32 v3, 4, v1
    s_and_b32 s14, s2, 7
    s_lshl_b32 s14, s14, 2
    s_lshr_b32 s15, s2, 3
    s_and_b32 s3, s15, 3
    s_add_u32 s14, s14, s3
    s_lshr_b32 s15, s15, 2
    s_lshl_b32 s14, s14, 6
    s_lshl_b32 s15, s15, 7
    s_and_b32 s17, s16, 3
    s_mul_i32 s20, s16, 17408
    v_lshrrev_b32 v13, 3, v1
    v_and_b32 v14, 7, v1
    v_bfe_u32 v15, v13, 1, 2
    v_lshrrev_b32 v6, 1, v14
    v_xor_b32 v6, v6, v15
    v_and_b32 v14, 1, v14
    v_lshl_or_b32 v6, v6, 1, v14
    v_lshlrev_b32 v6, 4, v6
    v_add_u32 v6, s15, v6
    v_lshrrev_b32 v16, 2, v2
    v_and_b32 v17, 1, v3
    v_lshrrev_b32 v18, 1, v16
    v_lshl_add_u32 v18, v17, 1, v18
    v_and_b32 v19, 3, v1
    v_lshlrev_b32 v19, 3, v19
    v_add_u32 v19, s20, v19
    s_waitcnt lgkmcnt(0)
    s_cmp_lt_u32 s16, 4
    s_cbranch_scc1 K2_opart
    v_mov_b32 v64, 0
    v_mov_b32 v65, 0
    v_mov_b32 v66, 0
    v_mov_b32 v67, 0
    v_mov_b32 v68, 0
    v_mov_b32 v69, 0
    v_mov_b32 v70, 0
    v_mov_b32 v71, 0
    v_mov_b32 v72, 0
    v_mov_b32 v73, 0
    v_mov_b32 v74, 0
    v_mov_b32 v75, 0
    v_mov_b32 v76, 0
    v_mov_b32 v77, 0
    v_mov_b32 v78, 0
    v_mov_b32 v79, 0
    v_mov_b32 v80, 0
    v_mov_b32 v81, 0
    v_mov_b32 v82, 0
    v_mov_b32 v83, 0
    v_mov_b32 v84, 0
    v_mov_b32 v85, 0
    v_mov_b32 v86, 0
    v_mov_b32 v87, 0
    v_mov_b32 v88, 0
    v_mov_b32 v89, 0
    v_mov_b32 v90, 0
    v_mov_b32 v91, 0
    v_mov_b32 v92, 0
    v_mov_b32 v93, 0
    v_mov_b32 v94, 0
    v_mov_b32 v95, 0
    v_mov_b32 v96, 0
    v_mov_b32 v97, 0
    v_mov_b32 v98, 0
    v_mov_b32 v99, 0
    v_mov_b32 v100, 0
    v_mov_b32 v101, 0
    v_mov_b32 v102, 0
    v_mov_b32 v103, 0
    v_mov_b32 v104, 0
    v_mov_b32 v105, 0
    v_mov_b32 v106, 0
    v_mov_b32 v107, 0
    v_mov_b32 v108, 0
    v_mov_b32 v109, 0
    v_mov_b32 v110, 0
    v_mov_b32 v111, 0
    v_mov_b32 v112, 0
    v_mov_b32 v113, 0
    v_mov_b32 v114, 0
    v_mov_b32 v115, 0
    v_mov_b32 v116, 0
    v_mov_b32 v117, 0
    v_mov_b32 v118, 0
    v_mov_b32 v119, 0
    v_mov_b32 v120, 0
    v_mov_b32 v121, 0
    v_mov_b32 v122, 0
    v_mov_b32 v123, 0
    v_mov_b32 v124, 0
    v_mov_b32 v125, 0
    v_mov_b32 v126, 0
    v_mov_b32 v127, 0
    s_mov_b32 s24, s8
    s_mov_b32 s25, s9
    s_mov_b32 s26, 0x158000
    s_mov_b32 s27, 0x00020000
    s_add_u32 s32, s12, 0x600000
    s_addc_u32 s33, s13, 0
    s_mov_b32 s34, 0x560000
    s_mov_b32 s35, 0x00020000
    v_and_b32 v14, 3, v13
    v_lshrrev_b32 v15, 2, v13
    v_lshl_add_u32 v14, v15, 3, v14
    v_lshl_add_u32 v6, v14, 10, v6
    v_lshrrev_b32 v15, 1, v3
    v_lshlrev_b32 v15, 4, v15
    v_lshl_add_u32 v15, v17, 2, v15
    v_add_u32 v15, v15, v16
    v_lshl_add_u32 v19, v15, 7, v19
    v_xor_b32 v15, 0, v18
    v_lshl_add_u32 v8, v15, 5, v19
    v_xor_b32 v15, 1, v18
    v_lshl_add_u32 v9, v15, 5, v19
    v_xor_b32 v15, 2, v18
    v_lshl_add_u32 v10, v15, 5, v19
    v_xor_b32 v15, 3, v18
    v_lshl_add_u32 v11, v15, 5, v19
    s_mul_i32 s3, s14, 2752
    v_lshlrev_b32 v15, 4, v1
    v_add_u32 v12, s3, v15
    v_add_u32 v13, 44032, v12
    v_add_u32 v14, 88064, v12
    v_add_u32 v15, 132096, v12
    s_cmp_lt_u32 s17, 3
    s_cselect_b32 s42, 11, 10
    s_lshr_b32 s41, s15, 7
    s_lshr_b32 s3, s14, 6
    s_and_b32 s3, s3, 3
    s_mul_i32 s3, s3, 3
    s_add_u32 s41, s41, s3
    s_cmp_ge_u32 s41, s42
    s_cselect_b32 s3, s42, 0
    s_sub_u32 s41, s41, s3
    s_mov_b32 s41, 0
    s_lshl_b32 s21, s41, 2
    s_add_u32 s21, s21, s17
    s_lshl_b32 s22, s21, 15
    s_lshl_b32 s21, s21, 10
    buffer_load_dwordx4 v[128:131], v12, s[32:35], s21 offen
    buffer_load_dwordx4 v[132:135], v13, s[32:35], s21 offen
    buffer_load_dwordx4 v[136:139], v14, s[32:35], s21 offen
    buffer_load_dwordx4 v[140:143], v15, s[32:35], s21 offen
    s_add_u32 s30, s22, 0
    s_add_u32 m0, s20, 0
    s_nop 0
    buffer_load_dwordx4 v6, s[24:27], s30 offen lds
    s_add_u32 s30, s22, 4096
    s_add_u32 m0, s20, 1024
    s_nop 0
    buffer_load_dwordx4 v6, s[24:27], s30 offen lds
    s_add_u32 s30, s22, 16384
    s_add_u32 m0, s20, 2048
    s_nop 0
    buffer_load_dwordx4 v6, s[24:27], s30 offen lds
    s_add_u32 s30, s22, 20480
    s_add_u32 m0, s20, 3072
    s_nop 0
    buffer_load_dwordx4 v6, s[24:27], s30 offen lds
    s_add_u32 s41, s41, 1
    s_cmp_ge_u32 s41, s42
    s_cselect_b32 s41, 0, s41
    s_lshl_b32 s21, s41, 2
    s_add_u32 s21, s21, s17
    s_lshl_b32 s22, s21, 15
    s_lshl_b32 s21, s21, 10
    buffer_load_dwordx4 v[144:147], v12, s[32:35], s21 offen
    buffer_load_dwordx4 v[148:151], v13, s[32:35], s21 offen
    buffer_load_dwordx4 v[152:155], v14, s[32:35], s21 offen
    buffer_load_dwordx4 v[156:159], v15, s[32:35], s21 offen
    s_add_u32 s30, s22, 0
    s_add_u32 m0, s20, 4096
    s_nop 0
    buffer_load_dwordx4 v6, s[24:27], s30 offen lds
    s_add_u32 s30, s22, 4096
    s_add_u32 m0, s20, 5120
    s_nop 0
    buffer_load_dwordx4 v6, s[24:27], s30 offen lds
    s_add_u32 s30, s22, 16384
    s_add_u32 m0, s20, 6144
    s_nop 0
    buffer_load_dwordx4 v6, s[24:27], s30 offen lds
    s_add_u32 s30, s22, 20480
    s_add_u32 m0, s20, 7168
    s_nop 0
    buffer_load_dwordx4 v6, s[24:27], s30 offen lds
    s_add_u32 s41, s41, 1
    s_cmp_ge_u32 s41, s42
    s_cselect_b32 s41, 0, s41
    s_lshl_b32 s21, s41, 2
    s_add_u32 s21, s21, s17
    s_lshl_b32 s22, s21, 15
    s_lshl_b32 s21, s21, 10
    buffer_load_dwordx4 v[160:163], v12, s[32:35], s21 offen
    buffer_load_dwordx4 v[164:167], v13, s[32:35], s21 offen
    buffer_load_dwordx4 v[168:171], v14, s[32:35], s21 offen
    buffer_load_dwordx4 v[172:175], v15, s[32:35], s21 offen
    s_add_u32 s30, s22, 0
    s_add_u32 m0, s20, 8192
    s_nop 0
    buffer_load_dwordx4 v6, s[24:27], s30 offen lds
    s_add_u32 s30, s22, 4096
    s_add_u32 m0, s20, 9216
    s_nop 0
    buffer_load_dwordx4 v6, s[24:27], s30 offen lds
    s_add_u32 s30, s22, 16384
    s_add_u32 m0, s20, 10240
    s_nop 0
    buffer_load_dwordx4 v6, s[24:27], s30 offen lds
    s_add_u32 s30, s22, 20480
    s_add_u32 m0, s20, 11264
    s_nop 0
    buffer_load_dwordx4 v6, s[24:27], s30 offen lds
    s_add_u32 s41, s41, 1
    s_cmp_ge_u32 s41, s42
    s_cselect_b32 s41, 0, s41
    s_lshl_b32 s21, s41, 2
    s_add_u32 s21, s21, s17
    s_lshl_b32 s22, s21, 15
    s_lshl_b32 s21, s21, 10
    buffer_load_dwordx4 v[176:179], v12, s[32:35], s21 offen
    buffer_load_dwordx4 v[180:183], v13, s[32:35], s21 offen
    buffer_load_dwordx4 v[184:187], v14, s[32:35], s21 offen
    buffer_load_dwordx4 v[188:191], v15, s[32:35], s21 offen
    s_add_u32 s30, s22, 0
    s_add_u32 m0, s20, 12288
    s_nop 0
    buffer_load_dwordx4 v6, s[24:27], s30 offen lds
    s_add_u32 s30, s22, 4096
    s_add_u32 m0, s20, 13312
    s_nop 0
    buffer_load_dwordx4 v6, s[24:27], s30 offen lds
    s_add_u32 s30, s22, 16384
    s_add_u32 m0, s20, 14336
    s_nop 0
    buffer_load_dwordx4 v6, s[24:27], s30 offen lds
    s_add_u32 s30, s22, 20480
    s_add_u32 m0, s20, 15360
    s_nop 0
    buffer_load_dwordx4 v6, s[24:27], s30 offen lds
    s_add_u32 s41, s41, 1
    s_cmp_ge_u32 s41, s42
    s_cselect_b32 s41, 0, s41
    s_lshl_b32 s21, s41, 2
    s_add_u32 s21, s21, s17
    s_lshl_b32 s22, s21, 15
    s_lshl_b32 s21, s21, 10
    s_waitcnt vmcnt(24)
    ds_read_b64_tr_b16 v[32:33], v8 offset:0
    ds_read_b64_tr_b16 v[34:35], v8 offset:1024
    ds_read_b64_tr_b16 v[36:37], v9 offset:0
    ds_read_b64_tr_b16 v[38:39], v9 offset:1024
    ds_read_b64_tr_b16 v[40:41], v10 offset:0
    ds_read_b64_tr_b16 v[42:43], v10 offset:1024
    ds_read_b64_tr_b16 v[44:45], v11 offset:0
    ds_read_b64_tr_b16 v[46:47], v11 offset:1024
    s_waitcnt lgkmcnt(6)
    v_mfma_f32_16x16x32_bf16 v[64:67], v[32:35], v[128:131], v[64:67]
    v_mfma_f32_16x16x32_bf16 v[68:71], v[32:35], v[132:135], v[68:71]
    v_mfma_f32_16x16x32_bf16 v[72:75], v[32:35], v[136:139], v[72:75]
    v_mfma_f32_16x16x32_bf16 v[76:79], v[32:35], v[140:143], v[76:79]
    s_waitcnt lgkmcnt(4)
    v_mfma_f32_16x16x32_bf16 v[80:83], v[36:39], v[128:131], v[80:83]
    v_mfma_f32_16x16x32_bf16 v[84:87], v[36:39], v[132:135], v[84:87]
    v_mfma_f32_16x16x32_bf16 v[88:91], v[36:39], v[136:139], v[88:91]
    v_mfma_f32_16x16x32_bf16 v[92:95], v[36:39], v[140:143], v[92:95]
    s_waitcnt lgkmcnt(2)
    v_mfma_f32_16x16x32_bf16 v[96:99], v[40:43], v[128:131], v[96:99]
    v_mfma_f32_16x16x32_bf16 v[100:103], v[40:43], v[132:135], v[100:103]
    v_mfma_f32_16x16x32_bf16 v[104:107], v[40:43], v[136:139], v[104:107]
    v_mfma_f32_16x16x32_bf16 v[108:111], v[40:43], v[140:143], v[108:111]
    s_waitcnt lgkmcnt(0)
    v_mfma_f32_16x16x32_bf16 v[112:115], v[44:47], v[128:131], v[112:115]
    v_mfma_f32_16x16x32_bf16 v[116:119], v[44:47], v[132:135], v[116:119]
    v_mfma_f32_16x16x32_bf16 v[120:123], v[44:47], v[136:139], v[120:123]
    v_mfma_f32_16x16x32_bf16 v[124:127], v[44:47], v[140:143], v[124:127]
    buffer_load_dwordx4 v[128:131], v12, s[32:35], s21 offen
    buffer_load_dwordx4 v[132:135], v13, s[32:35], s21 offen
    buffer_load_dwordx4 v[136:139], v14, s[32:35], s21 offen
    buffer_load_dwordx4 v[140:143], v15, s[32:35], s21 offen
    s_add_u32 s30, s22, 0
    s_add_u32 m0, s20, 0
    s_nop 0
    buffer_load_dwordx4 v6, s[24:27], s30 offen lds
    s_add_u32 s30, s22, 4096
    s_add_u32 m0, s20, 1024
    s_nop 0
    buffer_load_dwordx4 v6, s[24:27], s30 offen lds
    s_add_u32 s30, s22, 16384
    s_add_u32 m0, s20, 2048
    s_nop 0
    buffer_load_dwordx4 v6, s[24:27], s30 offen lds
    s_add_u32 s30, s22, 20480
    s_add_u32 m0, s20, 3072
    s_nop 0
    buffer_load_dwordx4 v6, s[24:27], s30 offen lds
    s_add_u32 s41, s41, 1
    s_cmp_ge_u32 s41, s42
    s_cselect_b32 s41, 0, s41
    s_lshl_b32 s21, s41, 2
    s_add_u32 s21, s21, s17
    s_lshl_b32 s22, s21, 15
    s_lshl_b32 s21, s21, 10
    s_waitcnt vmcnt(24)
    ds_read_b64_tr_b16 v[32:33], v8 offset:4096
    ds_read_b64_tr_b16 v[34:35], v8 offset:5120
    ds_read_b64_tr_b16 v[36:37], v9 offset:4096
    ds_read_b64_tr_b16 v[38:39], v9 offset:5120
    ds_read_b64_tr_b16 v[40:41], v10 offset:4096
    ds_read_b64_tr_b16 v[42:43], v10 offset:5120
    ds_read_b64_tr_b16 v[44:45], v11 offset:4096
    ds_read_b64_tr_b16 v[46:47], v11 offset:5120
    s_waitcnt lgkmcnt(6)
    v_mfma_f32_16x16x32_bf16 v[64:67], v[32:35], v[144:147], v[64:67]
    v_mfma_f32_16x16x32_bf16 v[68:71], v[32:35], v[148:151], v[68:71]
    v_mfma_f32_16x16x32_bf16 v[72:75], v[32:35], v[152:155], v[72:75]
    v_mfma_f32_16x16x32_bf16 v[76:79], v[32:35], v[156:159], v[76:79]
    s_waitcnt lgkmcnt(4)
    v_mfma_f32_16x16x32_bf16 v[80:83], v[36:39], v[144:147], v[80:83]
    v_mfma_f32_16x16x32_bf16 v[84:87], v[36:39], v[148:151], v[84:87]
    v_mfma_f32_16x16x32_bf16 v[88:91], v[36:39], v[152:155], v[88:91]
    v_mfma_f32_16x16x32_bf16 v[92:95], v[36:39], v[156:159], v[92:95]
    s_waitcnt lgkmcnt(2)
    v_mfma_f32_16x16x32_bf16 v[96:99], v[40:43], v[144:147], v[96:99]
    v_mfma_f32_16x16x32_bf16 v[100:103], v[40:43], v[148:151], v[100:103]
    v_mfma_f32_16x16x32_bf16 v[104:107], v[40:43], v[152:155], v[104:107]
    v_mfma_f32_16x16x32_bf16 v[108:111], v[40:43], v[156:159], v[108:111]
    s_waitcnt lgkmcnt(0)
    v_mfma_f32_16x16x32_bf16 v[112:115], v[44:47], v[144:147], v[112:115]
    v_mfma_f32_16x16x32_bf16 v[116:119], v[44:47], v[148:151], v[116:119]
    v_mfma_f32_16x16x32_bf16 v[120:123], v[44:47], v[152:155], v[120:123]
    v_mfma_f32_16x16x32_bf16 v[124:127], v[44:47], v[156:159], v[124:127]
    buffer_load_dwordx4 v[144:147], v12, s[32:35], s21 offen
    buffer_load_dwordx4 v[148:151], v13, s[32:35], s21 offen
    buffer_load_dwordx4 v[152:155], v14, s[32:35], s21 offen
    buffer_load_dwordx4 v[156:159], v15, s[32:35], s21 offen
    s_add_u32 s30, s22, 0
    s_add_u32 m0, s20, 4096
    s_nop 0
    buffer_load_dwordx4 v6, s[24:27], s30 offen lds
    s_add_u32 s30, s22, 4096
    s_add_u32 m0, s20, 5120
    s_nop 0
    buffer_load_dwordx4 v6, s[24:27], s30 offen lds
    s_add_u32 s30, s22, 16384
    s_add_u32 m0, s20, 6144
    s_nop 0
    buffer_load_dwordx4 v6, s[24:27], s30 offen lds
    s_add_u32 s30, s22, 20480
    s_add_u32 m0, s20, 7168
    s_nop 0
    buffer_load_dwordx4 v6, s[24:27], s30 offen lds
    s_add_u32 s41, s41, 1
    s_cmp_ge_u32 s41, s42
    s_cselect_b32 s41, 0, s41
    s_lshl_b32 s21, s41, 2
    s_add_u32 s21, s21, s17
    s_lshl_b32 s22, s21, 15
    s_lshl_b32 s21, s21, 10
    s_waitcnt vmcnt(24)
    ds_read_b64_tr_b16 v[32:33], v8 offset:8192
    ds_read_b64_tr_b16 v[34:35], v8 offset:9216
    ds_read_b64_tr_b16 v[36:37], v9 offset:8192
    ds_read_b64_tr_b16 v[38:39], v9 offset:9216
    ds_read_b64_tr_b16 v[40:41], v10 offset:8192
    ds_read_b64_tr_b16 v[42:43], v10 offset:9216
    ds_read_b64_tr_b16 v[44:45], v11 offset:8192
    ds_read_b64_tr_b16 v[46:47], v11 offset:9216
    s_waitcnt lgkmcnt(6)
    v_mfma_f32_16x16x32_bf16 v[64:67], v[32:35], v[160:163], v[64:67]
    v_mfma_f32_16x16x32_bf16 v[68:71], v[32:35], v[164:167], v[68:71]
    v_mfma_f32_16x16x32_bf16 v[72:75], v[32:35], v[168:171], v[72:75]
    v_mfma_f32_16x16x32_bf16 v[76:79], v[32:35], v[172:175], v[76:79]
    s_waitcnt lgkmcnt(4)
    v_mfma_f32_16x16x32_bf16 v[80:83], v[36:39], v[160:163], v[80:83]
    v_mfma_f32_16x16x32_bf16 v[84:87], v[36:39], v[164:167], v[84:87]
    v_mfma_f32_16x16x32_bf16 v[88:91], v[36:39], v[168:171], v[88:91]
    v_mfma_f32_16x16x32_bf16 v[92:95], v[36:39], v[172:175], v[92:95]
    s_waitcnt lgkmcnt(2)
    v_mfma_f32_16x16x32_bf16 v[96:99], v[40:43], v[160:163], v[96:99]
    v_mfma_f32_16x16x32_bf16 v[100:103], v[40:43], v[164:167], v[100:103]
    v_mfma_f32_16x16x32_bf16 v[104:107], v[40:43], v[168:171], v[104:107]
    v_mfma_f32_16x16x32_bf16 v[108:111], v[40:43], v[172:175], v[108:111]
    s_waitcnt lgkmcnt(0)
    v_mfma_f32_16x16x32_bf16 v[112:115], v[44:47], v[160:163], v[112:115]
    v_mfma_f32_16x16x32_bf16 v[116:119], v[44:47], v[164:167], v[116:119]
    v_mfma_f32_16x16x32_bf16 v[120:123], v[44:47], v[168:171], v[120:123]
    v_mfma_f32_16x16x32_bf16 v[124:127], v[44:47], v[172:175], v[124:127]
    buffer_load_dwordx4 v[160:163], v12, s[32:35], s21 offen
    buffer_load_dwordx4 v[164:167], v13, s[32:35], s21 offen
    buffer_load_dwordx4 v[168:171], v14, s[32:35], s21 offen
    buffer_load_dwordx4 v[172:175], v15, s[32:35], s21 offen
    s_add_u32 s30, s22, 0
    s_add_u32 m0, s20, 8192
    s_nop 0
    buffer_load_dwordx4 v6, s[24:27], s30 offen lds
    s_add_u32 s30, s22, 4096
    s_add_u32 m0, s20, 9216
    s_nop 0
    buffer_load_dwordx4 v6, s[24:27], s30 offen lds
    s_add_u32 s30, s22, 16384
    s_add_u32 m0, s20, 10240
    s_nop 0
    buffer_load_dwordx4 v6, s[24:27], s30 offen lds
    s_add_u32 s30, s22, 20480
    s_add_u32 m0, s20, 11264
    s_nop 0
    buffer_load_dwordx4 v6, s[24:27], s30 offen lds
    s_add_u32 s41, s41, 1
    s_cmp_ge_u32 s41, s42
    s_cselect_b32 s41, 0, s41
    s_lshl_b32 s21, s41, 2
    s_add_u32 s21, s21, s17
    s_lshl_b32 s22, s21, 15
    s_lshl_b32 s21, s21, 10
    s_waitcnt vmcnt(24)
    ds_read_b64_tr_b16 v[32:33], v8 offset:12288
    ds_read_b64_tr_b16 v[34:35], v8 offset:13312
    ds_read_b64_tr_b16 v[36:37], v9 offset:12288
    ds_read_b64_tr_b16 v[38:39], v9 offset:13312
    ds_read_b64_tr_b16 v[40:41], v10 offset:12288
    ds_read_b64_tr_b16 v[42:43], v10 offset:13312
    ds_read_b64_tr_b16 v[44:45], v11 offset:12288
    ds_read_b64_tr_b16 v[46:47], v11 offset:13312
    s_waitcnt lgkmcnt(6)
    v_mfma_f32_16x16x32_bf16 v[64:67], v[32:35], v[176:179], v[64:67]
    v_mfma_f32_16x16x32_bf16 v[68:71], v[32:35], v[180:183], v[68:71]
    v_mfma_f32_16x16x32_bf16 v[72:75], v[32:35], v[184:187], v[72:75]
    v_mfma_f32_16x16x32_bf16 v[76:79], v[32:35], v[188:191], v[76:79]
    s_waitcnt lgkmcnt(4)
    v_mfma_f32_16x16x32_bf16 v[80:83], v[36:39], v[176:179], v[80:83]
    v_mfma_f32_16x16x32_bf16 v[84:87], v[36:39], v[180:183], v[84:87]
    v_mfma_f32_16x16x32_bf16 v[88:91], v[36:39], v[184:187], v[88:91]
    v_mfma_f32_16x16x32_bf16 v[92:95], v[36:39], v[188:191], v[92:95]
    s_waitcnt lgkmcnt(2)
    v_mfma_f32_16x16x32_bf16 v[96:99], v[40:43], v[176:179], v[96:99]
    v_mfma_f32_16x16x32_bf16 v[100:103], v[40:43], v[180:183], v[100:103]
    v_mfma_f32_16x16x32_bf16 v[104:107], v[40:43], v[184:187], v[104:107]
    v_mfma_f32_16x16x32_bf16 v[108:111], v[40:43], v[188:191], v[108:111]
    s_waitcnt lgkmcnt(0)
    v_mfma_f32_16x16x32_bf16 v[112:115], v[44:47], v[176:179], v[112:115]
    v_mfma_f32_16x16x32_bf16 v[116:119], v[44:47], v[180:183], v[116:119]
    v_mfma_f32_16x16x32_bf16 v[120:123], v[44:47], v[184:187], v[120:123]
    v_mfma_f32_16x16x32_bf16 v[124:127], v[44:47], v[188:191], v[124:127]
    buffer_load_dwordx4 v[176:179], v12, s[32:35], s21 offen
    buffer_load_dwordx4 v[180:183], v13, s[32:35], s21 offen
    buffer_load_dwordx4 v[184:187], v14, s[32:35], s21 offen
    buffer_load_dwordx4 v[188:191], v15, s[32:35], s21 offen
    s_add_u32 s30, s22, 0
    s_add_u32 m0, s20, 12288
    s_nop 0
    buffer_load_dwordx4 v6, s[24:27], s30 offen lds
    s_add_u32 s30, s22, 4096
    s_add_u32 m0, s20, 13312
    s_nop 0
    buffer_load_dwordx4 v6, s[24:27], s30 offen lds
    s_add_u32 s30, s22, 16384
    s_add_u32 m0, s20, 14336
    s_nop 0
    buffer_load_dwordx4 v6, s[24:27], s30 offen lds
    s_add_u32 s30, s22, 20480
    s_add_u32 m0, s20, 15360
    s_nop 0
    buffer_load_dwordx4 v6, s[24:27], s30 offen lds
    s_add_u32 s41, s41, 1
    s_cmp_ge_u32 s41, s42
    s_cselect_b32 s41, 0, s41
    s_lshl_b32 s21, s41, 2
    s_add_u32 s21, s21, s17
    s_lshl_b32 s22, s21, 15
    s_lshl_b32 s21, s21, 10
    s_waitcnt vmcnt(24)
    ds_read_b64_tr_b16 v[32:33], v8 offset:0
    ds_read_b64_tr_b16 v[34:35], v8 offset:1024
    ds_read_b64_tr_b16 v[36:37], v9 offset:0
    ds_read_b64_tr_b16 v[38:39], v9 offset:1024
    ds_read_b64_tr_b16 v[40:41], v10 offset:0
    ds_read_b64_tr_b16 v[42:43], v10 offset:1024
    ds_read_b64_tr_b16 v[44:45], v11 offset:0
    ds_read_b64_tr_b16 v[46:47], v11 offset:1024
    s_waitcnt lgkmcnt(6)
    v_mfma_f32_16x16x32_bf16 v[64:67], v[32:35], v[128:131], v[64:67]
    v_mfma_f32_16x16x32_bf16 v[68:71], v[32:35], v[132:135], v[68:71]
    v_mfma_f32_16x16x32_bf16 v[72:75], v[32:35], v[136:139], v[72:75]
    v_mfma_f32_16x16x32_bf16 v[76:79], v[32:35], v[140:143], v[76:79]
    s_waitcnt lgkmcnt(4)
    v_mfma_f32_16x16x32_bf16 v[80:83], v[36:39], v[128:131], v[80:83]
    v_mfma_f32_16x16x32_bf16 v[84:87], v[36:39], v[132:135], v[84:87]
    v_mfma_f32_16x16x32_bf16 v[88:91], v[36:39], v[136:139], v[88:91]
    v_mfma_f32_16x16x32_bf16 v[92:95], v[36:39], v[140:143], v[92:95]
    s_waitcnt lgkmcnt(2)
    v_mfma_f32_16x16x32_bf16 v[96:99], v[40:43], v[128:131], v[96:99]
    v_mfma_f32_16x16x32_bf16 v[100:103], v[40:43], v[132:135], v[100:103]
    v_mfma_f32_16x16x32_bf16 v[104:107], v[40:43], v[136:139], v[104:107]
    v_mfma_f32_16x16x32_bf16 v[108:111], v[40:43], v[140:143], v[108:111]
    s_waitcnt lgkmcnt(0)
    v_mfma_f32_16x16x32_bf16 v[112:115], v[44:47], v[128:131], v[112:115]
    v_mfma_f32_16x16x32_bf16 v[116:119], v[44:47], v[132:135], v[116:119]
    v_mfma_f32_16x16x32_bf16 v[120:123], v[44:47], v[136:139], v[120:123]
    v_mfma_f32_16x16x32_bf16 v[124:127], v[44:47], v[140:143], v[124:127]
    buffer_load_dwordx4 v[128:131], v12, s[32:35], s21 offen
    buffer_load_dwordx4 v[132:135], v13, s[32:35], s21 offen
    buffer_load_dwordx4 v[136:139], v14, s[32:35], s21 offen
    buffer_load_dwordx4 v[140:143], v15, s[32:35], s21 offen
    s_add_u32 s30, s22, 0
    s_add_u32 m0, s20, 0
    s_nop 0
    buffer_load_dwordx4 v6, s[24:27], s30 offen lds
    s_add_u32 s30, s22, 4096
    s_add_u32 m0, s20, 1024
    s_nop 0
    buffer_load_dwordx4 v6, s[24:27], s30 offen lds
    s_add_u32 s30, s22, 16384
    s_add_u32 m0, s20, 2048
    s_nop 0
    buffer_load_dwordx4 v6, s[24:27], s30 offen lds
    s_add_u32 s30, s22, 20480
    s_add_u32 m0, s20, 3072
    s_nop 0
    buffer_load_dwordx4 v6, s[24:27], s30 offen lds
    s_add_u32 s41, s41, 1
    s_cmp_ge_u32 s41, s42
    s_cselect_b32 s41, 0, s41
    s_lshl_b32 s21, s41, 2
    s_add_u32 s21, s21, s17
    s_lshl_b32 s22, s21, 15
    s_lshl_b32 s21, s21, 10
    s_waitcnt vmcnt(24)
    ds_read_b64_tr_b16 v[32:33], v8 offset:4096
    ds_read_b64_tr_b16 v[34:35], v8 offset:5120
    ds_read_b64_tr_b16 v[36:37], v9 offset:4096
    ds_read_b64_tr_b16 v[38:39], v9 offset:5120
    ds_read_b64_tr_b16 v[40:41], v10 offset:4096
    ds_read_b64_tr_b16 v[42:43], v10 offset:5120
    ds_read_b64_tr_b16 v[44:45], v11 offset:4096
    ds_read_b64_tr_b16 v[46:47], v11 offset:5120
    s_waitcnt lgkmcnt(6)
    v_mfma_f32_16x16x32_bf16 v[64:67], v[32:35], v[144:147], v[64:67]
    v_mfma_f32_16x16x32_bf16 v[68:71], v[32:35], v[148:151], v[68:71]
    v_mfma_f32_16x16x32_bf16 v[72:75], v[32:35], v[152:155], v[72:75]
    v_mfma_f32_16x16x32_bf16 v[76:79], v[32:35], v[156:159], v[76:79]
    s_waitcnt lgkmcnt(4)
    v_mfma_f32_16x16x32_bf16 v[80:83], v[36:39], v[144:147], v[80:83]
    v_mfma_f32_16x16x32_bf16 v[84:87], v[36:39], v[148:151], v[84:87]
    v_mfma_f32_16x16x32_bf16 v[88:91], v[36:39], v[152:155], v[88:91]
    v_mfma_f32_16x16x32_bf16 v[92:95], v[36:39], v[156:159], v[92:95]
    s_waitcnt lgkmcnt(2)
    v_mfma_f32_16x16x32_bf16 v[96:99], v[40:43], v[144:147], v[96:99]
    v_mfma_f32_16x16x32_bf16 v[100:103], v[40:43], v[148:151], v[100:103]
    v_mfma_f32_16x16x32_bf16 v[104:107], v[40:43], v[152:155], v[104:107]
    v_mfma_f32_16x16x32_bf16 v[108:111], v[40:43], v[156:159], v[108:111]
    s_waitcnt lgkmcnt(0)
    v_mfma_f32_16x16x32_bf16 v[112:115], v[44:47], v[144:147], v[112:115]
    v_mfma_f32_16x16x32_bf16 v[116:119], v[44:47], v[148:151], v[116:119]
    v_mfma_f32_16x16x32_bf16 v[120:123], v[44:47], v[152:155], v[120:123]
    v_mfma_f32_16x16x32_bf16 v[124:127], v[44:47], v[156:159], v[124:127]
    buffer_load_dwordx4 v[144:147], v12, s[32:35], s21 offen
    buffer_load_dwordx4 v[148:151], v13, s[32:35], s21 offen
    buffer_load_dwordx4 v[152:155], v14, s[32:35], s21 offen
    buffer_load_dwordx4 v[156:159], v15, s[32:35], s21 offen
    s_add_u32 s30, s22, 0
    s_add_u32 m0, s20, 4096
    s_nop 0
    buffer_load_dwordx4 v6, s[24:27], s30 offen lds
    s_add_u32 s30, s22, 4096
    s_add_u32 m0, s20, 5120
    s_nop 0
    buffer_load_dwordx4 v6, s[24:27], s30 offen lds
    s_add_u32 s30, s22, 16384
    s_add_u32 m0, s20, 6144
    s_nop 0
    buffer_load_dwordx4 v6, s[24:27], s30 offen lds
    s_add_u32 s30, s22, 20480
    s_add_u32 m0, s20, 7168
    s_nop 0
    buffer_load_dwordx4 v6, s[24:27], s30 offen lds
    s_add_u32 s41, s41, 1
    s_cmp_ge_u32 s41, s42
    s_cselect_b32 s41, 0, s41
    s_lshl_b32 s21, s41, 2
    s_add_u32 s21, s21, s17
    s_lshl_b32 s22, s21, 15
    s_lshl_b32 s21, s21, 10
    s_waitcnt vmcnt(24)
    ds_read_b64_tr_b16 v[32:33], v8 offset:8192
    ds_read_b64_tr_b16 v[34:35], v8 offset:9216
    ds_read_b64_tr_b16 v[36:37], v9 offset:8192
    ds_read_b64_tr_b16 v[38:39], v9 offset:9216
    ds_read_b64_tr_b16 v[40:41], v10 offset:8192
    ds_read_b64_tr_b16 v[42:43], v10 offset:9216
    ds_read_b64_tr_b16 v[44:45], v11 offset:8192
    ds_read_b64_tr_b16 v[46:47], v11 offset:9216
    s_waitcnt lgkmcnt(6)
    v_mfma_f32_16x16x32_bf16 v[64:67], v[32:35], v[160:163], v[64:67]
    v_mfma_f32_16x16x32_bf16 v[68:71], v[32:35], v[164:167], v[68:71]
    v_mfma_f32_16x16x32_bf16 v[72:75], v[32:35], v[168:171], v[72:75]
    v_mfma_f32_16x16x32_bf16 v[76:79], v[32:35], v[172:175], v[76:79]
    s_waitcnt lgkmcnt(4)
    v_mfma_f32_16x16x32_bf16 v[80:83], v[36:39], v[160:163], v[80:83]
    v_mfma_f32_16x16x32_bf16 v[84:87], v[36:39], v[164:167], v[84:87]
    v_mfma_f32_16x16x32_bf16 v[88:91], v[36:39], v[168:171], v[88:91]
    v_mfma_f32_16x16x32_bf16 v[92:95], v[36:39], v[172:175], v[92:95]
    s_waitcnt lgkmcnt(2)
    v_mfma_f32_16x16x32_bf16 v[96:99], v[40:43], v[160:163], v[96:99]
    v_mfma_f32_16x16x32_bf16 v[100:103], v[40:43], v[164:167], v[100:103]
    v_mfma_f32_16x16x32_bf16 v[104:107], v[40:43], v[168:171], v[104:107]
    v_mfma_f32_16x16x32_bf16 v[108:111], v[40:43], v[172:175], v[108:111]
    s_waitcnt lgkmcnt(0)
    v_mfma_f32_16x16x32_bf16 v[112:115], v[44:47], v[160:163], v[112:115]
    v_mfma_f32_16x16x32_bf16 v[116:119], v[44:47], v[164:167], v[116:119]
    v_mfma_f32_16x16x32_bf16 v[120:123], v[44:47], v[168:171], v[120:123]
    v_mfma_f32_16x16x32_bf16 v[124:127], v[44:47], v[172:175], v[124:127]
    s_cmp_lt_u32 s17, 3
    s_cbranch_scc0 K2_h_tailY
    buffer_load_dwordx4 v[160:163], v12, s[32:35], s21 offen
    buffer_load_dwordx4 v[164:167], v13, s[32:35], s21 offen
    buffer_load_dwordx4 v[168:171], v14, s[32:35], s21 offen
    buffer_load_dwordx4 v[172:175], v15, s[32:35], s21 offen
    s_add_u32 s30, s22, 0
    s_add_u32 m0, s20, 8192
    s_nop 0
    buffer_load_dwordx4 v6, s[24:27], s30 offen lds
    s_add_u32 s30, s22, 4096
    s_add_u32 m0, s20, 9216
    s_nop 0
    buffer_load_dwordx4 v6, s[24:27], s30 offen lds
    s_add_u32 s30, s22, 16384
    s_add_u32 m0, s20, 10240
    s_nop 0
    buffer_load_dwordx4 v6, s[24:27], s30 offen lds
    s_add_u32 s30, s22, 20480
    s_add_u32 m0, s20, 11264
    s_nop 0
    buffer_load_dwordx4 v6, s[24:27], s30 offen lds
    s_add_u32 s41, s41, 1
    s_cmp_ge_u32 s41, s42
    s_cselect_b32 s41, 0, s41
    s_lshl_b32 s21, s41, 2
    s_add_u32 s21, s21, s17
    s_lshl_b32 s22, s21, 15
    s_lshl_b32 s21, s21, 10
    s_waitcnt vmcnt(24)
    ds_read_b64_tr_b16 v[32:33], v8 offset:12288
    ds_read_b64_tr_b16 v[34:35], v8 offset:13312
    ds_read_b64_tr_b16 v[36:37], v9 offset:12288
    ds_read_b64_tr_b16 v[38:39], v9 offset:13312
    ds_read_b64_tr_b16 v[40:41], v10 offset:12288
    ds_read_b64_tr_b16 v[42:43], v10 offset:13312
    ds_read_b64_tr_b16 v[44:45], v11 offset:12288
    ds_read_b64_tr_b16 v[46:47], v11 offset:13312
    s_waitcnt lgkmcnt(6)
    v_mfma_f32_16x16x32_bf16 v[64:67], v[32:35], v[176:179], v[64:67]
    v_mfma_f32_16x16x32_bf16 v[68:71], v[32:35], v[180:183], v[68:71]
    v_mfma_f32_16x16x32_bf16 v[72:75], v[32:35], v[184:187], v[72:75]
    v_mfma_f32_16x16x32_bf16 v[76:79], v[32:35], v[188:191], v[76:79]
    s_waitcnt lgkmcnt(4)
    v_mfma_f32_16x16x32_bf16 v[80:83], v[36:39], v[176:179], v[80:83]
    v_mfma_f32_16x16x32_bf16 v[84:87], v[36:39], v[180:183], v[84:87]
    v_mfma_f32_16x16x32_bf16 v[88:91], v[36:39], v[184:187], v[88:91]
    v_mfma_f32_16x16x32_bf16 v[92:95], v[36:39], v[188:191], v[92:95]
    s_waitcnt lgkmcnt(2)
    v_mfma_f32_16x16x32_bf16 v[96:99], v[40:43], v[176:179], v[96:99]
    v_mfma_f32_16x16x32_bf16 v[100:103], v[40:43], v[180:183], v[100:103]
    v_mfma_f32_16x16x32_bf16 v[104:107], v[40:43], v[184:187], v[104:107]
    v_mfma_f32_16x16x32_bf16 v[108:111], v[40:43], v[188:191], v[108:111]
    s_waitcnt lgkmcnt(0)
    v_mfma_f32_16x16x32_bf16 v[112:115], v[44:47], v[176:179], v[112:115]
    v_mfma_f32_16x16x32_bf16 v[116:119], v[44:47], v[180:183], v[116:119]
    v_mfma_f32_16x16x32_bf16 v[120:123], v[44:47], v[184:187], v[120:123]
    v_mfma_f32_16x16x32_bf16 v[124:127], v[44:47], v[188:191], v[124:127]
    s_waitcnt vmcnt(16)
    ds_read_b64_tr_b16 v[32:33], v8 offset:0
    ds_read_b64_tr_b16 v[34:35], v8 offset:1024
    ds_read_b64_tr_b16 v[36:37], v9 offset:0
    ds_read_b64_tr_b16 v[38:39], v9 offset:1024
    ds_read_b64_tr_b16 v[40:41], v10 offset:0
    ds_read_b64_tr_b16 v[42:43], v10 offset:1024
    ds_read_b64_tr_b16 v[44:45], v11 offset:0
    ds_read_b64_tr_b16 v[46:47], v11 offset:1024
    s_waitcnt lgkmcnt(6)
    v_mfma_f32_16x16x32_bf16 v[64:67], v[32:35], v[128:131], v[64:67]
    v_mfma_f32_16x16x32_bf16 v[68:71], v[32:35], v[132:135], v[68:71]
    v_mfma_f32_16x16x32_bf16 v[72:75], v[32:35], v[136:139], v[72:75]
    v_mfma_f32_16x16x32_bf16 v[76:79], v[32:35], v[140:143], v[76:79]
    s_waitcnt lgkmcnt(4)
    v_mfma_f32_16x16x32_bf16 v[80:83], v[36:39], v[128:131], v[80:83]
    v_mfma_f32_16x16x32_bf16 v[84:87], v[36:39], v[132:135], v[84:87]
    v_mfma_f32_16x16x32_bf16 v[88:91], v[36:39], v[136:139], v[88:91]
    v_mfma_f32_16x16x32_bf16 v[92:95], v[36:39], v[140:143], v[92:95]
    s_waitcnt lgkmcnt(2)
    v_mfma_f32_16x16x32_bf16 v[96:99], v[40:43], v[128:131], v[96:99]
    v_mfma_f32_16x16x32_bf16 v[100:103], v[40:43], v[132:135], v[100:103]
    v_mfma_f32_16x16x32_bf16 v[104:107], v[40:43], v[136:139], v[104:107]
    v_mfma_f32_16x16x32_bf16 v[108:111], v[40:43], v[140:143], v[108:111]
    s_waitcnt lgkmcnt(0)
    v_mfma_f32_16x16x32_bf16 v[112:115], v[44:47], v[128:131], v[112:115]
    v_mfma_f32_16x16x32_bf16 v[116:119], v[44:47], v[132:135], v[116:119]
    v_mfma_f32_16x16x32_bf16 v[120:123], v[44:47], v[136:139], v[120:123]
    v_mfma_f32_16x16x32_bf16 v[124:127], v[44:47], v[140:143], v[124:127]
    s_waitcnt vmcnt(8)
    ds_read_b64_tr_b16 v[32:33], v8 offset:4096
    ds_read_b64_tr_b16 v[34:35], v8 offset:5120
    ds_read_b64_tr_b16 v[36:37], v9 offset:4096
    ds_read_b64_tr_b16 v[38:39], v9 offset:5120
    ds_read_b64_tr_b16 v[40:41], v10 offset:4096
    ds_read_b64_tr_b16 v[42:43], v10 offset:5120
    ds_read_b64_tr_b16 v[44:45], v11 offset:4096
    ds_read_b64_tr_b16 v[46:47], v11 offset:5120
    s_waitcnt lgkmcnt(6)
    v_mfma_f32_16x16x32_bf16 v[64:67], v[32:35], v[144:147], v[64:67]
    v_mfma_f32_16x16x32_bf16 v[68:71], v[32:35], v[148:151], v[68:71]
    v_mfma_f32_16x16x32_bf16 v[72:75], v[32:35], v[152:155], v[72:75]
    v_mfma_f32_16x16x32_bf16 v[76:79], v[32:35], v[156:159], v[76:79]
    s_waitcnt lgkmcnt(4)
    v_mfma_f32_16x16x32_bf16 v[80:83], v[36:39], v[144:147], v[80:83]
    v_mfma_f32_16x16x32_bf16 v[84:87], v[36:39], v[148:151], v[84:87]
    v_mfma_f32_16x16x32_bf16 v[88:91], v[36:39], v[152:155], v[88:91]
    v_mfma_f32_16x16x32_bf16 v[92:95], v[36:39], v[156:159], v[92:95]
    s_waitcnt lgkmcnt(2)
    v_mfma_f32_16x16x32_bf16 v[96:99], v[40:43], v[144:147], v[96:99]
    v_mfma_f32_16x16x32_bf16 v[100:103], v[40:43], v[148:151], v[100:103]
    v_mfma_f32_16x16x32_bf16 v[104:107], v[40:43], v[152:155], v[104:107]
    v_mfma_f32_16x16x32_bf16 v[108:111], v[40:43], v[156:159], v[108:111]
    s_waitcnt lgkmcnt(0)
    v_mfma_f32_16x16x32_bf16 v[112:115], v[44:47], v[144:147], v[112:115]
    v_mfma_f32_16x16x32_bf16 v[116:119], v[44:47], v[148:151], v[116:119]
    v_mfma_f32_16x16x32_bf16 v[120:123], v[44:47], v[152:155], v[120:123]
    v_mfma_f32_16x16x32_bf16 v[124:127], v[44:47], v[156:159], v[124:127]
    s_waitcnt vmcnt(0)
    ds_read_b64_tr_b16 v[32:33], v8 offset:8192
    ds_read_b64_tr_b16 v[34:35], v8 offset:9216
    ds_read_b64_tr_b16 v[36:37], v9 offset:8192
    ds_read_b64_tr_b16 v[38:39], v9 offset:9216
    ds_read_b64_tr_b16 v[40:41], v10 offset:8192
    ds_read_b64_tr_b16 v[42:43], v10 offset:9216
    ds_read_b64_tr_b16 v[44:45], v11 offset:8192
    ds_read_b64_tr_b16 v[46:47], v11 offset:9216
    s_waitcnt lgkmcnt(6)
    v_mfma_f32_16x16x32_bf16 v[64:67], v[32:35], v[160:163], v[64:67]
    v_mfma_f32_16x16x32_bf16 v[68:71], v[32:35], v[164:167], v[68:71]
    v_mfma_f32_16x16x32_bf16 v[72:75], v[32:35], v[168:171], v[72:75]
    v_mfma_f32_16x16x32_bf16 v[76:79], v[32:35], v[172:175], v[76:79]
    s_waitcnt lgkmcnt(4)
    v_mfma_f32_16x16x32_bf16 v[80:83], v[36:39], v[160:163], v[80:83]
    v_mfma_f32_16x16x32_bf16 v[84:87], v[36:39], v[164:167], v[84:87]
    v_mfma_f32_16x16x32_bf16 v[88:91], v[36:39], v[168:171], v[88:91]
    v_mfma_f32_16x16x32_bf16 v[92:95], v[36:39], v[172:175], v[92:95]
    s_waitcnt lgkmcnt(2)
    v_mfma_f32_16x16x32_bf16 v[96:99], v[40:43], v[160:163], v[96:99]
    v_mfma_f32_16x16x32_bf16 v[100:103], v[40:43], v[164:167], v[100:103]
    v_mfma_f32_16x16x32_bf16 v[104:107], v[40:43], v[168:171], v[104:107]
    v_mfma_f32_16x16x32_bf16 v[108:111], v[40:43], v[172:175], v[108:111]
    s_waitcnt lgkmcnt(0)
    v_mfma_f32_16x16x32_bf16 v[112:115], v[44:47], v[160:163], v[112:115]
    v_mfma_f32_16x16x32_bf16 v[116:119], v[44:47], v[164:167], v[116:119]
    v_mfma_f32_16x16x32_bf16 v[120:123], v[44:47], v[168:171], v[120:123]
    v_mfma_f32_16x16x32_bf16 v[124:127], v[44:47], v[172:175], v[124:127]
    s_branch K2_part_out
K2_h_tailY:
    s_waitcnt vmcnt(16)
    ds_read_b64_tr_b16 v[32:33], v8 offset:12288
    ds_read_b64_tr_b16 v[34:35], v8 offset:13312
    ds_read_b64_tr_b16 v[36:37], v9 offset:12288
    ds_read_b64_tr_b16 v[38:39], v9 offset:13312
    ds_read_b64_tr_b16 v[40:41], v10 offset:12288
    ds_read_b64_tr_b16 v[42:43], v10 offset:13312
    ds_read_b64_tr_b16 v[44:45], v11 offset:12288
    ds_read_b64_tr_b16 v[46:47], v11 offset:13312
    s_waitcnt lgkmcnt(6)
    v_mfma_f32_16x16x32_bf16 v[64:67], v[32:35], v[176:179], v[64:67]
    v_mfma_f32_16x16x32_bf16 v[68:71], v[32:35], v[180:183], v[68:71]
    v_mfma_f32_16x16x32_bf16 v[72:75], v[32:35], v[184:187], v[72:75]
    v_mfma_f32_16x16x32_bf16 v[76:79], v[32:35], v[188:191], v[76:79]
    s_waitcnt lgkmcnt(4)
    v_mfma_f32_16x16x32_bf16 v[80:83], v[36:39], v[176:179], v[80:83]
    v_mfma_f32_16x16x32_bf16 v[84:87], v[36:39], v[180:183], v[84:87]
    v_mfma_f32_16x16x32_bf16 v[88:91], v[36:39], v[184:187], v[88:91]
    v_mfma_f32_16x16x32_bf16 v[92:95], v[36:39], v[188:191], v[92:95]
    s_waitcnt lgkmcnt(2)
    v_mfma_f32_16x16x32_bf16 v[96:99], v[40:43], v[176:179], v[96:99]
    v_mfma_f32_16x16x32_bf16 v[100:103], v[40:43], v[180:183], v[100:103]
    v_mfma_f32_16x16x32_bf16 v[104:107], v[40:43], v[184:187], v[104:107]
    v_mfma_f32_16x16x32_bf16 v[108:111], v[40:43], v[188:191], v[108:111]
    s_waitcnt lgkmcnt(0)
    v_mfma_f32_16x16x32_bf16 v[112:115], v[44:47], v[176:179], v[112:115]
    v_mfma_f32_16x16x32_bf16 v[116:119], v[44:47], v[180:183], v[116:119]
    v_mfma_f32_16x16x32_bf16 v[120:123], v[44:47], v[184:187], v[120:123]
    v_mfma_f32_16x16x32_bf16 v[124:127], v[44:47], v[188:191], v[124:127]
    s_waitcnt vmcnt(8)
    ds_read_b64_tr_b16 v[32:33], v8 offset:0
    ds_read_b64_tr_b16 v[34:35], v8 offset:1024
    ds_read_b64_tr_b16 v[36:37], v9 offset:0
    ds_read_b64_tr_b16 v[38:39], v9 offset:1024
    ds_read_b64_tr_b16 v[40:41], v10 offset:0
    ds_read_b64_tr_b16 v[42:43], v10 offset:1024
    ds_read_b64_tr_b16 v[44:45], v11 offset:0
    ds_read_b64_tr_b16 v[46:47], v11 offset:1024
    s_waitcnt lgkmcnt(6)
    v_mfma_f32_16x16x32_bf16 v[64:67], v[32:35], v[128:131], v[64:67]
    v_mfma_f32_16x16x32_bf16 v[68:71], v[32:35], v[132:135], v[68:71]
    v_mfma_f32_16x16x32_bf16 v[72:75], v[32:35], v[136:139], v[72:75]
    v_mfma_f32_16x16x32_bf16 v[76:79], v[32:35], v[140:143], v[76:79]
    s_waitcnt lgkmcnt(4)
    v_mfma_f32_16x16x32_bf16 v[80:83], v[36:39], v[128:131], v[80:83]
    v_mfma_f32_16x16x32_bf16 v[84:87], v[36:39], v[132:135], v[84:87]
    v_mfma_f32_16x16x32_bf16 v[88:91], v[36:39], v[136:139], v[88:91]
    v_mfma_f32_16x16x32_bf16 v[92:95], v[36:39], v[140:143], v[92:95]
    s_waitcnt lgkmcnt(2)
    v_mfma_f32_16x16x32_bf16 v[96:99], v[40:43], v[128:131], v[96:99]
    v_mfma_f32_16x16x32_bf16 v[100:103], v[40:43], v[132:135], v[100:103]
    v_mfma_f32_16x16x32_bf16 v[104:107], v[40:43], v[136:139], v[104:107]
    v_mfma_f32_16x16x32_bf16 v[108:111], v[40:43], v[140:143], v[108:111]
    s_waitcnt lgkmcnt(0)
    v_mfma_f32_16x16x32_bf16 v[112:115], v[44:47], v[128:131], v[112:115]
    v_mfma_f32_16x16x32_bf16 v[116:119], v[44:47], v[132:135], v[116:119]
    v_mfma_f32_16x16x32_bf16 v[120:123], v[44:47], v[136:139], v[120:123]
    v_mfma_f32_16x16x32_bf16 v[124:127], v[44:47], v[140:143], v[124:127]
    s_waitcnt vmcnt(0)
    ds_read_b64_tr_b16 v[32:33], v8 offset:4096
    ds_read_b64_tr_b16 v[34:35], v8 offset:5120
    ds_read_b64_tr_b16 v[36:37], v9 offset:4096
    ds_read_b64_tr_b16 v[38:39], v9 offset:5120
    ds_read_b64_tr_b16 v[40:41], v10 offset:4096
    ds_read_b64_tr_b16 v[42:43], v10 offset:5120
    ds_read_b64_tr_b16 v[44:45], v11 offset:4096
    ds_read_b64_tr_b16 v[46:47], v11 offset:5120
    s_waitcnt lgkmcnt(6)
    v_mfma_f32_16x16x32_bf16 v[64:67], v[32:35], v[144:147], v[64:67]
    v_mfma_f32_16x16x32_bf16 v[68:71], v[32:35], v[148:151], v[68:71]
    v_mfma_f32_16x16x32_bf16 v[72:75], v[32:35], v[152:155], v[72:75]
    v_mfma_f32_16x16x32_bf16 v[76:79], v[32:35], v[156:159], v[76:79]
    s_waitcnt lgkmcnt(4)
    v_mfma_f32_16x16x32_bf16 v[80:83], v[36:39], v[144:147], v[80:83]
    v_mfma_f32_16x16x32_bf16 v[84:87], v[36:39], v[148:151], v[84:87]
    v_mfma_f32_16x16x32_bf16 v[88:91], v[36:39], v[152:155], v[88:91]
    v_mfma_f32_16x16x32_bf16 v[92:95], v[36:39], v[156:159], v[92:95]
    s_waitcnt lgkmcnt(2)
    v_mfma_f32_16x16x32_bf16 v[96:99], v[40:43], v[144:147], v[96:99]
    v_mfma_f32_16x16x32_bf16 v[100:103], v[40:43], v[148:151], v[100:103]
    v_mfma_f32_16x16x32_bf16 v[104:107], v[40:43], v[152:155], v[104:107]
    v_mfma_f32_16x16x32_bf16 v[108:111], v[40:43], v[156:159], v[108:111]
    s_waitcnt lgkmcnt(0)
    v_mfma_f32_16x16x32_bf16 v[112:115], v[44:47], v[144:147], v[112:115]
    v_mfma_f32_16x16x32_bf16 v[116:119], v[44:47], v[148:151], v[116:119]
    v_mfma_f32_16x16x32_bf16 v[120:123], v[44:47], v[152:155], v[120:123]
    v_mfma_f32_16x16x32_bf16 v[124:127], v[44:47], v[156:159], v[124:127]
    s_branch K2_part_out
K2_opart:
    v_mov_b32 v64, 0
    v_mov_b32 v65, 0
    v_mov_b32 v66, 0
    v_mov_b32 v67, 0
    v_mov_b32 v68, 0
    v_mov_b32 v69, 0
    v_mov_b32 v70, 0
    v_mov_b32 v71, 0
    v_mov_b32 v72, 0
    v_mov_b32 v73, 0
    v_mov_b32 v74, 0
    v_mov_b32 v75, 0
    v_mov_b32 v76, 0
    v_mov_b32 v77, 0
    v_mov_b32 v78, 0
    v_mov_b32 v79, 0
    v_mov_b32 v80, 0
    v_mov_b32 v81, 0
    v_mov_b32 v82, 0
    v_mov_b32 v83, 0
    v_mov_b32 v84, 0
    v_mov_b32 v85, 0
    v_mov_b32 v86, 0
    v_mov_b32 v87, 0
    v_mov_b32 v88, 0
    v_mov_b32 v89, 0
    v_mov_b32 v90, 0
    v_mov_b32 v91, 0
    v_mov_b32 v92, 0
    v_mov_b32 v93, 0
    v_mov_b32 v94, 0
    v_mov_b32 v95, 0
    v_mov_b32 v96, 0
    v_mov_b32 v97, 0
    v_mov_b32 v98, 0
    v_mov_b32 v99, 0
    v_mov_b32 v100, 0
    v_mov_b32 v101, 0
    v_mov_b32 v102, 0
    v_mov_b32 v103, 0
    v_mov_b32 v104, 0
    v_mov_b32 v105, 0
    v_mov_b32 v106, 0
    v_mov_b32 v107, 0
    v_mov_b32 v108, 0
    v_mov_b32 v109, 0
    v_mov_b32 v110, 0
    v_mov_b32 v111, 0
    v_mov_b32 v112, 0
    v_mov_b32 v113, 0
    v_mov_b32 v114, 0
    v_mov_b32 v115, 0
    v_mov_b32 v116, 0
    v_mov_b32 v117, 0
    v_mov_b32 v118, 0
    v_mov_b32 v119, 0
    v_mov_b32 v120, 0
    v_mov_b32 v121, 0
    v_mov_b32 v122, 0
    v_mov_b32 v123, 0
    v_mov_b32 v124, 0
    v_mov_b32 v125, 0
    v_mov_b32 v126, 0
    v_mov_b32 v127, 0
    s_mov_b32 s24, s6
    s_mov_b32 s25, s7
    s_mov_b32 s26, 0x80000
    s_mov_b32 s27, 0x00020000
    s_add_u32 s32, s12, 0x200000
    s_addc_u32 s33, s13, 0
    s_mov_b32 s34, 0x400000
    s_mov_b32 s35, 0x00020000
    s_add_u32 s36, s12, 0xc00000
    s_addc_u32 s37, s13, 0
    s_mov_b32 s38, 0x11000
    s_mov_b32 s39, 0x00020000
    v_lshl_add_u32 v6, v13, 10, v6
    v_lshl_add_u32 v15, v3, 2, v16
    v_lshl_add_u32 v19, v15, 7, v19
    v_xor_b32 v15, 0, v18
    v_lshl_add_u32 v8, v15, 5, v19
    v_xor_b32 v15, 1, v18
    v_lshl_add_u32 v9, v15, 5, v19
    v_xor_b32 v15, 2, v18
    v_lshl_add_u32 v10, v15, 5, v19
    v_xor_b32 v15, 3, v18
    v_lshl_add_u32 v11, v15, 5, v19
    s_lshl_b32 s3, s14, 11
    v_lshlrev_b32 v15, 4, v1
    v_add_u32 v12, s3, v15
    v_add_u32 v13, 32768, v12
    v_add_u32 v14, 65536, v12
    v_add_u32 v15, 98304, v12
    v_lshlrev_b32 v20, 4, v2
    v_lshl_add_u32 v20, v3, 9, v20
    v_lshlrev_b32 v21, 5, v3
    s_lshr_b32 s43, s15, 7
    s_and_b32 s43, s43, 0
    s_mov_b32 s44, s43
    s_lshl_b32 s3, s43, 2
    s_add_u32 s3, s3, s17
    s_lshl_b32 s22, s3, 12
    s_lshl_b32 s23, s3, 8
    s_add_u32 s23, s23, 65536
    s_add_u32 s43, s43, 1
    s_and_b32 s43, s43, 3
    buffer_load_dwordx4 v[192:195], v20, s[36:39], s22 offen offset:0
    buffer_load_dwordx4 v[196:199], v20, s[36:39], s22 offen offset:256
    buffer_load_dwordx4 v[208:211], v21, s[36:39], s23 offen offset:0
    buffer_load_dwordx4 v[212:215], v21, s[36:39], s23 offen offset:16
    buffer_load_dwordx4 v[200:203], v20, s[36:39], s22 offen offset:2048
    buffer_load_dwordx4 v[204:207], v20, s[36:39], s22 offen offset:2304
    buffer_load_dwordx4 v[216:219], v21, s[36:39], s23 offen offset:128
    buffer_load_dwordx4 v[220:223], v21, s[36:39], s23 offen offset:144
    s_lshl_b32 s3, s44, 2
    s_add_u32 s3, s3, s17
    s_lshl_b32 s21, s3, 11
    s_lshl_b32 s40, s3, 15
    s_add_u32 s44, s44, 1
    s_and_b32 s44, s44, 3
    buffer_load_dwordx4 v[128:131], v12, s[32:35], s21 offen offset:0
    buffer_load_dwordx4 v[132:135], v13, s[32:35], s21 offen offset:0
    buffer_load_dwordx4 v[136:139], v14, s[32:35], s21 offen offset:0
    buffer_load_dwordx4 v[140:143], v15, s[32:35], s21 offen offset:0
    buffer_load_dwordx4 v[144:147], v12, s[32:35], s21 offen offset:1024
    buffer_load_dwordx4 v[148:151], v13, s[32:35], s21 offen offset:1024
    buffer_load_dwordx4 v[152:155], v14, s[32:35], s21 offen offset:1024
    buffer_load_dwordx4 v[156:159], v15, s[32:35], s21 offen offset:1024
    s_add_u32 s30, s40, 0
    s_add_u32 m0, s20, 0
    s_nop 0
    buffer_load_dwordx4 v6, s[24:27], s30 offen lds
    s_add_u32 s30, s40, 8192
    s_add_u32 m0, s20, 1024
    s_nop 0
    buffer_load_dwordx4 v6, s[24:27], s30 offen lds
    s_add_u32 s30, s40, 16384
    s_add_u32 m0, s20, 2048
    s_nop 0
    buffer_load_dwordx4 v6, s[24:27], s30 offen lds
    s_add_u32 s30, s40, 24576
    s_add_u32 m0, s20, 3072
    s_nop 0
    buffer_load_dwordx4 v6, s[24:27], s30 offen lds
    s_waitcnt vmcnt(0)
    ds_read_b64_tr_b16 v[32:33], v8 offset:0
    ds_read_b64_tr_b16 v[34:35], v8 offset:2048
    ds_read_b64_tr_b16 v[36:37], v9 offset:0
    ds_read_b64_tr_b16 v[38:39], v9 offset:2048
    ds_read_b64_tr_b16 v[40:41], v10 offset:0
    ds_read_b64_tr_b16 v[42:43], v10 offset:2048
    ds_read_b64_tr_b16 v[44:45], v11 offset:0
    ds_read_b64_tr_b16 v[46:47], v11 offset:2048
    v_cvt_pk_bf16_f32 v224, v192, v193
    v_cvt_pk_bf16_f32 v225, v194, v195
    v_cvt_pk_bf16_f32 v226, v196, v197
    v_cvt_pk_bf16_f32 v227, v198, v199
    v_cvt_pk_bf16_f32 v228, v208, v209
    v_cvt_pk_bf16_f32 v229, v210, v211
    v_cvt_pk_bf16_f32 v230, v212, v213
    v_cvt_pk_bf16_f32 v231, v214, v215
    v_cvt_pk_bf16_f32 v232, v200, v201
    v_cvt_pk_bf16_f32 v233, v202, v203
    v_cvt_pk_bf16_f32 v234, v204, v205
    v_cvt_pk_bf16_f32 v235, v206, v207
    v_cvt_pk_bf16_f32 v236, v216, v217
    v_cvt_pk_bf16_f32 v237, v218, v219
    v_cvt_pk_bf16_f32 v238, v220, v221
    v_cvt_pk_bf16_f32 v239, v222, v223
    s_lshl_b32 s3, s44, 2
    s_add_u32 s3, s3, s17
    s_lshl_b32 s21, s3, 11
    s_lshl_b32 s40, s3, 15
    s_add_u32 s44, s44, 1
    s_and_b32 s44, s44, 3
    buffer_load_dwordx4 v[160:163], v12, s[32:35], s21 offen offset:0
    buffer_load_dwordx4 v[164:167], v13, s[32:35], s21 offen offset:0
    buffer_load_dwordx4 v[168:171], v14, s[32:35], s21 offen offset:0
    buffer_load_dwordx4 v[172:175], v15, s[32:35], s21 offen offset:0
    buffer_load_dwordx4 v[176:179], v12, s[32:35], s21 offen offset:1024
    buffer_load_dwordx4 v[180:183], v13, s[32:35], s21 offen offset:1024
    buffer_load_dwordx4 v[184:187], v14, s[32:35], s21 offen offset:1024
    buffer_load_dwordx4 v[188:191], v15, s[32:35], s21 offen offset:1024
    s_add_u32 s30, s40, 0
    s_add_u32 m0, s20, 4096
    s_nop 0
    buffer_load_dwordx4 v6, s[24:27], s30 offen lds
    s_add_u32 s30, s40, 8192
    s_add_u32 m0, s20, 5120
    s_nop 0
    buffer_load_dwordx4 v6, s[24:27], s30 offen lds
    s_add_u32 s30, s40, 16384
    s_add_u32 m0, s20, 6144
    s_nop 0
    buffer_load_dwordx4 v6, s[24:27], s30 offen lds
    s_add_u32 s30, s40, 24576
    s_add_u32 m0, s20, 7168
    s_nop 0
    buffer_load_dwordx4 v6, s[24:27], s30 offen lds
    s_lshl_b32 s3, s43, 2
    s_add_u32 s3, s3, s17
    s_lshl_b32 s22, s3, 12
    s_lshl_b32 s23, s3, 8
    s_add_u32 s23, s23, 65536
    s_add_u32 s43, s43, 1
    s_and_b32 s43, s43, 3
    buffer_load_dwordx4 v[192:195], v20, s[36:39], s22 offen offset:0
    buffer_load_dwordx4 v[196:199], v20, s[36:39], s22 offen offset:256
    buffer_load_dwordx4 v[208:211], v21, s[36:39], s23 offen offset:0
    buffer_load_dwordx4 v[212:215], v21, s[36:39], s23 offen offset:16
    buffer_load_dwordx4 v[200:203], v20, s[36:39], s22 offen offset:2048
    buffer_load_dwordx4 v[204:207], v20, s[36:39], s22 offen offset:2304
    buffer_load_dwordx4 v[216:219], v21, s[36:39], s23 offen offset:128
    buffer_load_dwordx4 v[220:223], v21, s[36:39], s23 offen offset:144
    v_mfma_f32_16x16x32_bf16 v[240:243], v[224:227], v[128:131], 0
    v_mfma_f32_16x16x32_bf16 v[244:247], v[224:227], v[132:135], 0
    v_mfma_f32_16x16x32_bf16 v[248:251], v[224:227], v[136:139], 0
    v_mfma_f32_16x16x32_bf16 v[252:255], v[224:227], v[140:143], 0
    v_mfma_f32_16x16x32_bf16 v[24:27], v[228:231], v[128:131], 0
    s_nop 7
    v_cvt_pk_bf16_f32 v24, v24, v24
    v_lshlrev_b32 v24, 16, v24
    v_add_f32 v24, 0x358637bd, v24
    v_cvt_pk_bf16_f32 v24, v24, v24
    v_lshlrev_b32 v24, 16, v24
    v_rcp_f32 v24, v24
    v_cvt_pk_bf16_f32 v25, v240, v241
    v_cvt_pk_bf16_f32 v26, v242, v243
    v_lshlrev_b32 v240, 16, v25
    v_and_b32 v241, 0xffff0000, v25
    v_lshlrev_b32 v242, 16, v26
    v_and_b32 v243, 0xffff0000, v26
    v_mul_f32 v240, v240, v24
    v_mul_f32 v241, v241, v24
    v_mul_f32 v242, v242, v24
    v_mul_f32 v243, v243, v24
    v_cvt_pk_bf16_f32 v48, v240, v241
    v_cvt_pk_bf16_f32 v49, v242, v243
    v_mfma_f32_16x16x32_bf16 v[28:31], v[228:231], v[132:135], 0
    s_nop 7
    v_cvt_pk_bf16_f32 v28, v28, v28
    v_lshlrev_b32 v28, 16, v28
    v_add_f32 v28, 0x358637bd, v28
    v_cvt_pk_bf16_f32 v28, v28, v28
    v_lshlrev_b32 v28, 16, v28
    v_rcp_f32 v28, v28
    v_cvt_pk_bf16_f32 v29, v244, v245
    v_cvt_pk_bf16_f32 v30, v246, v247
    v_lshlrev_b32 v244, 16, v29
    v_and_b32 v245, 0xffff0000, v29
    v_lshlrev_b32 v246, 16, v30
    v_and_b32 v247, 0xffff0000, v30
    v_mul_f32 v244, v244, v28
    v_mul_f32 v245, v245, v28
    v_mul_f32 v246, v246, v28
    v_mul_f32 v247, v247, v28
    v_cvt_pk_bf16_f32 v52, v244, v245
    v_cvt_pk_bf16_f32 v53, v246, v247
    v_mfma_f32_16x16x32_bf16 v[24:27], v[228:231], v[136:139], 0
    s_nop 7
    v_cvt_pk_bf16_f32 v24, v24, v24
    v_lshlrev_b32 v24, 16, v24
    v_add_f32 v24, 0x358637bd, v24
    v_cvt_pk_bf16_f32 v24, v24, v24
    v_lshlrev_b32 v24, 16, v24
    v_rcp_f32 v24, v24
    v_cvt_pk_bf16_f32 v25, v248, v249
    v_cvt_pk_bf16_f32 v26, v250, v251
    v_lshlrev_b32 v248, 16, v25
    v_and_b32 v249, 0xffff0000, v25
    v_lshlrev_b32 v250, 16, v26
    v_and_b32 v251, 0xffff0000, v26
    v_mul_f32 v248, v248, v24
    v_mul_f32 v249, v249, v24
    v_mul_f32 v250, v250, v24
    v_mul_f32 v251, v251, v24
    v_cvt_pk_bf16_f32 v56, v248, v249
    v_cvt_pk_bf16_f32 v57, v250, v251
    v_mfma_f32_16x16x32_bf16 v[28:31], v[228:231], v[140:143], 0
    s_nop 7
    v_cvt_pk_bf16_f32 v28, v28, v28
    v_lshlrev_b32 v28, 16, v28
    v_add_f32 v28, 0x358637bd, v28
    v_cvt_pk_bf16_f32 v28, v28, v28
    v_lshlrev_b32 v28, 16, v28
    v_rcp_f32 v28, v28
    v_cvt_pk_bf16_f32 v29, v252, v253
    v_cvt_pk_bf16_f32 v30, v254, v255
    v_lshlrev_b32 v252, 16, v29
    v_and_b32 v253, 0xffff0000, v29
    v_lshlrev_b32 v254, 16, v30
    v_and_b32 v255, 0xffff0000, v30
    v_mul_f32 v252, v252, v28
    v_mul_f32 v253, v253, v28
    v_mul_f32 v254, v254, v28
    v_mul_f32 v255, v255, v28
    v_cvt_pk_bf16_f32 v60, v252, v253
    v_cvt_pk_bf16_f32 v61, v254, v255
    v_mfma_f32_16x16x32_bf16 v[240:243], v[232:235], v[144:147], 0
    v_mfma_f32_16x16x32_bf16 v[244:247], v[232:235], v[148:151], 0
    v_mfma_f32_16x16x32_bf16 v[248:251], v[232:235], v[152:155], 0
    v_mfma_f32_16x16x32_bf16 v[252:255], v[232:235], v[156:159], 0
    v_mfma_f32_16x16x32_bf16 v[24:27], v[236:239], v[144:147], 0
    s_nop 7
    v_cvt_pk_bf16_f32 v24, v24, v24
    v_lshlrev_b32 v24, 16, v24
    v_add_f32 v24, 0x358637bd, v24
    v_cvt_pk_bf16_f32 v24, v24, v24
    v_lshlrev_b32 v24, 16, v24
    v_rcp_f32 v24, v24
    v_cvt_pk_bf16_f32 v25, v240, v241
    v_cvt_pk_bf16_f32 v26, v242, v243
    v_lshlrev_b32 v240, 16, v25
    v_and_b32 v241, 0xffff0000, v25
    v_lshlrev_b32 v242, 16, v26
    v_and_b32 v243, 0xffff0000, v26
    v_mul_f32 v240, v240, v24
    v_mul_f32 v241, v241, v24
    v_mul_f32 v242, v242, v24
    v_mul_f32 v243, v243, v24
    v_cvt_pk_bf16_f32 v50, v240, v241
    v_cvt_pk_bf16_f32 v51, v242, v243
    v_mfma_f32_16x16x32_bf16 v[28:31], v[236:239], v[148:151], 0
    s_nop 7
    v_cvt_pk_bf16_f32 v28, v28, v28
    v_lshlrev_b32 v28, 16, v28
    v_add_f32 v28, 0x358637bd, v28
    v_cvt_pk_bf16_f32 v28, v28, v28
    v_lshlrev_b32 v28, 16, v28
    v_rcp_f32 v28, v28
    v_cvt_pk_bf16_f32 v29, v244, v245
    v_cvt_pk_bf16_f32 v30, v246, v247
    v_lshlrev_b32 v244, 16, v29
    v_and_b32 v245, 0xffff0000, v29
    v_lshlrev_b32 v246, 16, v30
    v_and_b32 v247, 0xffff0000, v30
    v_mul_f32 v244, v244, v28
    v_mul_f32 v245, v245, v28
    v_mul_f32 v246, v246, v28
    v_mul_f32 v247, v247, v28
    v_cvt_pk_bf16_f32 v54, v244, v245
    v_cvt_pk_bf16_f32 v55, v246, v247
    v_mfma_f32_16x16x32_bf16 v[24:27], v[236:239], v[152:155], 0
    s_nop 7
    v_cvt_pk_bf16_f32 v24, v24, v24
    v_lshlrev_b32 v24, 16, v24
    v_add_f32 v24, 0x358637bd, v24
    v_cvt_pk_bf16_f32 v24, v24, v24
    v_lshlrev_b32 v24, 16, v24
    v_rcp_f32 v24, v24
    v_cvt_pk_bf16_f32 v25, v248, v249
    v_cvt_pk_bf16_f32 v26, v250, v251
    v_lshlrev_b32 v248, 16, v25
    v_and_b32 v249, 0xffff0000, v25
    v_lshlrev_b32 v250, 16, v26
    v_and_b32 v251, 0xffff0000, v26
    v_mul_f32 v248, v248, v24
    v_mul_f32 v249, v249, v24
    v_mul_f32 v250, v250, v24
    v_mul_f32 v251, v251, v24
    v_cvt_pk_bf16_f32 v58, v248, v249
    v_cvt_pk_bf16_f32 v59, v250, v251
    v_mfma_f32_16x16x32_bf16 v[28:31], v[236:239], v[156:159], 0
    s_nop 7
    v_cvt_pk_bf16_f32 v28, v28, v28
    v_lshlrev_b32 v28, 16, v28
    v_add_f32 v28, 0x358637bd, v28
    v_cvt_pk_bf16_f32 v28, v28, v28
    v_lshlrev_b32 v28, 16, v28
    v_rcp_f32 v28, v28
    v_cvt_pk_bf16_f32 v29, v252, v253
    v_cvt_pk_bf16_f32 v30, v254, v255
    v_lshlrev_b32 v252, 16, v29
    v_and_b32 v253, 0xffff0000, v29
    v_lshlrev_b32 v254, 16, v30
    v_and_b32 v255, 0xffff0000, v30
    v_mul_f32 v252, v252, v28
    v_mul_f32 v253, v253, v28
    v_mul_f32 v254, v254, v28
    v_mul_f32 v255, v255, v28
    v_cvt_pk_bf16_f32 v62, v252, v253
    v_cvt_pk_bf16_f32 v63, v254, v255
    s_waitcnt lgkmcnt(0)
    v_mfma_f32_16x16x32_bf16 v[64:67], v[32:35], v[48:51], v[64:67]
    v_mfma_f32_16x16x32_bf16 v[68:71], v[32:35], v[52:55], v[68:71]
    v_mfma_f32_16x16x32_bf16 v[72:75], v[32:35], v[56:59], v[72:75]
    v_mfma_f32_16x16x32_bf16 v[76:79], v[32:35], v[60:63], v[76:79]
    v_mfma_f32_16x16x32_bf16 v[80:83], v[36:39], v[48:51], v[80:83]
    v_mfma_f32_16x16x32_bf16 v[84:87], v[36:39], v[52:55], v[84:87]
    v_mfma_f32_16x16x32_bf16 v[88:91], v[36:39], v[56:59], v[88:91]
    v_mfma_f32_16x16x32_bf16 v[92:95], v[36:39], v[60:63], v[92:95]
    v_mfma_f32_16x16x32_bf16 v[96:99], v[40:43], v[48:51], v[96:99]
    v_mfma_f32_16x16x32_bf16 v[100:103], v[40:43], v[52:55], v[100:103]
    v_mfma_f32_16x16x32_bf16 v[104:107], v[40:43], v[56:59], v[104:107]
    v_mfma_f32_16x16x32_bf16 v[108:111], v[40:43], v[60:63], v[108:111]
    v_mfma_f32_16x16x32_bf16 v[112:115], v[44:47], v[48:51], v[112:115]
    v_mfma_f32_16x16x32_bf16 v[116:119], v[44:47], v[52:55], v[116:119]
    v_mfma_f32_16x16x32_bf16 v[120:123], v[44:47], v[56:59], v[120:123]
    v_mfma_f32_16x16x32_bf16 v[124:127], v[44:47], v[60:63], v[124:127]
    s_lshl_b32 s3, s44, 2
    s_add_u32 s3, s3, s17
    s_lshl_b32 s21, s3, 11
    s_lshl_b32 s40, s3, 15
    s_add_u32 s44, s44, 1
    s_and_b32 s44, s44, 3
    buffer_load_dwordx4 v[128:131], v12, s[32:35], s21 offen offset:0
    buffer_load_dwordx4 v[132:135], v13, s[32:35], s21 offen offset:0
    buffer_load_dwordx4 v[136:139], v14, s[32:35], s21 offen offset:0
    buffer_load_dwordx4 v[140:143], v15, s[32:35], s21 offen offset:0
    buffer_load_dwordx4 v[144:147], v12, s[32:35], s21 offen offset:1024
    buffer_load_dwordx4 v[148:151], v13, s[32:35], s21 offen offset:1024
    buffer_load_dwordx4 v[152:155], v14, s[32:35], s21 offen offset:1024
    buffer_load_dwordx4 v[156:159], v15, s[32:35], s21 offen offset:1024
    s_add_u32 s30, s40, 0
    s_add_u32 m0, s20, 8192
    s_nop 0
    buffer_load_dwordx4 v6, s[24:27], s30 offen lds
    s_add_u32 s30, s40, 8192
    s_add_u32 m0, s20, 9216
    s_nop 0
    buffer_load_dwordx4 v6, s[24:27], s30 offen lds
    s_add_u32 s30, s40, 16384
    s_add_u32 m0, s20, 10240
    s_nop 0
    buffer_load_dwordx4 v6, s[24:27], s30 offen lds
    s_add_u32 s30, s40, 24576
    s_add_u32 m0, s20, 11264
    s_nop 0
    buffer_load_dwordx4 v6, s[24:27], s30 offen lds
    s_waitcnt vmcnt(12)
    ds_read_b64_tr_b16 v[32:33], v8 offset:4096
    ds_read_b64_tr_b16 v[34:35], v8 offset:6144
    ds_read_b64_tr_b16 v[36:37], v9 offset:4096
    ds_read_b64_tr_b16 v[38:39], v9 offset:6144
    ds_read_b64_tr_b16 v[40:41], v10 offset:4096
    ds_read_b64_tr_b16 v[42:43], v10 offset:6144
    ds_read_b64_tr_b16 v[44:45], v11 offset:4096
    ds_read_b64_tr_b16 v[46:47], v11 offset:6144
    v_cvt_pk_bf16_f32 v224, v192, v193
    v_cvt_pk_bf16_f32 v225, v194, v195
    v_cvt_pk_bf16_f32 v226, v196, v197
    v_cvt_pk_bf16_f32 v227, v198, v199
    v_cvt_pk_bf16_f32 v228, v208, v209
    v_cvt_pk_bf16_f32 v229, v210, v211
    v_cvt_pk_bf16_f32 v230, v212, v213
    v_cvt_pk_bf16_f32 v231, v214, v215
    v_cvt_pk_bf16_f32 v232, v200, v201
    v_cvt_pk_bf16_f32 v233, v202, v203
    v_cvt_pk_bf16_f32 v234, v204, v205
    v_cvt_pk_bf16_f32 v235, v206, v207
    v_cvt_pk_bf16_f32 v236, v216, v217
    v_cvt_pk_bf16_f32 v237, v218, v219
    v_cvt_pk_bf16_f32 v238, v220, v221
    v_cvt_pk_bf16_f32 v239, v222, v223
    s_lshl_b32 s3, s43, 2
    s_add_u32 s3, s3, s17
    s_lshl_b32 s22, s3, 12
    s_lshl_b32 s23, s3, 8
    s_add_u32 s23, s23, 65536
    s_add_u32 s43, s43, 1
    s_and_b32 s43, s43, 3
    buffer_load_dwordx4 v[192:195], v20, s[36:39], s22 offen offset:0
    buffer_load_dwordx4 v[196:199], v20, s[36:39], s22 offen offset:256
    buffer_load_dwordx4 v[208:211], v21, s[36:39], s23 offen offset:0
    buffer_load_dwordx4 v[212:215], v21, s[36:39], s23 offen offset:16
    buffer_load_dwordx4 v[200:203], v20, s[36:39], s22 offen offset:2048
    buffer_load_dwordx4 v[204:207], v20, s[36:39], s22 offen offset:2304
    buffer_load_dwordx4 v[216:219], v21, s[36:39], s23 offen offset:128
    buffer_load_dwordx4 v[220:223], v21, s[36:39], s23 offen offset:144
    v_mfma_f32_16x16x32_bf16 v[240:243], v[224:227], v[160:163], 0
    v_mfma_f32_16x16x32_bf16 v[244:247], v[224:227], v[164:167], 0
    v_mfma_f32_16x16x32_bf16 v[248:251], v[224:227], v[168:171], 0
    v_mfma_f32_16x16x32_bf16 v[252:255], v[224:227], v[172:175], 0
    v_mfma_f32_16x16x32_bf16 v[24:27], v[228:231], v[160:163], 0
    s_nop 7
    v_cvt_pk_bf16_f32 v24, v24, v24
    v_lshlrev_b32 v24, 16, v24
    v_add_f32 v24, 0x358637bd, v24
    v_cvt_pk_bf16_f32 v24, v24, v24
    v_lshlrev_b32 v24, 16, v24
    v_rcp_f32 v24, v24
    v_cvt_pk_bf16_f32 v25, v240, v241
    v_cvt_pk_bf16_f32 v26, v242, v243
    v_lshlrev_b32 v240, 16, v25
    v_and_b32 v241, 0xffff0000, v25
    v_lshlrev_b32 v242, 16, v26
    v_and_b32 v243, 0xffff0000, v26
    v_mul_f32 v240, v240, v24
    v_mul_f32 v241, v241, v24
    v_mul_f32 v242, v242, v24
    v_mul_f32 v243, v243, v24
    v_cvt_pk_bf16_f32 v48, v240, v241
    v_cvt_pk_bf16_f32 v49, v242, v243
    v_mfma_f32_16x16x32_bf16 v[28:31], v[228:231], v[164:167], 0
    s_nop 7
    v_cvt_pk_bf16_f32 v28, v28, v28
    v_lshlrev_b32 v28, 16, v28
    v_add_f32 v28, 0x358637bd, v28
    v_cvt_pk_bf16_f32 v28, v28, v28
    v_lshlrev_b32 v28, 16, v28
    v_rcp_f32 v28, v28
    v_cvt_pk_bf16_f32 v29, v244, v245
    v_cvt_pk_bf16_f32 v30, v246, v247
    v_lshlrev_b32 v244, 16, v29
    v_and_b32 v245, 0xffff0000, v29
    v_lshlrev_b32 v246, 16, v30
    v_and_b32 v247, 0xffff0000, v30
    v_mul_f32 v244, v244, v28
    v_mul_f32 v245, v245, v28
    v_mul_f32 v246, v246, v28
    v_mul_f32 v247, v247, v28
    v_cvt_pk_bf16_f32 v52, v244, v245
    v_cvt_pk_bf16_f32 v53, v246, v247
    v_mfma_f32_16x16x32_bf16 v[24:27], v[228:231], v[168:171], 0
    s_nop 7
    v_cvt_pk_bf16_f32 v24, v24, v24
    v_lshlrev_b32 v24, 16, v24
    v_add_f32 v24, 0x358637bd, v24
    v_cvt_pk_bf16_f32 v24, v24, v24
    v_lshlrev_b32 v24, 16, v24
    v_rcp_f32 v24, v24
    v_cvt_pk_bf16_f32 v25, v248, v249
    v_cvt_pk_bf16_f32 v26, v250, v251
    v_lshlrev_b32 v248, 16, v25
    v_and_b32 v249, 0xffff0000, v25
    v_lshlrev_b32 v250, 16, v26
    v_and_b32 v251, 0xffff0000, v26
    v_mul_f32 v248, v248, v24
    v_mul_f32 v249, v249, v24
    v_mul_f32 v250, v250, v24
    v_mul_f32 v251, v251, v24
    v_cvt_pk_bf16_f32 v56, v248, v249
    v_cvt_pk_bf16_f32 v57, v250, v251
    v_mfma_f32_16x16x32_bf16 v[28:31], v[228:231], v[172:175], 0
    s_nop 7
    v_cvt_pk_bf16_f32 v28, v28, v28
    v_lshlrev_b32 v28, 16, v28
    v_add_f32 v28, 0x358637bd, v28
    v_cvt_pk_bf16_f32 v28, v28, v28
    v_lshlrev_b32 v28, 16, v28
    v_rcp_f32 v28, v28
    v_cvt_pk_bf16_f32 v29, v252, v253
    v_cvt_pk_bf16_f32 v30, v254, v255
    v_lshlrev_b32 v252, 16, v29
    v_and_b32 v253, 0xffff0000, v29
    v_lshlrev_b32 v254, 16, v30
    v_and_b32 v255, 0xffff0000, v30
    v_mul_f32 v252, v252, v28
    v_mul_f32 v253, v253, v28
    v_mul_f32 v254, v254, v28
    v_mul_f32 v255, v255, v28
    v_cvt_pk_bf16_f32 v60, v252, v253
    v_cvt_pk_bf16_f32 v61, v254, v255
    v_mfma_f32_16x16x32_bf16 v[240:243], v[232:235], v[176:179], 0
    v_mfma_f32_16x16x32_bf16 v[244:247], v[232:235], v[180:183], 0
    v_mfma_f32_16x16x32_bf16 v[248:251], v[232:235], v[184:187], 0
    v_mfma_f32_16x16x32_bf16 v[252:255], v[232:235], v[188:191], 0
    v_mfma_f32_16x16x32_bf16 v[24:27], v[236:239], v[176:179], 0
    s_nop 7
    v_cvt_pk_bf16_f32 v24, v24, v24
    v_lshlrev_b32 v24, 16, v24
    v_add_f32 v24, 0x358637bd, v24
    v_cvt_pk_bf16_f32 v24, v24, v24
    v_lshlrev_b32 v24, 16, v24
    v_rcp_f32 v24, v24
    v_cvt_pk_bf16_f32 v25, v240, v241
    v_cvt_pk_bf16_f32 v26, v242, v243
    v_lshlrev_b32 v240, 16, v25
    v_and_b32 v241, 0xffff0000, v25
    v_lshlrev_b32 v242, 16, v26
    v_and_b32 v243, 0xffff0000, v26
    v_mul_f32 v240, v240, v24
    v_mul_f32 v241, v241, v24
    v_mul_f32 v242, v242, v24
    v_mul_f32 v243, v243, v24
    v_cvt_pk_bf16_f32 v50, v240, v241
    v_cvt_pk_bf16_f32 v51, v242, v243
    v_mfma_f32_16x16x32_bf16 v[28:31], v[236:239], v[180:183], 0
    s_nop 7
    v_cvt_pk_bf16_f32 v28, v28, v28
    v_lshlrev_b32 v28, 16, v28
    v_add_f32 v28, 0x358637bd, v28
    v_cvt_pk_bf16_f32 v28, v28, v28
    v_lshlrev_b32 v28, 16, v28
    v_rcp_f32 v28, v28
    v_cvt_pk_bf16_f32 v29, v244, v245
    v_cvt_pk_bf16_f32 v30, v246, v247
    v_lshlrev_b32 v244, 16, v29
    v_and_b32 v245, 0xffff0000, v29
    v_lshlrev_b32 v246, 16, v30
    v_and_b32 v247, 0xffff0000, v30
    v_mul_f32 v244, v244, v28
    v_mul_f32 v245, v245, v28
    v_mul_f32 v246, v246, v28
    v_mul_f32 v247, v247, v28
    v_cvt_pk_bf16_f32 v54, v244, v245
    v_cvt_pk_bf16_f32 v55, v246, v247
    v_mfma_f32_16x16x32_bf16 v[24:27], v[236:239], v[184:187], 0
    s_nop 7
    v_cvt_pk_bf16_f32 v24, v24, v24
    v_lshlrev_b32 v24, 16, v24
    v_add_f32 v24, 0x358637bd, v24
    v_cvt_pk_bf16_f32 v24, v24, v24
    v_lshlrev_b32 v24, 16, v24
    v_rcp_f32 v24, v24
    v_cvt_pk_bf16_f32 v25, v248, v249
    v_cvt_pk_bf16_f32 v26, v250, v251
    v_lshlrev_b32 v248, 16, v25
    v_and_b32 v249, 0xffff0000, v25
    v_lshlrev_b32 v250, 16, v26
    v_and_b32 v251, 0xffff0000, v26
    v_mul_f32 v248, v248, v24
    v_mul_f32 v249, v249, v24
    v_mul_f32 v250, v250, v24
    v_mul_f32 v251, v251, v24
    v_cvt_pk_bf16_f32 v58, v248, v249
    v_cvt_pk_bf16_f32 v59, v250, v251
    v_mfma_f32_16x16x32_bf16 v[28:31], v[236:239], v[188:191], 0
    s_nop 7
    v_cvt_pk_bf16_f32 v28, v28, v28
    v_lshlrev_b32 v28, 16, v28
    v_add_f32 v28, 0x358637bd, v28
    v_cvt_pk_bf16_f32 v28, v28, v28
    v_lshlrev_b32 v28, 16, v28
    v_rcp_f32 v28, v28
    v_cvt_pk_bf16_f32 v29, v252, v253
    v_cvt_pk_bf16_f32 v30, v254, v255
    v_lshlrev_b32 v252, 16, v29
    v_and_b32 v253, 0xffff0000, v29
    v_lshlrev_b32 v254, 16, v30
    v_and_b32 v255, 0xffff0000, v30
    v_mul_f32 v252, v252, v28
    v_mul_f32 v253, v253, v28
    v_mul_f32 v254, v254, v28
    v_mul_f32 v255, v255, v28
    v_cvt_pk_bf16_f32 v62, v252, v253
    v_cvt_pk_bf16_f32 v63, v254, v255
    s_waitcnt lgkmcnt(0)
    v_mfma_f32_16x16x32_bf16 v[64:67], v[32:35], v[48:51], v[64:67]
    v_mfma_f32_16x16x32_bf16 v[68:71], v[32:35], v[52:55], v[68:71]
    v_mfma_f32_16x16x32_bf16 v[72:75], v[32:35], v[56:59], v[72:75]
    v_mfma_f32_16x16x32_bf16 v[76:79], v[32:35], v[60:63], v[76:79]
    v_mfma_f32_16x16x32_bf16 v[80:83], v[36:39], v[48:51], v[80:83]
    v_mfma_f32_16x16x32_bf16 v[84:87], v[36:39], v[52:55], v[84:87]
    v_mfma_f32_16x16x32_bf16 v[88:91], v[36:39], v[56:59], v[88:91]
    v_mfma_f32_16x16x32_bf16 v[92:95], v[36:39], v[60:63], v[92:95]
    v_mfma_f32_16x16x32_bf16 v[96:99], v[40:43], v[48:51], v[96:99]
    v_mfma_f32_16x16x32_bf16 v[100:103], v[40:43], v[52:55], v[100:103]
    v_mfma_f32_16x16x32_bf16 v[104:107], v[40:43], v[56:59], v[104:107]
    v_mfma_f32_16x16x32_bf16 v[108:111], v[40:43], v[60:63], v[108:111]
    v_mfma_f32_16x16x32_bf16 v[112:115], v[44:47], v[48:51], v[112:115]
    v_mfma_f32_16x16x32_bf16 v[116:119], v[44:47], v[52:55], v[116:119]
    v_mfma_f32_16x16x32_bf16 v[120:123], v[44:47], v[56:59], v[120:123]
    v_mfma_f32_16x16x32_bf16 v[124:127], v[44:47], v[60:63], v[124:127]
    s_lshl_b32 s3, s44, 2
    s_add_u32 s3, s3, s17
    s_lshl_b32 s21, s3, 11
    s_lshl_b32 s40, s3, 15
    s_add_u32 s44, s44, 1
    s_and_b32 s44, s44, 3
    buffer_load_dwordx4 v[160:163], v12, s[32:35], s21 offen offset:0
    buffer_load_dwordx4 v[164:167], v13, s[32:35], s21 offen offset:0
    buffer_load_dwordx4 v[168:171], v14, s[32:35], s21 offen offset:0
    buffer_load_dwordx4 v[172:175], v15, s[32:35], s21 offen offset:0
    buffer_load_dwordx4 v[176:179], v12, s[32:35], s21 offen offset:1024
    buffer_load_dwordx4 v[180:183], v13, s[32:35], s21 offen offset:1024
    buffer_load_dwordx4 v[184:187], v14, s[32:35], s21 offen offset:1024
    buffer_load_dwordx4 v[188:191], v15, s[32:35], s21 offen offset:1024
    s_add_u32 s30, s40, 0
    s_add_u32 m0, s20, 12288
    s_nop 0
    buffer_load_dwordx4 v6, s[24:27], s30 offen lds
    s_add_u32 s30, s40, 8192
    s_add_u32 m0, s20, 13312
    s_nop 0
    buffer_load_dwordx4 v6, s[24:27], s30 offen lds
    s_add_u32 s30, s40, 16384
    s_add_u32 m0, s20, 14336
    s_nop 0
    buffer_load_dwordx4 v6, s[24:27], s30 offen lds
    s_add_u32 s30, s40, 24576
    s_add_u32 m0, s20, 15360
    s_nop 0
    buffer_load_dwordx4 v6, s[24:27], s30 offen lds
    s_waitcnt vmcnt(12)
    ds_read_b64_tr_b16 v[32:33], v8 offset:8192
    ds_read_b64_tr_b16 v[34:35], v8 offset:10240
    ds_read_b64_tr_b16 v[36:37], v9 offset:8192
    ds_read_b64_tr_b16 v[38:39], v9 offset:10240
    ds_read_b64_tr_b16 v[40:41], v10 offset:8192
    ds_read_b64_tr_b16 v[42:43], v10 offset:10240
    ds_read_b64_tr_b16 v[44:45], v11 offset:8192
    ds_read_b64_tr_b16 v[46:47], v11 offset:10240
    v_cvt_pk_bf16_f32 v224, v192, v193
    v_cvt_pk_bf16_f32 v225, v194, v195
    v_cvt_pk_bf16_f32 v226, v196, v197
    v_cvt_pk_bf16_f32 v227, v198, v199
    v_cvt_pk_bf16_f32 v228, v208, v209
    v_cvt_pk_bf16_f32 v229, v210, v211
    v_cvt_pk_bf16_f32 v230, v212, v213
    v_cvt_pk_bf16_f32 v231, v214, v215
    v_cvt_pk_bf16_f32 v232, v200, v201
    v_cvt_pk_bf16_f32 v233, v202, v203
    v_cvt_pk_bf16_f32 v234, v204, v205
    v_cvt_pk_bf16_f32 v235, v206, v207
    v_cvt_pk_bf16_f32 v236, v216, v217
    v_cvt_pk_bf16_f32 v237, v218, v219
    v_cvt_pk_bf16_f32 v238, v220, v221
    v_cvt_pk_bf16_f32 v239, v222, v223
    s_lshl_b32 s3, s43, 2
    s_add_u32 s3, s3, s17
    s_lshl_b32 s22, s3, 12
    s_lshl_b32 s23, s3, 8
    s_add_u32 s23, s23, 65536
    s_add_u32 s43, s43, 1
    s_and_b32 s43, s43, 3
    buffer_load_dwordx4 v[192:195], v20, s[36:39], s22 offen offset:0
    buffer_load_dwordx4 v[196:199], v20, s[36:39], s22 offen offset:256
    buffer_load_dwordx4 v[208:211], v21, s[36:39], s23 offen offset:0
    buffer_load_dwordx4 v[212:215], v21, s[36:39], s23 offen offset:16
    buffer_load_dwordx4 v[200:203], v20, s[36:39], s22 offen offset:2048
    buffer_load_dwordx4 v[204:207], v20, s[36:39], s22 offen offset:2304
    buffer_load_dwordx4 v[216:219], v21, s[36:39], s23 offen offset:128
    buffer_load_dwordx4 v[220:223], v21, s[36:39], s23 offen offset:144
    v_mfma_f32_16x16x32_bf16 v[240:243], v[224:227], v[128:131], 0
    v_mfma_f32_16x16x32_bf16 v[244:247], v[224:227], v[132:135], 0
    v_mfma_f32_16x16x32_bf16 v[248:251], v[224:227], v[136:139], 0
    v_mfma_f32_16x16x32_bf16 v[252:255], v[224:227], v[140:143], 0
    v_mfma_f32_16x16x32_bf16 v[24:27], v[228:231], v[128:131], 0
    s_nop 7
    v_cvt_pk_bf16_f32 v24, v24, v24
    v_lshlrev_b32 v24, 16, v24
    v_add_f32 v24, 0x358637bd, v24
    v_cvt_pk_bf16_f32 v24, v24, v24
    v_lshlrev_b32 v24, 16, v24
    v_rcp_f32 v24, v24
    v_cvt_pk_bf16_f32 v25, v240, v241
    v_cvt_pk_bf16_f32 v26, v242, v243
    v_lshlrev_b32 v240, 16, v25
    v_and_b32 v241, 0xffff0000, v25
    v_lshlrev_b32 v242, 16, v26
    v_and_b32 v243, 0xffff0000, v26
    v_mul_f32 v240, v240, v24
    v_mul_f32 v241, v241, v24
    v_mul_f32 v242, v242, v24
    v_mul_f32 v243, v243, v24
    v_cvt_pk_bf16_f32 v48, v240, v241
    v_cvt_pk_bf16_f32 v49, v242, v243
    v_mfma_f32_16x16x32_bf16 v[28:31], v[228:231], v[132:135], 0
    s_nop 7
    v_cvt_pk_bf16_f32 v28, v28, v28
    v_lshlrev_b32 v28, 16, v28
    v_add_f32 v28, 0x358637bd, v28
    v_cvt_pk_bf16_f32 v28, v28, v28
    v_lshlrev_b32 v28, 16, v28
    v_rcp_f32 v28, v28
    v_cvt_pk_bf16_f32 v29, v244, v245
    v_cvt_pk_bf16_f32 v30, v246, v247
    v_lshlrev_b32 v244, 16, v29
    v_and_b32 v245, 0xffff0000, v29
    v_lshlrev_b32 v246, 16, v30
    v_and_b32 v247, 0xffff0000, v30
    v_mul_f32 v244, v244, v28
    v_mul_f32 v245, v245, v28
    v_mul_f32 v246, v246, v28
    v_mul_f32 v247, v247, v28
    v_cvt_pk_bf16_f32 v52, v244, v245
    v_cvt_pk_bf16_f32 v53, v246, v247
    v_mfma_f32_16x16x32_bf16 v[24:27], v[228:231], v[136:139], 0
    s_nop 7
    v_cvt_pk_bf16_f32 v24, v24, v24
    v_lshlrev_b32 v24, 16, v24
    v_add_f32 v24, 0x358637bd, v24
    v_cvt_pk_bf16_f32 v24, v24, v24
    v_lshlrev_b32 v24, 16, v24
    v_rcp_f32 v24, v24
    v_cvt_pk_bf16_f32 v25, v248, v249
    v_cvt_pk_bf16_f32 v26, v250, v251
    v_lshlrev_b32 v248, 16, v25
    v_and_b32 v249, 0xffff0000, v25
    v_lshlrev_b32 v250, 16, v26
    v_and_b32 v251, 0xffff0000, v26
    v_mul_f32 v248, v248, v24
    v_mul_f32 v249, v249, v24
    v_mul_f32 v250, v250, v24
    v_mul_f32 v251, v251, v24
    v_cvt_pk_bf16_f32 v56, v248, v249
    v_cvt_pk_bf16_f32 v57, v250, v251
    v_mfma_f32_16x16x32_bf16 v[28:31], v[228:231], v[140:143], 0
    s_nop 7
    v_cvt_pk_bf16_f32 v28, v28, v28
    v_lshlrev_b32 v28, 16, v28
    v_add_f32 v28, 0x358637bd, v28
    v_cvt_pk_bf16_f32 v28, v28, v28
    v_lshlrev_b32 v28, 16, v28
    v_rcp_f32 v28, v28
    v_cvt_pk_bf16_f32 v29, v252, v253
    v_cvt_pk_bf16_f32 v30, v254, v255
    v_lshlrev_b32 v252, 16, v29
    v_and_b32 v253, 0xffff0000, v29
    v_lshlrev_b32 v254, 16, v30
    v_and_b32 v255, 0xffff0000, v30
    v_mul_f32 v252, v252, v28
    v_mul_f32 v253, v253, v28
    v_mul_f32 v254, v254, v28
    v_mul_f32 v255, v255, v28
    v_cvt_pk_bf16_f32 v60, v252, v253
    v_cvt_pk_bf16_f32 v61, v254, v255
    v_mfma_f32_16x16x32_bf16 v[240:243], v[232:235], v[144:147], 0
    v_mfma_f32_16x16x32_bf16 v[244:247], v[232:235], v[148:151], 0
    v_mfma_f32_16x16x32_bf16 v[248:251], v[232:235], v[152:155], 0
    v_mfma_f32_16x16x32_bf16 v[252:255], v[232:235], v[156:159], 0
    v_mfma_f32_16x16x32_bf16 v[24:27], v[236:239], v[144:147], 0
    s_nop 7
    v_cvt_pk_bf16_f32 v24, v24, v24
    v_lshlrev_b32 v24, 16, v24
    v_add_f32 v24, 0x358637bd, v24
    v_cvt_pk_bf16_f32 v24, v24, v24
    v_lshlrev_b32 v24, 16, v24
    v_rcp_f32 v24, v24
    v_cvt_pk_bf16_f32 v25, v240, v241
    v_cvt_pk_bf16_f32 v26, v242, v243
    v_lshlrev_b32 v240, 16, v25
    v_and_b32 v241, 0xffff0000, v25
    v_lshlrev_b32 v242, 16, v26
    v_and_b32 v243, 0xffff0000, v26
    v_mul_f32 v240, v240, v24
    v_mul_f32 v241, v241, v24
    v_mul_f32 v242, v242, v24
    v_mul_f32 v243, v243, v24
    v_cvt_pk_bf16_f32 v50, v240, v241
    v_cvt_pk_bf16_f32 v51, v242, v243
    v_mfma_f32_16x16x32_bf16 v[28:31], v[236:239], v[148:151], 0
    s_nop 7
    v_cvt_pk_bf16_f32 v28, v28, v28
    v_lshlrev_b32 v28, 16, v28
    v_add_f32 v28, 0x358637bd, v28
    v_cvt_pk_bf16_f32 v28, v28, v28
    v_lshlrev_b32 v28, 16, v28
    v_rcp_f32 v28, v28
    v_cvt_pk_bf16_f32 v29, v244, v245
    v_cvt_pk_bf16_f32 v30, v246, v247
    v_lshlrev_b32 v244, 16, v29
    v_and_b32 v245, 0xffff0000, v29
    v_lshlrev_b32 v246, 16, v30
    v_and_b32 v247, 0xffff0000, v30
    v_mul_f32 v244, v244, v28
    v_mul_f32 v245, v245, v28
    v_mul_f32 v246, v246, v28
    v_mul_f32 v247, v247, v28
    v_cvt_pk_bf16_f32 v54, v244, v245
    v_cvt_pk_bf16_f32 v55, v246, v247
    v_mfma_f32_16x16x32_bf16 v[24:27], v[236:239], v[152:155], 0
    s_nop 7
    v_cvt_pk_bf16_f32 v24, v24, v24
    v_lshlrev_b32 v24, 16, v24
    v_add_f32 v24, 0x358637bd, v24
    v_cvt_pk_bf16_f32 v24, v24, v24
    v_lshlrev_b32 v24, 16, v24
    v_rcp_f32 v24, v24
    v_cvt_pk_bf16_f32 v25, v248, v249
    v_cvt_pk_bf16_f32 v26, v250, v251
    v_lshlrev_b32 v248, 16, v25
    v_and_b32 v249, 0xffff0000, v25
    v_lshlrev_b32 v250, 16, v26
    v_and_b32 v251, 0xffff0000, v26
    v_mul_f32 v248, v248, v24
    v_mul_f32 v249, v249, v24
    v_mul_f32 v250, v250, v24
    v_mul_f32 v251, v251, v24
    v_cvt_pk_bf16_f32 v58, v248, v249
    v_cvt_pk_bf16_f32 v59, v250, v251
    v_mfma_f32_16x16x32_bf16 v[28:31], v[236:239], v[156:159], 0
    s_nop 7
    v_cvt_pk_bf16_f32 v28, v28, v28
    v_lshlrev_b32 v28, 16, v28
    v_add_f32 v28, 0x358637bd, v28
    v_cvt_pk_bf16_f32 v28, v28, v28
    v_lshlrev_b32 v28, 16, v28
    v_rcp_f32 v28, v28
    v_cvt_pk_bf16_f32 v29, v252, v253
    v_cvt_pk_bf16_f32 v30, v254, v255
    v_lshlrev_b32 v252, 16, v29
    v_and_b32 v253, 0xffff0000, v29
    v_lshlrev_b32 v254, 16, v30
    v_and_b32 v255, 0xffff0000, v30
    v_mul_f32 v252, v252, v28
    v_mul_f32 v253, v253, v28
    v_mul_f32 v254, v254, v28
    v_mul_f32 v255, v255, v28
    v_cvt_pk_bf16_f32 v62, v252, v253
    v_cvt_pk_bf16_f32 v63, v254, v255
    s_waitcnt lgkmcnt(0)
    v_mfma_f32_16x16x32_bf16 v[64:67], v[32:35], v[48:51], v[64:67]
    v_mfma_f32_16x16x32_bf16 v[68:71], v[32:35], v[52:55], v[68:71]
    v_mfma_f32_16x16x32_bf16 v[72:75], v[32:35], v[56:59], v[72:75]
    v_mfma_f32_16x16x32_bf16 v[76:79], v[32:35], v[60:63], v[76:79]
    v_mfma_f32_16x16x32_bf16 v[80:83], v[36:39], v[48:51], v[80:83]
    v_mfma_f32_16x16x32_bf16 v[84:87], v[36:39], v[52:55], v[84:87]
    v_mfma_f32_16x16x32_bf16 v[88:91], v[36:39], v[56:59], v[88:91]
    v_mfma_f32_16x16x32_bf16 v[92:95], v[36:39], v[60:63], v[92:95]
    v_mfma_f32_16x16x32_bf16 v[96:99], v[40:43], v[48:51], v[96:99]
    v_mfma_f32_16x16x32_bf16 v[100:103], v[40:43], v[52:55], v[100:103]
    v_mfma_f32_16x16x32_bf16 v[104:107], v[40:43], v[56:59], v[104:107]
    v_mfma_f32_16x16x32_bf16 v[108:111], v[40:43], v[60:63], v[108:111]
    v_mfma_f32_16x16x32_bf16 v[112:115], v[44:47], v[48:51], v[112:115]
    v_mfma_f32_16x16x32_bf16 v[116:119], v[44:47], v[52:55], v[116:119]
    v_mfma_f32_16x16x32_bf16 v[120:123], v[44:47], v[56:59], v[120:123]
    v_mfma_f32_16x16x32_bf16 v[124:127], v[44:47], v[60:63], v[124:127]
    s_waitcnt vmcnt(0)
    ds_read_b64_tr_b16 v[32:33], v8 offset:12288
    ds_read_b64_tr_b16 v[34:35], v8 offset:14336
    ds_read_b64_tr_b16 v[36:37], v9 offset:12288
    ds_read_b64_tr_b16 v[38:39], v9 offset:14336
    ds_read_b64_tr_b16 v[40:41], v10 offset:12288
    ds_read_b64_tr_b16 v[42:43], v10 offset:14336
    ds_read_b64_tr_b16 v[44:45], v11 offset:12288
    ds_read_b64_tr_b16 v[46:47], v11 offset:14336
    v_cvt_pk_bf16_f32 v224, v192, v193
    v_cvt_pk_bf16_f32 v225, v194, v195
    v_cvt_pk_bf16_f32 v226, v196, v197
    v_cvt_pk_bf16_f32 v227, v198, v199
    v_cvt_pk_bf16_f32 v228, v208, v209
    v_cvt_pk_bf16_f32 v229, v210, v211
    v_cvt_pk_bf16_f32 v230, v212, v213
    v_cvt_pk_bf16_f32 v231, v214, v215
    v_cvt_pk_bf16_f32 v232, v200, v201
    v_cvt_pk_bf16_f32 v233, v202, v203
    v_cvt_pk_bf16_f32 v234, v204, v205
    v_cvt_pk_bf16_f32 v235, v206, v207
    v_cvt_pk_bf16_f32 v236, v216, v217
    v_cvt_pk_bf16_f32 v237, v218, v219
    v_cvt_pk_bf16_f32 v238, v220, v221
    v_cvt_pk_bf16_f32 v239, v222, v223
    v_mfma_f32_16x16x32_bf16 v[240:243], v[224:227], v[160:163], 0
    v_mfma_f32_16x16x32_bf16 v[244:247], v[224:227], v[164:167], 0
    v_mfma_f32_16x16x32_bf16 v[248:251], v[224:227], v[168:171], 0
    v_mfma_f32_16x16x32_bf16 v[252:255], v[224:227], v[172:175], 0
    v_mfma_f32_16x16x32_bf16 v[24:27], v[228:231], v[160:163], 0
    s_nop 7
    v_cvt_pk_bf16_f32 v24, v24, v24
    v_lshlrev_b32 v24, 16, v24
    v_add_f32 v24, 0x358637bd, v24
    v_cvt_pk_bf16_f32 v24, v24, v24
    v_lshlrev_b32 v24, 16, v24
    v_rcp_f32 v24, v24
    v_cvt_pk_bf16_f32 v25, v240, v241
    v_cvt_pk_bf16_f32 v26, v242, v243
    v_lshlrev_b32 v240, 16, v25
    v_and_b32 v241, 0xffff0000, v25
    v_lshlrev_b32 v242, 16, v26
    v_and_b32 v243, 0xffff0000, v26
    v_mul_f32 v240, v240, v24
    v_mul_f32 v241, v241, v24
    v_mul_f32 v242, v242, v24
    v_mul_f32 v243, v243, v24
    v_cvt_pk_bf16_f32 v48, v240, v241
    v_cvt_pk_bf16_f32 v49, v242, v243
    v_mfma_f32_16x16x32_bf16 v[28:31], v[228:231], v[164:167], 0
    s_nop 7
    v_cvt_pk_bf16_f32 v28, v28, v28
    v_lshlrev_b32 v28, 16, v28
    v_add_f32 v28, 0x358637bd, v28
    v_cvt_pk_bf16_f32 v28, v28, v28
    v_lshlrev_b32 v28, 16, v28
    v_rcp_f32 v28, v28
    v_cvt_pk_bf16_f32 v29, v244, v245
    v_cvt_pk_bf16_f32 v30, v246, v247
    v_lshlrev_b32 v244, 16, v29
    v_and_b32 v245, 0xffff0000, v29
    v_lshlrev_b32 v246, 16, v30
    v_and_b32 v247, 0xffff0000, v30
    v_mul_f32 v244, v244, v28
    v_mul_f32 v245, v245, v28
    v_mul_f32 v246, v246, v28
    v_mul_f32 v247, v247, v28
    v_cvt_pk_bf16_f32 v52, v244, v245
    v_cvt_pk_bf16_f32 v53, v246, v247
    v_mfma_f32_16x16x32_bf16 v[24:27], v[228:231], v[168:171], 0
    s_nop 7
    v_cvt_pk_bf16_f32 v24, v24, v24
    v_lshlrev_b32 v24, 16, v24
    v_add_f32 v24, 0x358637bd, v24
    v_cvt_pk_bf16_f32 v24, v24, v24
    v_lshlrev_b32 v24, 16, v24
    v_rcp_f32 v24, v24
    v_cvt_pk_bf16_f32 v25, v248, v249
    v_cvt_pk_bf16_f32 v26, v250, v251
    v_lshlrev_b32 v248, 16, v25
    v_and_b32 v249, 0xffff0000, v25
    v_lshlrev_b32 v250, 16, v26
    v_and_b32 v251, 0xffff0000, v26
    v_mul_f32 v248, v248, v24
    v_mul_f32 v249, v249, v24
    v_mul_f32 v250, v250, v24
    v_mul_f32 v251, v251, v24
    v_cvt_pk_bf16_f32 v56, v248, v249
    v_cvt_pk_bf16_f32 v57, v250, v251
    v_mfma_f32_16x16x32_bf16 v[28:31], v[228:231], v[172:175], 0
    s_nop 7
    v_cvt_pk_bf16_f32 v28, v28, v28
    v_lshlrev_b32 v28, 16, v28
    v_add_f32 v28, 0x358637bd, v28
    v_cvt_pk_bf16_f32 v28, v28, v28
    v_lshlrev_b32 v28, 16, v28
    v_rcp_f32 v28, v28
    v_cvt_pk_bf16_f32 v29, v252, v253
    v_cvt_pk_bf16_f32 v30, v254, v255
    v_lshlrev_b32 v252, 16, v29
    v_and_b32 v253, 0xffff0000, v29
    v_lshlrev_b32 v254, 16, v30
    v_and_b32 v255, 0xffff0000, v30
    v_mul_f32 v252, v252, v28
    v_mul_f32 v253, v253, v28
    v_mul_f32 v254, v254, v28
    v_mul_f32 v255, v255, v28
    v_cvt_pk_bf16_f32 v60, v252, v253
    v_cvt_pk_bf16_f32 v61, v254, v255
    v_mfma_f32_16x16x32_bf16 v[240:243], v[232:235], v[176:179], 0
    v_mfma_f32_16x16x32_bf16 v[244:247], v[232:235], v[180:183], 0
    v_mfma_f32_16x16x32_bf16 v[248:251], v[232:235], v[184:187], 0
    v_mfma_f32_16x16x32_bf16 v[252:255], v[232:235], v[188:191], 0
    v_mfma_f32_16x16x32_bf16 v[24:27], v[236:239], v[176:179], 0
    s_nop 7
    v_cvt_pk_bf16_f32 v24, v24, v24
    v_lshlrev_b32 v24, 16, v24
    v_add_f32 v24, 0x358637bd, v24
    v_cvt_pk_bf16_f32 v24, v24, v24
    v_lshlrev_b32 v24, 16, v24
    v_rcp_f32 v24, v24
    v_cvt_pk_bf16_f32 v25, v240, v241
    v_cvt_pk_bf16_f32 v26, v242, v243
    v_lshlrev_b32 v240, 16, v25
    v_and_b32 v241, 0xffff0000, v25
    v_lshlrev_b32 v242, 16, v26
    v_and_b32 v243, 0xffff0000, v26
    v_mul_f32 v240, v240, v24
    v_mul_f32 v241, v241, v24
    v_mul_f32 v242, v242, v24
    v_mul_f32 v243, v243, v24
    v_cvt_pk_bf16_f32 v50, v240, v241
    v_cvt_pk_bf16_f32 v51, v242, v243
    v_mfma_f32_16x16x32_bf16 v[28:31], v[236:239], v[180:183], 0
    s_nop 7
    v_cvt_pk_bf16_f32 v28, v28, v28
    v_lshlrev_b32 v28, 16, v28
    v_add_f32 v28, 0x358637bd, v28
    v_cvt_pk_bf16_f32 v28, v28, v28
    v_lshlrev_b32 v28, 16, v28
    v_rcp_f32 v28, v28
    v_cvt_pk_bf16_f32 v29, v244, v245
    v_cvt_pk_bf16_f32 v30, v246, v247
    v_lshlrev_b32 v244, 16, v29
    v_and_b32 v245, 0xffff0000, v29
    v_lshlrev_b32 v246, 16, v30
    v_and_b32 v247, 0xffff0000, v30
    v_mul_f32 v244, v244, v28
    v_mul_f32 v245, v245, v28
    v_mul_f32 v246, v246, v28
    v_mul_f32 v247, v247, v28
    v_cvt_pk_bf16_f32 v54, v244, v245
    v_cvt_pk_bf16_f32 v55, v246, v247
    v_mfma_f32_16x16x32_bf16 v[24:27], v[236:239], v[184:187], 0
    s_nop 7
    v_cvt_pk_bf16_f32 v24, v24, v24
    v_lshlrev_b32 v24, 16, v24
    v_add_f32 v24, 0x358637bd, v24
    v_cvt_pk_bf16_f32 v24, v24, v24
    v_lshlrev_b32 v24, 16, v24
    v_rcp_f32 v24, v24
    v_cvt_pk_bf16_f32 v25, v248, v249
    v_cvt_pk_bf16_f32 v26, v250, v251
    v_lshlrev_b32 v248, 16, v25
    v_and_b32 v249, 0xffff0000, v25
    v_lshlrev_b32 v250, 16, v26
    v_and_b32 v251, 0xffff0000, v26
    v_mul_f32 v248, v248, v24
    v_mul_f32 v249, v249, v24
    v_mul_f32 v250, v250, v24
    v_mul_f32 v251, v251, v24
    v_cvt_pk_bf16_f32 v58, v248, v249
    v_cvt_pk_bf16_f32 v59, v250, v251
    v_mfma_f32_16x16x32_bf16 v[28:31], v[236:239], v[188:191], 0
    s_nop 7
    v_cvt_pk_bf16_f32 v28, v28, v28
    v_lshlrev_b32 v28, 16, v28
    v_add_f32 v28, 0x358637bd, v28
    v_cvt_pk_bf16_f32 v28, v28, v28
    v_lshlrev_b32 v28, 16, v28
    v_rcp_f32 v28, v28
    v_cvt_pk_bf16_f32 v29, v252, v253
    v_cvt_pk_bf16_f32 v30, v254, v255
    v_lshlrev_b32 v252, 16, v29
    v_and_b32 v253, 0xffff0000, v29
    v_lshlrev_b32 v254, 16, v30
    v_and_b32 v255, 0xffff0000, v30
    v_mul_f32 v252, v252, v28
    v_mul_f32 v253, v253, v28
    v_mul_f32 v254, v254, v28
    v_mul_f32 v255, v255, v28
    v_cvt_pk_bf16_f32 v62, v252, v253
    v_cvt_pk_bf16_f32 v63, v254, v255
    s_waitcnt lgkmcnt(0)
    v_mfma_f32_16x16x32_bf16 v[64:67], v[32:35], v[48:51], v[64:67]
    v_mfma_f32_16x16x32_bf16 v[68:71], v[32:35], v[52:55], v[68:71]
    v_mfma_f32_16x16x32_bf16 v[72:75], v[32:35], v[56:59], v[72:75]
    v_mfma_f32_16x16x32_bf16 v[76:79], v[32:35], v[60:63], v[76:79]
    v_mfma_f32_16x16x32_bf16 v[80:83], v[36:39], v[48:51], v[80:83]
    v_mfma_f32_16x16x32_bf16 v[84:87], v[36:39], v[52:55], v[84:87]
    v_mfma_f32_16x16x32_bf16 v[88:91], v[36:39], v[56:59], v[88:91]
    v_mfma_f32_16x16x32_bf16 v[92:95], v[36:39], v[60:63], v[92:95]
    v_mfma_f32_16x16x32_bf16 v[96:99], v[40:43], v[48:51], v[96:99]
    v_mfma_f32_16x16x32_bf16 v[100:103], v[40:43], v[52:55], v[100:103]
    v_mfma_f32_16x16x32_bf16 v[104:107], v[40:43], v[56:59], v[104:107]
    v_mfma_f32_16x16x32_bf16 v[108:111], v[40:43], v[60:63], v[108:111]
    v_mfma_f32_16x16x32_bf16 v[112:115], v[44:47], v[48:51], v[112:115]
    v_mfma_f32_16x16x32_bf16 v[116:119], v[44:47], v[52:55], v[116:119]
    v_mfma_f32_16x16x32_bf16 v[120:123], v[44:47], v[56:59], v[120:123]
    v_mfma_f32_16x16x32_bf16 v[124:127], v[44:47], v[60:63], v[124:127]
K2_part_out:
    v_mul_u32_u24 v4, 272, v2
    v_lshl_add_u32 v4, v3, 4, v4
    v_add_u32 v4, s20, v4
    ds_write_b128 v4, v[64:67] offset:0
    ds_write_b128 v4, v[68:71] offset:4352
    ds_write_b128 v4, v[72:75] offset:8704
    ds_write_b128 v4, v[76:79] offset:13056
    ds_write_b128 v4, v[80:83] offset:64
    ds_write_b128 v4, v[84:87] offset:4416
    ds_write_b128 v4, v[88:91] offset:8768
    ds_write_b128 v4, v[92:95] offset:13120
    ds_write_b128 v4, v[96:99] offset:128
    ds_write_b128 v4, v[100:103] offset:4480
    ds_write_b128 v4, v[104:107] offset:8832
    ds_write_b128 v4, v[108:111] offset:13184
    ds_write_b128 v4, v[112:115] offset:192
    ds_write_b128 v4, v[116:119] offset:4544
    ds_write_b128 v4, v[120:123] offset:8896
    ds_write_b128 v4, v[124:127] offset:13248
    s_mov_b32 s24, s4
    s_mov_b32 s25, s5
    s_mov_b32 s26, 0x200000
    s_mov_b32 s27, 0x00020000
    s_mov_b32 s28, s10
    s_mov_b32 s29, s11
    s_mov_b32 s30, 0x200000
    s_mov_b32 s31, 0x00020000
    v_lshrrev_b32 v5, 3, v0
    v_and_b32 v6, 7, v0
    v_add_u32 v7, s14, v5
    v_lshlrev_b32 v7, 10, v7
    v_lshl_add_u32 v7, v6, 4, v7
    v_add_u32 v7, s15, v7
    buffer_load_dwordx4 v[8:11], v7, s[24:27], 0 offen
    v_mul_u32_u24 v5, 272, v5
    v_lshl_add_u32 v5, v6, 5, v5
    v_add_u32 v6, 69632, v5
    s_waitcnt lgkmcnt(0)
    s_barrier
    ds_read_b128 v[64:67], v5 offset:0
    ds_read_b128 v[68:71], v5 offset:16
    ds_read_b128 v[72:75], v5 offset:17408
    ds_read_b128 v[76:79], v5 offset:17424
    ds_read_b128 v[80:83], v5 offset:34816
    ds_read_b128 v[84:87], v5 offset:34832
    ds_read_b128 v[88:91], v5 offset:52224
    ds_read_b128 v[92:95], v5 offset:52240
    ds_read_b128 v[96:99], v6 offset:0
    ds_read_b128 v[100:103], v6 offset:16
    ds_read_b128 v[104:107], v6 offset:17408
    ds_read_b128 v[108:111], v6 offset:17424
    ds_read_b128 v[112:115], v6 offset:34816
    ds_read_b128 v[116:119], v6 offset:34832
    ds_read_b128 v[120:123], v6 offset:52224
    ds_read_b128 v[124:127], v6 offset:52240
    s_waitcnt lgkmcnt(8)
    v_add_f32 v64, v64, v72
    v_add_f32 v65, v65, v73
    v_add_f32 v66, v66, v74
    v_add_f32 v67, v67, v75
    v_add_f32 v68, v68, v76
    v_add_f32 v69, v69, v77
    v_add_f32 v70, v70, v78
    v_add_f32 v71, v71, v79
    v_add_f32 v64, v64, v80
    v_add_f32 v65, v65, v81
    v_add_f32 v66, v66, v82
    v_add_f32 v67, v67, v83
    v_add_f32 v68, v68, v84
    v_add_f32 v69, v69, v85
    v_add_f32 v70, v70, v86
    v_add_f32 v71, v71, v87
    v_add_f32 v64, v64, v88
    v_add_f32 v65, v65, v89
    v_add_f32 v66, v66, v90
    v_add_f32 v67, v67, v91
    v_add_f32 v68, v68, v92
    v_add_f32 v69, v69, v93
    v_add_f32 v70, v70, v94
    v_add_f32 v71, v71, v95
    s_waitcnt lgkmcnt(0)
    v_add_f32 v96, v96, v104
    v_add_f32 v97, v97, v105
    v_add_f32 v98, v98, v106
    v_add_f32 v99, v99, v107
    v_add_f32 v100, v100, v108
    v_add_f32 v101, v101, v109
    v_add_f32 v102, v102, v110
    v_add_f32 v103, v103, v111
    v_add_f32 v96, v96, v112
    v_add_f32 v97, v97, v113
    v_add_f32 v98, v98, v114
    v_add_f32 v99, v99, v115
    v_add_f32 v100, v100, v116
    v_add_f32 v101, v101, v117
    v_add_f32 v102, v102, v118
    v_add_f32 v103, v103, v119
    v_add_f32 v96, v96, v120
    v_add_f32 v97, v97, v121
    v_add_f32 v98, v98, v122
    v_add_f32 v99, v99, v123
    v_add_f32 v100, v100, v124
    v_add_f32 v101, v101, v125
    v_add_f32 v102, v102, v126
    v_add_f32 v103, v103, v127
    v_cvt_pk_bf16_f32 v72, v64, v65
    v_cvt_pk_bf16_f32 v73, v66, v67
    v_cvt_pk_bf16_f32 v74, v68, v69
    v_cvt_pk_bf16_f32 v75, v70, v71
    v_lshlrev_b32 v64, 16, v72
    v_and_b32 v65, 0xffff0000, v72
    v_lshlrev_b32 v66, 16, v73
    v_and_b32 v67, 0xffff0000, v73
    v_lshlrev_b32 v68, 16, v74
    v_and_b32 v69, 0xffff0000, v74
    v_lshlrev_b32 v70, 16, v75
    v_and_b32 v71, 0xffff0000, v75
    v_cvt_pk_bf16_f32 v72, v96, v97
    v_cvt_pk_bf16_f32 v73, v98, v99
    v_cvt_pk_bf16_f32 v74, v100, v101
    v_cvt_pk_bf16_f32 v75, v102, v103
    v_lshlrev_b32 v96, 16, v72
    v_and_b32 v97, 0xffff0000, v72
    v_lshlrev_b32 v98, 16, v73
    v_and_b32 v99, 0xffff0000, v73
    v_lshlrev_b32 v100, 16, v74
    v_and_b32 v101, 0xffff0000, v74
    v_lshlrev_b32 v102, 16, v75
    v_and_b32 v103, 0xffff0000, v75
    v_mul_f32 v104, 0xbfb8aa3b, v96
    v_mul_f32 v105, 0xbfb8aa3b, v97
    v_mul_f32 v106, 0xbfb8aa3b, v98
    v_mul_f32 v107, 0xbfb8aa3b, v99
    v_mul_f32 v108, 0xbfb8aa3b, v100
    v_mul_f32 v109, 0xbfb8aa3b, v101
    v_mul_f32 v110, 0xbfb8aa3b, v102
    v_mul_f32 v111, 0xbfb8aa3b, v103
    v_exp_f32 v104, v104
    v_exp_f32 v105, v105
    v_exp_f32 v106, v106
    v_exp_f32 v107, v107
    v_exp_f32 v108, v108
    v_exp_f32 v109, v109
    v_exp_f32 v110, v110
    v_exp_f32 v111, v111
    v_add_f32 v104, 1.0, v104
    v_add_f32 v105, 1.0, v105
    v_add_f32 v106, 1.0, v106
    v_add_f32 v107, 1.0, v107
    v_add_f32 v108, 1.0, v108
    v_add_f32 v109, 1.0, v109
    v_add_f32 v110, 1.0, v110
    v_add_f32 v111, 1.0, v111
    v_rcp_f32 v104, v104
    v_rcp_f32 v105, v105
    v_rcp_f32 v106, v106
    v_rcp_f32 v107, v107
    v_rcp_f32 v108, v108
    v_rcp_f32 v109, v109
    v_rcp_f32 v110, v110
    v_rcp_f32 v111, v111
    v_mul_f32 v104, v104, v96
    v_mul_f32 v105, v105, v97
    v_mul_f32 v106, v106, v98
    v_mul_f32 v107, v107, v99
    v_mul_f32 v108, v108, v100
    v_mul_f32 v109, v109, v101
    v_mul_f32 v110, v110, v102
    v_mul_f32 v111, v111, v103
    v_cvt_pk_bf16_f32 v72, v104, v105
    v_cvt_pk_bf16_f32 v73, v106, v107
    v_cvt_pk_bf16_f32 v74, v108, v109
    v_cvt_pk_bf16_f32 v75, v110, v111
    v_lshlrev_b32 v104, 16, v72
    v_and_b32 v105, 0xffff0000, v72
    v_lshlrev_b32 v106, 16, v73
    v_and_b32 v107, 0xffff0000, v73
    v_lshlrev_b32 v108, 16, v74
    v_and_b32 v109, 0xffff0000, v74
    v_lshlrev_b32 v110, 16, v75
    v_and_b32 v111, 0xffff0000, v75
    v_mul_f32 v64, v64, v104
    v_mul_f32 v65, v65, v105
    v_mul_f32 v66, v66, v106
    v_mul_f32 v67, v67, v107
    v_mul_f32 v68, v68, v108
    v_mul_f32 v69, v69, v109
    v_mul_f32 v70, v70, v110
    v_mul_f32 v71, v71, v111
    v_cvt_pk_bf16_f32 v72, v64, v65
    v_cvt_pk_bf16_f32 v73, v66, v67
    v_cvt_pk_bf16_f32 v74, v68, v69
    v_cvt_pk_bf16_f32 v75, v70, v71
    v_lshlrev_b32 v64, 16, v72
    v_and_b32 v65, 0xffff0000, v72
    v_lshlrev_b32 v66, 16, v73
    v_and_b32 v67, 0xffff0000, v73
    v_lshlrev_b32 v68, 16, v74
    v_and_b32 v69, 0xffff0000, v74
    v_lshlrev_b32 v70, 16, v75
    v_and_b32 v71, 0xffff0000, v75
    s_waitcnt vmcnt(0)
    v_lshlrev_b32 v96, 16, v8
    v_and_b32 v97, 0xffff0000, v8
    v_lshlrev_b32 v98, 16, v9
    v_and_b32 v99, 0xffff0000, v9
    v_lshlrev_b32 v100, 16, v10
    v_and_b32 v101, 0xffff0000, v10
    v_lshlrev_b32 v102, 16, v11
    v_and_b32 v103, 0xffff0000, v11
    v_add_f32 v64, v64, v96
    v_add_f32 v65, v65, v97
    v_add_f32 v66, v66, v98
    v_add_f32 v67, v67, v99
    v_add_f32 v68, v68, v100
    v_add_f32 v69, v69, v101
    v_add_f32 v70, v70, v102
    v_add_f32 v71, v71, v103
    v_cvt_pk_bf16_f32 v72, v64, v65
    v_cvt_pk_bf16_f32 v73, v66, v67
    v_cvt_pk_bf16_f32 v74, v68, v69
    v_cvt_pk_bf16_f32 v75, v70, v71
    buffer_store_dwordx4 v[72:75], v7, s[28:31], 0 offen
K2_done:
    s_endpgm
.section .rodata,"a"
.p2align 6
.amdhsa_kernel k0_kernel
  .amdhsa_next_free_vgpr 32
  .amdhsa_next_free_sgpr 40
  .amdhsa_accum_offset 32
  .amdhsa_group_segment_fixed_size 0
  .amdhsa_kernarg_size 88
  .amdhsa_user_sgpr_count 2
  .amdhsa_user_sgpr_kernarg_segment_ptr 1
  .amdhsa_system_sgpr_workgroup_id_x 1
.end_amdhsa_kernel
.section .rodata,"a"
.p2align 6
.amdhsa_kernel k1_kernel
  .amdhsa_next_free_vgpr 256
  .amdhsa_next_free_sgpr 100
  .amdhsa_accum_offset 256
  .amdhsa_group_segment_fixed_size 0
  .amdhsa_kernarg_size 88
  .amdhsa_user_sgpr_count 2
  .amdhsa_user_sgpr_kernarg_segment_ptr 1
  .amdhsa_system_sgpr_workgroup_id_x 1
.end_amdhsa_kernel
.section .rodata,"a"
.p2align 6
.amdhsa_kernel k2_kernel
  .amdhsa_next_free_vgpr 256
  .amdhsa_next_free_sgpr 100
  .amdhsa_accum_offset 256
  .amdhsa_group_segment_fixed_size 0
  .amdhsa_kernarg_size 88
  .amdhsa_user_sgpr_count 2
  .amdhsa_user_sgpr_kernarg_segment_ptr 1
  .amdhsa_system_sgpr_workgroup_id_x 1
.end_amdhsa_kernel
```
